```python
import torch

def _softmax(x, axis=-1):
    return torch.softmax(x, dim=axis)
def _gelu(x):
    return torch.nn.functional.gelu(x, approximate="tanh")
def _silu(x):
    return torch.nn.functional.silu(x)
def _sigmoid(x):
    return torch.sigmoid(x)
def _layernorm(x, axis=-1, eps=1e-5):
    m = x.mean(dim=axis, keepdim=True)
    v = x.var(dim=axis, keepdim=True, unbiased=False)
    return (x - m) / torch.sqrt(v + eps)
def _scatter_add(tgt, idx, src, axis=0):
    return tgt.clone().index_add_(axis, idx, src)
def _segment_sum(src, seg, n):
    out = torch.zeros((n,) + src.shape[1:], dtype=src.dtype)
    return out.index_add_(0, seg, src)
def _pad(x, pw):
    flat = tuple(v for pair in reversed(pw) for v in pair)
    return torch.nn.functional.pad(x, flat)

kernel_name = 'sequential_preLN__ssm_conv_s4__glu_gated_swiglu__prompt'

def setup_inputs():

    _w = (lambda a: (lambda t: t.to(torch.bfloat16) if t.is_floating_point() else t)(torch.as_tensor(a)))
    def _A_setup():
        B, L, D, N = 1, 2048, 640, 128
        A_re = -(lambda _x: torch.exp(torch.as_tensor(_x)))((lambda *s: torch.randn(*s, dtype=torch.bfloat16) * 6.4)(D, N))
        A_im = torch.pi * (lambda *s: torch.randn(*s, dtype=torch.bfloat16) * 0.05)(D, N)
        B_re = (lambda *s: torch.randn(*s, dtype=torch.bfloat16) * 0.05)(D, N)
        B_im = (lambda *s: torch.randn(*s, dtype=torch.bfloat16) * 0.05)(D, N)
        C_re = (lambda *s: torch.randn(*s, dtype=torch.bfloat16) * 0.05)(D, N)
        C_im = (lambda *s: torch.randn(*s, dtype=torch.bfloat16) * 0.05)(D, N)
        log_dt = (lambda *s: torch.randn(*s, dtype=torch.bfloat16) * 0.05)(D) * 0.5 - 4.0
        Dskip = (lambda *s: torch.randn(*s, dtype=torch.bfloat16) * 0.05)(D)
        return {
            "u": _w((lambda *s: torch.randn(*s, dtype=torch.bfloat16) * 0.05)(B, L, D)),
            "A_re": _w(A_re),
            "A_im": _w(A_im),
            "B_re": _w(B_re),
            "B_im": _w(B_im),
            "C_re": _w(C_re),
            "C_im": _w(C_im),
            "log_dt": _w(log_dt),
            "Dskip": _w(Dskip),
        }
    _A_in = _A_setup()

    def _B_setup():
        B, S, D, F = 1, 2048, 640, 1728
        return {
            "x": _w((lambda *s: torch.randn(*s, dtype=torch.bfloat16) * 0.05)(B, S, D)),
            "w1": _w((lambda *s: torch.randn(*s, dtype=torch.bfloat16) * 0.4)(D, F) * (2.0 / D) ** 0.5),
            "w3": _w((lambda *s: torch.randn(*s, dtype=torch.bfloat16) * 0.4)(D, F) * (2.0 / D) ** 0.5),
            "w2": _w((lambda *s: torch.randn(*s, dtype=torch.bfloat16) * 0.4)(F, D) * (2.0 / F) ** 0.5),
        }
    _B_in = _B_setup()

    return {
        "A_u": _A_in["u"],
        "A_A_re": _A_in["A_re"],
        "A_A_im": _A_in["A_im"],
        "A_B_re": _A_in["B_re"],
        "A_B_im": _A_in["B_im"],
        "A_C_re": _A_in["C_re"],
        "A_C_im": _A_in["C_im"],
        "A_log_dt": _A_in["log_dt"],
        "A_Dskip": _A_in["Dskip"],
        "B_x": _B_in["x"],
        "B_w1": _B_in["w1"],
        "B_w3": _B_in["w3"],
        "B_w2": _B_in["w2"],
    }

def reference(A_u, A_A_re, A_A_im, A_B_re, A_B_im, A_C_re, A_C_im, A_log_dt, A_Dskip, B_x, B_w1, B_w3, B_w2):
    def _A_ref(u, A_re, A_im, B_re, B_im, C_re, C_im, log_dt, Dskip):
        Bsz, L, D = u.shape
        dt = torch.exp(log_dt)[:, None]
        A = A_re + 1j * A_im
        Bc = B_re + 1j * B_im
        Cc = C_re + 1j * C_im
        logdA = dt * A
        dB = dt * Bc
        l = (lambda x, dt: x.to(dt))(torch.arange(L), A_re.dtype)
        P = torch.exp(logdA[:, :, None] * l[None, None, :])
        K = torch.einsum("dn,dnl,dn->dl", Cc, P, dB).real
        L2 = 2 * L
        Kp = _pad(K, ((0, 0), (0, L)))
        up = (lambda x, *d: x.permute(*d))(u, 0, 2, 1)
        up = _pad(up, ((0, 0), (0, 0), (0, L)))
        Kf = (lambda x, axes=(-2,-1): torch.fft.rfft2(x.float(), dim=axes))(Kp[:, None, :], axes=(-2, -1))
        Uf = (lambda x, axes=(-2,-1): torch.fft.rfft2(x.float(), dim=axes))(up[:, :, None, :], axes=(-2, -1))
        Yf = Uf * Kf[None, :, :, :]
        y = (lambda x, s, axes=(-2,-1): torch.fft.irfft2(x, s=s, dim=axes).to(torch.bfloat16))(Yf, (1, L2), axes=(-2, -1))[:, :, 0, :L]
        y = (lambda x, *d: x.permute(*d))(y, 0, 2, 1) + u * Dskip[None, None, :]
        return y

    def _B_ref(x, w1, w3, w2):
        gate = torch.einsum("bsd,df->bsf", x, w1)
        up = torch.einsum("bsd,df->bsf", x, w3)
        h = _silu(gate) * up
        out = torch.einsum("bsf,fd->bsd", h, w2)
        return out

    x = A_u
    h = x + _A_ref(_layernorm(x, axis=-1), A_A_re, A_A_im, A_B_re, A_B_im, A_C_re, A_C_im, A_log_dt, A_Dskip)
    h2 = h + _B_ref(_layernorm(h, axis=-1), B_w1, B_w3, B_w2)
    return h2
```

```asm
; @launch grid=(256,1,1) block=(512,1,1) lds=160896
.amdgcn_target "amdgcn-amd-amdhsa--gfx950"
.text
.globl sequential_preLN__ssm_conv_s4__glu_gated_swiglu__prompt_kernel
.p2align 8
.type sequential_preLN__ssm_conv_s4__glu_gated_swiglu__prompt_kernel,@function
sequential_preLN__ssm_conv_s4__glu_gated_swiglu__prompt_kernel:
    s_cmp_ge_u32 s2, 256
    s_cbranch_scc1 done_sequential_preLN__ssm_conv_s4__glu_gated_swiglu__prompt_kernel_1
    s_load_dwordx4 s[4:7], s[0:1], 0
    s_load_dwordx4 s[48:51], s[0:1], 112
    s_load_dwordx4 s[8:11], s[0:1], 16
    s_load_dwordx4 s[12:15], s[0:1], 32
    s_load_dwordx4 s[16:19], s[0:1], 48
    s_load_dwordx2 s[20:21], s[0:1], 64
    s_load_dwordx2 s[60:61], s[0:1], 96
    v_lshrrev_b32 v1, 6, v0
    s_sub_u32 s62, s2, 0
    v_readfirstlane_b32 s36, v1
    s_nop 1
    s_cmp_lt_u32 s36, 4
    s_cbranch_scc1 main_sequential_preLN__ssm_conv_s4__glu_gated_swiglu__prompt_kernel_4
    s_lshr_b32 s40, s2, 3
    s_and_b32 s40, s40, 7
    s_cmp_lg_u32 s40, 0
    s_cbranch_scc1 comp_rest_sequential_preLN__ssm_conv_s4__glu_gated_swiglu__prompt_kernel_6
    s_getpc_b64 s[40:41]
here_sequential_preLN__ssm_conv_s4__glu_gated_swiglu__prompt_kernel_7:
    s_sub_u32 s40, s40, here_sequential_preLN__ssm_conv_s4__glu_gated_swiglu__prompt_kernel_7-sequential_preLN__ssm_conv_s4__glu_gated_swiglu__prompt_kernel
    s_subb_u32 s41, s41, 0
    v_lshlrev_b32 v2, 4, v0
    v_subrev_u32 v2, 4096, v2
    v_mov_b32 v6, s41
    s_mov_b32 s42, 11
pf_sequential_preLN__ssm_conv_s4__glu_gated_swiglu__prompt_kernel_8:
    v_min_u32 v3, done_sequential_preLN__ssm_conv_s4__glu_gated_swiglu__prompt_kernel_1-sequential_preLN__ssm_conv_s4__glu_gated_swiglu__prompt_kernel-16, v2
    v_add_co_u32 v4, vcc, s40, v3
    v_add_u32 v2, 4096, v2
    s_sub_u32 s42, s42, 1
    v_addc_co_u32 v5, vcc, 0, v6, vcc
    s_cmp_lg_u32 s42, 0
    global_load_dwordx4 v[8:11], v[4:5], off
    s_cbranch_scc1 pf_sequential_preLN__ssm_conv_s4__glu_gated_swiglu__prompt_kernel_8
comp_rest_sequential_preLN__ssm_conv_s4__glu_gated_swiglu__prompt_kernel_6:
    s_waitcnt vmcnt(0) lgkmcnt(0)
    s_cmp_ge_u32 s62, 96
    s_cbranch_scc1 comp_conv_sequential_preLN__ssm_conv_s4__glu_gated_swiglu__prompt_kernel_11
    s_barrier
    s_barrier
    s_branch ffn_sequential_preLN__ssm_conv_s4__glu_gated_swiglu__prompt_kernel_2
comp_conv_sequential_preLN__ssm_conv_s4__glu_gated_swiglu__prompt_kernel_11:
    s_cmp_lt_u32 s2, 224
    s_cbranch_scc1 comp_w13_sequential_preLN__ssm_conv_s4__glu_gated_swiglu__prompt_kernel_9
comp_now13_sequential_preLN__ssm_conv_s4__glu_gated_swiglu__prompt_kernel_10:
    s_barrier
    s_barrier
    s_barrier
    s_barrier
    s_barrier
    s_barrier
    s_branch ffn_sequential_preLN__ssm_conv_s4__glu_gated_swiglu__prompt_kernel_2
main_sequential_preLN__ssm_conv_s4__glu_gated_swiglu__prompt_kernel_4:
    s_cmp_lt_u32 s62, 96
    s_cbranch_scc1 toln_sequential_preLN__ssm_conv_s4__glu_gated_swiglu__prompt_kernel_12
    s_sub_u32 s39, s2, 96
    s_lshl_b32 s37, s39, 2
    s_add_u32 s37, s37, s36
    s_waitcnt lgkmcnt(0)
    v_and_b32 v246, 63, v0
    s_lshl_b32 s40, s37, 8
    v_lshl_add_u32 v246, v246, 2, s40
    global_load_dword v240, v246, s[6:7]
    global_load_dword v241, v246, s[8:9]
    global_load_dword v242, v246, s[10:11]
    global_load_dword v243, v246, s[12:13]
    global_load_dword v244, v246, s[14:15]
    global_load_dword v245, v246, s[16:17]
    s_lshr_b32 s40, s37, 1
    s_lshl_b32 s40, s40, 2
    s_load_dword s56, s[18:19], s40
    s_load_dword s57, s[20:21], s40
    s_branch conv_sequential_preLN__ssm_conv_s4__glu_gated_swiglu__prompt_kernel_3
toln_sequential_preLN__ssm_conv_s4__glu_gated_swiglu__prompt_kernel_12:
lnpath_sequential_preLN__ssm_conv_s4__glu_gated_swiglu__prompt_kernel_5:
    s_waitcnt lgkmcnt(0)
    v_and_b32 v3, 63, v0
    v_lshrrev_b32 v4, 3, v3
    v_and_b32 v5, 7, v3
    s_mul_i32 s40, s36, 88
    s_add_u32 s40, s40, s62
    s_sub_u32 s40, s40, 8
    s_cmp_lt_u32 s62, 8
    s_cselect_b32 s40, 256, s40
    s_min_u32 s41, s40, 255
    s_lshl_b32 s41, s41, 3
    v_add_u32 v6, s41, v4
    v_lshlrev_b32 v100, 3, v6
    v_mul_u32_u24 v6, 1280, v6
    v_lshl_add_u32 v6, v5, 4, v6
    s_cmp_ge_u32 s40, 256
    s_cbranch_scc1 ln_noload_sequential_preLN__ssm_conv_s4__glu_gated_swiglu__prompt_kernel_14
    global_load_dwordx4 v[12:15], v6, s[4:5] offset:0
    global_load_dwordx4 v[16:19], v6, s[4:5] offset:128
    global_load_dwordx4 v[20:23], v6, s[4:5] offset:256
    global_load_dwordx4 v[24:27], v6, s[4:5] offset:384
    global_load_dwordx4 v[28:31], v6, s[4:5] offset:512
    global_load_dwordx4 v[32:35], v6, s[4:5] offset:640
    global_load_dwordx4 v[36:39], v6, s[4:5] offset:768
    global_load_dwordx4 v[40:43], v6, s[4:5] offset:896
    global_load_dwordx4 v[44:47], v6, s[4:5] offset:1024
    global_load_dwordx4 v[48:51], v6, s[4:5] offset:1152
ln_noload_sequential_preLN__ssm_conv_s4__glu_gated_swiglu__prompt_kernel_14:
    s_mov_b32 s22, s50
    s_mov_b32 s23, s51
    s_mov_b32 s32, s48
    s_mov_b32 s33, s49
    s_mov_b32 s34, 256
    s_mov_b32 s35, 0x20000
    s_mov_b32 s24, s22
    s_mov_b32 s25, s23
    s_mov_b32 s26, 5242880
    s_mov_b32 s27, 0x20000
    s_add_u32 s56, s22, 22134784
    s_addc_u32 s57, s23, 0
    s_mov_b32 s58, 16384
    s_mov_b32 s59, 0x20000
    s_cmp_lg_u32 s62, 4
    s_cbranch_scc1 nozero_sequential_preLN__ssm_conv_s4__glu_gated_swiglu__prompt_kernel_15
    s_cmp_lg_u32 s36, 3
    s_cbranch_scc1 nozero_sequential_preLN__ssm_conv_s4__glu_gated_swiglu__prompt_kernel_15
    v_and_b32 v200, 63, v0
    v_lshlrev_b32 v200, 4, v200
    v_mov_b32 v204, 0
    v_mov_b32 v205, 0
    v_mov_b32 v206, 0
    v_mov_b32 v207, 0
    s_mov_b32 s44, 0
    buffer_store_dwordx4 v[204:207], v200, s[56:59], s44 offen offset:0 sc1
    s_mov_b32 s44, 0
    buffer_store_dwordx4 v[204:207], v200, s[56:59], s44 offen offset:1024 sc1
    s_mov_b32 s44, 0
    buffer_store_dwordx4 v[204:207], v200, s[56:59], s44 offen offset:2048 sc1
    s_mov_b32 s44, 0
    buffer_store_dwordx4 v[204:207], v200, s[56:59], s44 offen offset:3072 sc1
    s_mov_b32 s44, 4096
    buffer_store_dwordx4 v[204:207], v200, s[56:59], s44 offen offset:0 sc1
    s_mov_b32 s44, 4096
    buffer_store_dwordx4 v[204:207], v200, s[56:59], s44 offen offset:1024 sc1
    s_mov_b32 s44, 4096
    buffer_store_dwordx4 v[204:207], v200, s[56:59], s44 offen offset:2048 sc1
    s_mov_b32 s44, 4096
    buffer_store_dwordx4 v[204:207], v200, s[56:59], s44 offen offset:3072 sc1
    s_mov_b32 s44, 8192
    buffer_store_dwordx4 v[204:207], v200, s[56:59], s44 offen offset:0 sc1
    s_mov_b32 s44, 8192
    buffer_store_dwordx4 v[204:207], v200, s[56:59], s44 offen offset:1024 sc1
    s_mov_b32 s44, 8192
    buffer_store_dwordx4 v[204:207], v200, s[56:59], s44 offen offset:2048 sc1
    s_mov_b32 s44, 8192
    buffer_store_dwordx4 v[204:207], v200, s[56:59], s44 offen offset:3072 sc1
    s_mov_b32 s44, 12288
    buffer_store_dwordx4 v[204:207], v200, s[56:59], s44 offen offset:0 sc1
    s_mov_b32 s44, 12288
    buffer_store_dwordx4 v[204:207], v200, s[56:59], s44 offen offset:1024 sc1
    s_mov_b32 s44, 12288
    buffer_store_dwordx4 v[204:207], v200, s[56:59], s44 offen offset:2048 sc1
    s_mov_b32 s44, 12288
    buffer_store_dwordx4 v[204:207], v200, s[56:59], s44 offen offset:3072 sc1
nozero_sequential_preLN__ssm_conv_s4__glu_gated_swiglu__prompt_kernel_15:
    s_mul_i32 s42, s36, 10752
    v_mul_u32_u24 v7, 1344, v4
    v_lshl_add_u32 v7, v5, 4, v7
    v_add_u32 v97, s42, v7
    v_mov_b32 v96, 0x3f803f80
    v_mov_b32 v92, 0
    v_mov_b32 v93, 0
    v_mov_b32 v94, 0
    v_mov_b32 v95, 0
    v_bfe_u32 v7, v3, 2, 2
    v_mul_u32_u24 v7, 1344, v7
    v_lshrrev_b32 v8, 4, v3
    v_lshl_add_u32 v7, v8, 5, v7
    v_and_b32 v8, 3, v3
    v_lshl_add_u32 v7, v8, 3, v7
    v_add_u32 v98, s42, v7
    s_mul_i32 s43, s40, 10240
    v_lshl_add_u32 v99, v3, 4, s43
    s_cmp_ge_u32 s40, 256
    s_cbranch_scc1 ln_skip_sequential_preLN__ssm_conv_s4__glu_gated_swiglu__prompt_kernel_13
    s_waitcnt vmcnt(9)
    ds_write_b128 v97, v[12:15] offset:0
    ds_read_b64_tr_b16 v[52:53], v98 offset:0
    ds_read_b64_tr_b16 v[54:55], v98 offset:5376
    v_dot2_f32_bf16 v92, v12, v96, v92
    v_dot2_f32_bf16 v93, v12, v12, v93
    v_dot2_f32_bf16 v94, v13, v96, v94
    v_dot2_f32_bf16 v95, v13, v13, v95
    v_dot2_f32_bf16 v92, v14, v96, v92
    v_dot2_f32_bf16 v93, v14, v14, v93
    v_dot2_f32_bf16 v94, v15, v96, v94
    v_dot2_f32_bf16 v95, v15, v15, v95
    s_waitcnt vmcnt(8)
    ds_write_b128 v97, v[16:19] offset:128
    ds_read_b64_tr_b16 v[56:57], v98 offset:128
    ds_read_b64_tr_b16 v[58:59], v98 offset:5504
    v_dot2_f32_bf16 v92, v16, v96, v92
    v_dot2_f32_bf16 v93, v16, v16, v93
    v_dot2_f32_bf16 v94, v17, v96, v94
    v_dot2_f32_bf16 v95, v17, v17, v95
    v_dot2_f32_bf16 v92, v18, v96, v92
    v_dot2_f32_bf16 v93, v18, v18, v93
    v_dot2_f32_bf16 v94, v19, v96, v94
    v_dot2_f32_bf16 v95, v19, v19, v95
    s_waitcnt lgkmcnt(3)
    s_mov_b32 s44, 2621440
    buffer_store_dwordx4 v[52:55], v99, s[24:27], s44 offen sc1
    s_waitcnt vmcnt(8)
    ds_write_b128 v97, v[20:23] offset:256
    ds_read_b64_tr_b16 v[60:61], v98 offset:256
    ds_read_b64_tr_b16 v[62:63], v98 offset:5632
    v_dot2_f32_bf16 v92, v20, v96, v92
    v_dot2_f32_bf16 v93, v20, v20, v93
    v_dot2_f32_bf16 v94, v21, v96, v94
    v_dot2_f32_bf16 v95, v21, v21, v95
    v_dot2_f32_bf16 v92, v22, v96, v92
    v_dot2_f32_bf16 v93, v22, v22, v93
    v_dot2_f32_bf16 v94, v23, v96, v94
    v_dot2_f32_bf16 v95, v23, v23, v95
    s_waitcnt lgkmcnt(3)
    s_mov_b32 s44, 2622464
    buffer_store_dwordx4 v[56:59], v99, s[24:27], s44 offen sc1
    s_waitcnt vmcnt(8)
    ds_write_b128 v97, v[24:27] offset:384
    ds_read_b64_tr_b16 v[64:65], v98 offset:384
    ds_read_b64_tr_b16 v[66:67], v98 offset:5760
    v_dot2_f32_bf16 v92, v24, v96, v92
    v_dot2_f32_bf16 v93, v24, v24, v93
    v_dot2_f32_bf16 v94, v25, v96, v94
    v_dot2_f32_bf16 v95, v25, v25, v95
    v_dot2_f32_bf16 v92, v26, v96, v92
    v_dot2_f32_bf16 v93, v26, v26, v93
    v_dot2_f32_bf16 v94, v27, v96, v94
    v_dot2_f32_bf16 v95, v27, v27, v95
    s_waitcnt lgkmcnt(3)
    s_mov_b32 s44, 2623488
    buffer_store_dwordx4 v[60:63], v99, s[24:27], s44 offen sc1
    s_waitcnt vmcnt(8)
    ds_write_b128 v97, v[28:31] offset:512
    ds_read_b64_tr_b16 v[68:69], v98 offset:512
    ds_read_b64_tr_b16 v[70:71], v98 offset:5888
    v_dot2_f32_bf16 v92, v28, v96, v92
    v_dot2_f32_bf16 v93, v28, v28, v93
    v_dot2_f32_bf16 v94, v29, v96, v94
    v_dot2_f32_bf16 v95, v29, v29, v95
    v_dot2_f32_bf16 v92, v30, v96, v92
    v_dot2_f32_bf16 v93, v30, v30, v93
    v_dot2_f32_bf16 v94, v31, v96, v94
    v_dot2_f32_bf16 v95, v31, v31, v95
    s_waitcnt lgkmcnt(3)
    s_mov_b32 s44, 2624512
    buffer_store_dwordx4 v[64:67], v99, s[24:27], s44 offen sc1
    s_waitcnt vmcnt(8)
    ds_write_b128 v97, v[32:35] offset:640
    ds_read_b64_tr_b16 v[72:73], v98 offset:640
    ds_read_b64_tr_b16 v[74:75], v98 offset:6016
    v_dot2_f32_bf16 v92, v32, v96, v92
    v_dot2_f32_bf16 v93, v32, v32, v93
    v_dot2_f32_bf16 v94, v33, v96, v94
    v_dot2_f32_bf16 v95, v33, v33, v95
    v_dot2_f32_bf16 v92, v34, v96, v92
    v_dot2_f32_bf16 v93, v34, v34, v93
    v_dot2_f32_bf16 v94, v35, v96, v94
    v_dot2_f32_bf16 v95, v35, v35, v95
    s_waitcnt lgkmcnt(3)
    s_mov_b32 s44, 2625536
    buffer_store_dwordx4 v[68:71], v99, s[24:27], s44 offen sc1
    s_waitcnt vmcnt(8)
    ds_write_b128 v97, v[36:39] offset:768
    ds_read_b64_tr_b16 v[76:77], v98 offset:768
    ds_read_b64_tr_b16 v[78:79], v98 offset:6144
    v_dot2_f32_bf16 v92, v36, v96, v92
    v_dot2_f32_bf16 v93, v36, v36, v93
    v_dot2_f32_bf16 v94, v37, v96, v94
    v_dot2_f32_bf16 v95, v37, v37, v95
    v_dot2_f32_bf16 v92, v38, v96, v92
    v_dot2_f32_bf16 v93, v38, v38, v93
    v_dot2_f32_bf16 v94, v39, v96, v94
    v_dot2_f32_bf16 v95, v39, v39, v95
    s_waitcnt lgkmcnt(3)
    s_mov_b32 s44, 2626560
    buffer_store_dwordx4 v[72:75], v99, s[24:27], s44 offen sc1
    s_waitcnt vmcnt(8)
    ds_write_b128 v97, v[40:43] offset:896
    ds_read_b64_tr_b16 v[80:81], v98 offset:896
    ds_read_b64_tr_b16 v[82:83], v98 offset:6272
    v_dot2_f32_bf16 v92, v40, v96, v92
    v_dot2_f32_bf16 v93, v40, v40, v93
    v_dot2_f32_bf16 v94, v41, v96, v94
    v_dot2_f32_bf16 v95, v41, v41, v95
    v_dot2_f32_bf16 v92, v42, v96, v92
    v_dot2_f32_bf16 v93, v42, v42, v93
    v_dot2_f32_bf16 v94, v43, v96, v94
    v_dot2_f32_bf16 v95, v43, v43, v95
    s_waitcnt lgkmcnt(3)
    s_mov_b32 s44, 2627584
    buffer_store_dwordx4 v[76:79], v99, s[24:27], s44 offen sc1
    s_waitcnt vmcnt(8)
    ds_write_b128 v97, v[44:47] offset:1024
    ds_read_b64_tr_b16 v[84:85], v98 offset:1024
    ds_read_b64_tr_b16 v[86:87], v98 offset:6400
    v_dot2_f32_bf16 v92, v44, v96, v92
    v_dot2_f32_bf16 v93, v44, v44, v93
    v_dot2_f32_bf16 v94, v45, v96, v94
    v_dot2_f32_bf16 v95, v45, v45, v95
    v_dot2_f32_bf16 v92, v46, v96, v92
    v_dot2_f32_bf16 v93, v46, v46, v93
    v_dot2_f32_bf16 v94, v47, v96, v94
    v_dot2_f32_bf16 v95, v47, v47, v95
    s_waitcnt lgkmcnt(3)
    s_mov_b32 s44, 2628608
    buffer_store_dwordx4 v[80:83], v99, s[24:27], s44 offen sc1
    s_waitcnt vmcnt(8)
    ds_write_b128 v97, v[48:51] offset:1152
    ds_read_b64_tr_b16 v[88:89], v98 offset:1152
    ds_read_b64_tr_b16 v[90:91], v98 offset:6528
    v_dot2_f32_bf16 v92, v48, v96, v92
    v_dot2_f32_bf16 v93, v48, v48, v93
    v_dot2_f32_bf16 v94, v49, v96, v94
    v_dot2_f32_bf16 v95, v49, v49, v95
    v_dot2_f32_bf16 v92, v50, v96, v92
    v_dot2_f32_bf16 v93, v50, v50, v93
    v_dot2_f32_bf16 v94, v51, v96, v94
    v_dot2_f32_bf16 v95, v51, v51, v95
    s_waitcnt lgkmcnt(3)
    s_mov_b32 s44, 2629632
    buffer_store_dwordx4 v[84:87], v99, s[24:27], s44 offen sc1
    s_waitcnt lgkmcnt(0)
    s_mov_b32 s44, 2630656
    buffer_store_dwordx4 v[88:91], v99, s[24:27], s44 offen sc1
    v_add_f32 v92, v92, v94
    v_add_f32 v93, v93, v95
    s_nop 0
    v_add_f32_dpp v92, v92, v92 quad_perm:[1,0,3,2] row_mask:0xf bank_mask:0xf
    v_add_f32_dpp v93, v93, v93 quad_perm:[1,0,3,2] row_mask:0xf bank_mask:0xf
    s_nop 0
    v_add_f32_dpp v92, v92, v92 quad_perm:[2,3,0,1] row_mask:0xf bank_mask:0xf
    v_add_f32_dpp v93, v93, v93 quad_perm:[2,3,0,1] row_mask:0xf bank_mask:0xf
    s_nop 0
    v_add_f32_dpp v92, v92, v92 row_half_mirror row_mask:0xf bank_mask:0xf
    v_add_f32_dpp v93, v93, v93 row_half_mirror row_mask:0xf bank_mask:0xf
    v_mul_f32 v92, 0x3acccccd, v92
    v_mul_f32 v93, 0x3acccccd, v93
    v_fma_f32 v93, -v92, v92, v93
    v_max_f32 v93, 0, v93
    v_cvt_pk_bf16_f32 v93, v93, v93
    v_lshlrev_b32 v93, 16, v93
    v_add_f32 v93, 0x3727c5ac, v93
    v_cvt_pk_bf16_f32 v93, v93, v93
    v_lshlrev_b32 v93, 16, v93
    v_sqrt_f32 v93, v93
    s_nop 0
    v_cvt_pk_bf16_f32 v93, v93, v93
    v_lshlrev_b32 v93, 16, v93
    v_rcp_f32 v6, v93
    s_nop 0
    v_fma_f32 v7, -v93, v6, 1.0
    v_fma_f32 v93, v7, v6, v6
    v_cvt_pk_bf16_f32 v92, v92, v92
    v_lshlrev_b32 v92, 16, v92
    v_mov_b32 v102, v92
    v_mov_b32 v103, v93
    s_mov_b32 exec_lo, 0x01010101
    s_mov_b32 exec_hi, 0x01010101
    buffer_store_dwordx2 v[102:103], v100, s[24:27], 0 offen sc1
    s_mov_b64 exec, -1
ln_skip_sequential_preLN__ssm_conv_s4__glu_gated_swiglu__prompt_kernel_13:
    s_waitcnt vmcnt(0)
    s_barrier
    s_cmp_lg_u32 s36, 0
    s_cbranch_scc1 pub_sequential_preLN__ssm_conv_s4__glu_gated_swiglu__prompt_kernel_16
    v_mov_b32 v1, 0
    v_mov_b32 v2, 1
    s_mov_b64 exec, 1
    buffer_atomic_add v2, v1, s[32:35], 0 offen sc0
    s_waitcnt vmcnt(0)
    v_readfirstlane_b32 s45, v2
    s_nop 1
    s_cmp_lg_u32 s45, 95
    s_cbranch_scc1 notlast_sequential_preLN__ssm_conv_s4__glu_gated_swiglu__prompt_kernel_17
    v_mov_b32 v1, 128
    v_mov_b32 v2, 1
    buffer_store_dword v2, v1, s[32:35], 0 offen sc1
notlast_sequential_preLN__ssm_conv_s4__glu_gated_swiglu__prompt_kernel_17:
    s_mov_b64 exec, -1
pub_sequential_preLN__ssm_conv_s4__glu_gated_swiglu__prompt_kernel_16:
    s_add_u32 s28, s22, 19922944
    s_addc_u32 s29, s23, 0
    s_mov_b32 s30, 2211840
    s_mov_b32 s31, 0x20000
    s_mul_i32 s37, s62, 4
    s_add_u32 s37, s37, s36
    v_and_b32 v1, 63, v0
    v_add_u32 v2, 0, v1
    v_mul_u32_u24 v3, 6554, v2
    v_lshrrev_b32 v3, 16, v3
    v_mad_i32_i24 v2, v3, -10, v2
    v_lshlrev_b32 v6, 4, v2
    v_and_b32 v2, 12, v3
    v_and_b32 v4, 3, v3
    v_lshl_add_u32 v2, v2, 1, v4
    v_lshrrev_b32 v4, 4, v3
    v_lshl_add_u32 v2, v4, 2, v2
    v_mul_u32_u24 v2, 1280, v2
    v_add_u32 v6, v6, v2
    v_add_u32 v2, 64, v1
    v_mul_u32_u24 v3, 6554, v2
    v_lshrrev_b32 v3, 16, v3
    v_mad_i32_i24 v2, v3, -10, v2
    v_lshlrev_b32 v7, 4, v2
    v_and_b32 v2, 12, v3
    v_and_b32 v4, 3, v3
    v_lshl_add_u32 v2, v2, 1, v4
    v_lshrrev_b32 v4, 4, v3
    v_lshl_add_u32 v2, v4, 2, v2
    v_mul_u32_u24 v2, 1280, v2
    v_add_u32 v7, v7, v2
    v_add_u32 v2, 128, v1
    v_mul_u32_u24 v3, 6554, v2
    v_lshrrev_b32 v3, 16, v3
    v_mad_i32_i24 v2, v3, -10, v2
    v_lshlrev_b32 v8, 4, v2
    v_and_b32 v2, 12, v3
    v_and_b32 v4, 3, v3
    v_lshl_add_u32 v2, v2, 1, v4
    v_lshrrev_b32 v4, 4, v3
    v_lshl_add_u32 v2, v4, 2, v2
    v_mul_u32_u24 v2, 1280, v2
    v_add_u32 v8, v8, v2
    v_add_u32 v2, 192, v1
    v_mul_u32_u24 v3, 6554, v2
    v_lshrrev_b32 v3, 16, v3
    v_mad_i32_i24 v2, v3, -10, v2
    v_lshlrev_b32 v9, 4, v2
    v_and_b32 v2, 12, v3
    v_and_b32 v4, 3, v3
    v_lshl_add_u32 v2, v2, 1, v4
    v_lshrrev_b32 v4, 4, v3
    v_lshl_add_u32 v2, v4, 2, v2
    v_mul_u32_u24 v2, 1280, v2
    v_add_u32 v9, v9, v2
    v_add_u32 v2, 256, v1
    v_mul_u32_u24 v3, 6554, v2
    v_lshrrev_b32 v3, 16, v3
    v_mad_i32_i24 v2, v3, -10, v2
    v_lshlrev_b32 v10, 4, v2
    v_and_b32 v2, 12, v3
    v_and_b32 v4, 3, v3
    v_lshl_add_u32 v2, v2, 1, v4
    v_lshrrev_b32 v4, 4, v3
    v_lshl_add_u32 v2, v4, 2, v2
    v_mul_u32_u24 v2, 1280, v2
    v_add_u32 v10, v10, v2
    v_lshlrev_b32 v5, 4, v1
    s_mul_i32 s44, s36, 5120
    v_add_u32 v52, s44, v5
    v_bfe_u32 v2, v1, 2, 2
    v_lshrrev_b32 v3, 4, v1
    v_lshl_add_u32 v2, v3, 2, v2
    v_mul_u32_u24 v2, 160, v2
    v_and_b32 v3, 3, v1
    v_lshl_add_u32 v2, v3, 3, v2
    v_add_u32 v53, s44, v2
    s_mov_b32 s8, s60
    s_mov_b32 s9, s61
    s_mov_b32 s10, 2211840
    s_mov_b32 s11, 0x20000
    s_add_u32 s40, s37, 0
    s_mul_i32 s41, s40, 1214
    s_lshr_b32 s41, s41, 16
    s_mul_i32 s42, s41, 54
    s_sub_u32 s42, s40, s42
    s_mul_i32 s41, s41, 160
    s_mul_i32 s42, s42, 40960
    s_add_u32 s41, s41, s42
    buffer_load_dwordx4 v[12:15], v6, s[8:11], s41 offen
    buffer_load_dwordx4 v[16:19], v7, s[8:11], s41 offen
    buffer_load_dwordx4 v[20:23], v8, s[8:11], s41 offen
    buffer_load_dwordx4 v[24:27], v9, s[8:11], s41 offen
    buffer_load_dwordx4 v[28:31], v10, s[8:11], s41 offen
    s_mul_i32 s43, s40, 5120
    s_waitcnt vmcnt(4)
    ds_write_b128 v52, v[12:15] offset:0
    s_waitcnt vmcnt(3)
    ds_write_b128 v52, v[16:19] offset:1024
    s_waitcnt vmcnt(2)
    ds_write_b128 v52, v[20:23] offset:2048
    s_waitcnt vmcnt(1)
    ds_write_b128 v52, v[24:27] offset:3072
    s_waitcnt vmcnt(0)
    ds_write_b128 v52, v[28:31] offset:4096
    s_waitcnt lgkmcnt(0)
    ds_read_b64_tr_b16 v[12:13], v53 offset:0
    ds_read_b64_tr_b16 v[14:15], v53 offset:2560
    ds_read_b64_tr_b16 v[16:17], v53 offset:32
    ds_read_b64_tr_b16 v[18:19], v53 offset:2592
    ds_read_b64_tr_b16 v[20:21], v53 offset:64
    ds_read_b64_tr_b16 v[22:23], v53 offset:2624
    ds_read_b64_tr_b16 v[24:25], v53 offset:96
    ds_read_b64_tr_b16 v[26:27], v53 offset:2656
    ds_read_b64_tr_b16 v[28:29], v53 offset:128
    ds_read_b64_tr_b16 v[30:31], v53 offset:2688
    s_waitcnt lgkmcnt(8)
    buffer_store_dwordx4 v[12:15], v5, s[28:31], s43 offen offset:0 sc1
    s_waitcnt lgkmcnt(6)
    buffer_store_dwordx4 v[16:19], v5, s[28:31], s43 offen offset:1024 sc1
    s_waitcnt lgkmcnt(4)
    buffer_store_dwordx4 v[20:23], v5, s[28:31], s43 offen offset:2048 sc1
    s_waitcnt lgkmcnt(2)
    buffer_store_dwordx4 v[24:27], v5, s[28:31], s43 offen offset:3072 sc1
    s_waitcnt lgkmcnt(0)
    s_add_u32 s43, s43, 4096
    buffer_store_dwordx4 v[28:31], v5, s[28:31], s43 offen offset:0 sc1
    s_add_u32 s40, s37, 384
    s_cmp_ge_u32 s40, 432
    s_cbranch_scc1 w2last_sequential_preLN__ssm_conv_s4__glu_gated_swiglu__prompt_kernel_18
    s_mul_i32 s41, s40, 1214
    s_lshr_b32 s41, s41, 16
    s_mul_i32 s42, s41, 54
    s_sub_u32 s42, s40, s42
    s_mul_i32 s41, s41, 160
    s_mul_i32 s42, s42, 40960
    s_add_u32 s41, s41, s42
    buffer_load_dwordx4 v[32:35], v6, s[8:11], s41 offen
    buffer_load_dwordx4 v[36:39], v7, s[8:11], s41 offen
    buffer_load_dwordx4 v[40:43], v8, s[8:11], s41 offen
    buffer_load_dwordx4 v[44:47], v9, s[8:11], s41 offen
    buffer_load_dwordx4 v[48:51], v10, s[8:11], s41 offen
    s_mul_i32 s43, s40, 5120
    s_waitcnt vmcnt(4)
    ds_write_b128 v52, v[32:35] offset:0
    s_waitcnt vmcnt(3)
    ds_write_b128 v52, v[36:39] offset:1024
    s_waitcnt vmcnt(2)
    ds_write_b128 v52, v[40:43] offset:2048
    s_waitcnt vmcnt(1)
    ds_write_b128 v52, v[44:47] offset:3072
    s_waitcnt vmcnt(0)
    ds_write_b128 v52, v[48:51] offset:4096
    s_waitcnt lgkmcnt(0)
    ds_read_b64_tr_b16 v[32:33], v53 offset:0
    ds_read_b64_tr_b16 v[34:35], v53 offset:2560
    ds_read_b64_tr_b16 v[36:37], v53 offset:32
    ds_read_b64_tr_b16 v[38:39], v53 offset:2592
    ds_read_b64_tr_b16 v[40:41], v53 offset:64
    ds_read_b64_tr_b16 v[42:43], v53 offset:2624
    ds_read_b64_tr_b16 v[44:45], v53 offset:96
    ds_read_b64_tr_b16 v[46:47], v53 offset:2656
    ds_read_b64_tr_b16 v[48:49], v53 offset:128
    ds_read_b64_tr_b16 v[50:51], v53 offset:2688
    s_waitcnt lgkmcnt(8)
    buffer_store_dwordx4 v[32:35], v5, s[28:31], s43 offen offset:0 sc1
    s_waitcnt lgkmcnt(6)
    buffer_store_dwordx4 v[36:39], v5, s[28:31], s43 offen offset:1024 sc1
    s_waitcnt lgkmcnt(4)
    buffer_store_dwordx4 v[40:43], v5, s[28:31], s43 offen offset:2048 sc1
    s_waitcnt lgkmcnt(2)
    buffer_store_dwordx4 v[44:47], v5, s[28:31], s43 offen offset:3072 sc1
    s_waitcnt lgkmcnt(0)
    s_add_u32 s43, s43, 4096
    buffer_store_dwordx4 v[48:51], v5, s[28:31], s43 offen offset:0 sc1
w2last_sequential_preLN__ssm_conv_s4__glu_gated_swiglu__prompt_kernel_18:
    s_cmp_lg_u32 s36, 0
    s_cbranch_scc1 nopoll_sequential_preLN__ssm_conv_s4__glu_gated_swiglu__prompt_kernel_19
    v_mov_b32 v1, 128
    s_mov_b32 s45, 0x40000
poll_sequential_preLN__ssm_conv_s4__glu_gated_swiglu__prompt_kernel_20:
    buffer_load_dword v2, v1, s[32:35], 0 offen sc1
    s_waitcnt vmcnt(0)
    v_readfirstlane_b32 s46, v2
    s_nop 1
    s_cmp_lg_u32 s46, 0
    s_cbranch_scc1 polled_sequential_preLN__ssm_conv_s4__glu_gated_swiglu__prompt_kernel_21
    s_sleep 4
    s_sub_u32 s45, s45, 1
    s_cmp_lg_u32 s45, 0
    s_cbranch_scc1 poll_sequential_preLN__ssm_conv_s4__glu_gated_swiglu__prompt_kernel_20
polled_sequential_preLN__ssm_conv_s4__glu_gated_swiglu__prompt_kernel_21:
nopoll_sequential_preLN__ssm_conv_s4__glu_gated_swiglu__prompt_kernel_19:
    s_waitcnt vmcnt(0)
    s_barrier
    s_mov_b32 s40, 96
    s_cmp_lg_u32 s36, 0
    s_cbranch_scc1 arr_sequential_preLN__ssm_conv_s4__glu_gated_swiglu__prompt_kernel_22
    s_lshl_b32 s45, s40, 7
    v_mov_b32 v1, s45
    v_mov_b32 v2, 1
    s_mov_b64 exec, 1
    buffer_atomic_add v2, v1, s[56:59], 0 offen sc0
    s_waitcnt vmcnt(0)
    v_readfirstlane_b32 s46, v2
    s_nop 1
    s_cmp_lg_u32 s46, 95
    s_cbranch_scc1 arr_notlast_sequential_preLN__ssm_conv_s4__glu_gated_swiglu__prompt_kernel_23
    s_add_u32 s45, s45, 128
    v_mov_b32 v1, s45
    v_mov_b32 v2, 1
    buffer_store_dword v2, v1, s[56:59], 0 offen sc1
arr_notlast_sequential_preLN__ssm_conv_s4__glu_gated_swiglu__prompt_kernel_23:
    s_mov_b64 exec, -1
arr_sequential_preLN__ssm_conv_s4__glu_gated_swiglu__prompt_kernel_22:
    s_branch ffn_sequential_preLN__ssm_conv_s4__glu_gated_swiglu__prompt_kernel_2
conv_sequential_preLN__ssm_conv_s4__glu_gated_swiglu__prompt_kernel_3:
    s_load_dwordx4 s[4:7], s[0:1], 80
    s_mov_b32 s22, s50
    s_mov_b32 s23, s51
    s_mov_b32 s24, s22
    s_mov_b32 s25, s23
    s_mov_b32 s26, 5242880
    s_mov_b32 s27, 0x20000
    s_add_u32 s28, s22, 5242880
    s_addc_u32 s29, s23, 0
    s_mov_b32 s30, 2621440
    s_mov_b32 s31, 0x20000
    s_mov_b32 s32, s48
    s_mov_b32 s33, s49
    s_mov_b32 s34, 256
    s_mov_b32 s35, 0x20000
    s_add_u32 s48, s22, 15335424
    s_addc_u32 s49, s23, 0
    s_mov_b32 s50, 4587520
    s_mov_b32 s51, 0x20000
    s_add_u32 s52, s22, 14942208
    s_addc_u32 s53, s23, 0
    s_mov_b32 s54, 114688
    s_mov_b32 s55, 0x20000
    s_mul_i32 s38, s36, 38432
    v_and_b32 v1, 63, v0
    v_and_b32 v2, 15, v1
    v_lshrrev_b32 v3, 4, v1
    v_bfe_u32 v5, v1, 1, 2
    v_lshl_add_u32 v6, v1, 6, s38
    v_xor_b32 v7, 0, v5
    v_lshl_add_u32 v10, v7, 4, v6
    v_xor_b32 v7, 1, v5
    v_lshl_add_u32 v11, v7, 4, v6
    v_xor_b32 v7, 2, v5
    v_lshl_add_u32 v12, v7, 4, v6
    v_xor_b32 v7, 3, v5
    v_lshl_add_u32 v13, v7, 4, v6
    v_bfe_u32 v4, v1, 2, 2
    v_lshrrev_b32 v5, 1, v3
    v_lshl_add_u32 v5, v5, 3, v4
    v_lshl_add_u32 v5, v5, 6, s38
    v_and_b32 v6, 1, v1
    v_lshl_add_u32 v5, v6, 3, v5
    v_and_b32 v6, 1, v3
    v_bfe_u32 v7, v1, 1, 1
    v_lshl_add_u32 v6, v6, 1, v7
    v_lshrrev_b32 v4, 1, v4
    v_add_u32 v7, 0, v4
    v_xor_b32 v7, v7, v6
    v_lshl_add_u32 v7, v7, 4, v5
    v_add_u32 v14, 0, v7
    v_add_u32 v7, 2, v4
    v_xor_b32 v7, v7, v6
    v_lshl_add_u32 v7, v7, 4, v5
    v_add_u32 v15, 256, v7
    s_waitcnt lgkmcnt(0)
    s_and_b32 s40, s37, 1
    s_lshl_b32 s40, s40, 4
    s_lshr_b32 s42, s56, s40
    s_lshl_b32 s42, s42, 16
    s_lshr_b32 s43, s57, s40
    s_lshl_b32 s43, s43, 16
    v_mov_b32 v7, s42
    v_mov_b32 v9, s43
    v_mul_f32 v4, 0x3fb8aa3b, v7
    v_mov_b32 v6, 0x3fb8aa3b
    v_fma_f32 v5, v7, v6, -v4
    v_mov_b32 v6, 0x32a57060
    v_fmac_f32 v5, v7, v6
    v_exp_f32 v4, v4
    v_mul_f32 v5, 0x3f317218, v5
    v_fma_f32 v4, v4, v5, v4
    v_cvt_pk_bf16_f32 v4, v4, v4
    v_lshlrev_b32 v8, 16, v4
    s_waitcnt vmcnt(0)
    s_mul_i32 s40, s37, 3456
    v_and_b32 v247, 63, v0
    v_lshl_add_u32 v247, v247, 4, s40
    s_mov_b32 s72, s4
    s_mov_b32 s73, s5
    s_mov_b32 s74, 2211840
    s_mov_b32 s75, 0x20000
    buffer_load_dwordx4 v[248:251], v247, s[72:75], 0 offen offset:0
    buffer_load_dwordx4 v[248:251], v247, s[72:75], 0 offen offset:1024
    buffer_load_dwordx4 v[248:251], v247, s[72:75], 0 offen offset:2048
    buffer_load_dwordx4 v[248:251], v247, s[72:75], 0 offen offset:2432
    s_mov_b32 s72, s6
    s_mov_b32 s73, s7
    s_mov_b32 s74, 2211840
    s_mov_b32 s75, 0x20000
    buffer_load_dwordx4 v[248:251], v247, s[72:75], 0 offen offset:0
    buffer_load_dwordx4 v[248:251], v247, s[72:75], 0 offen offset:1024
    buffer_load_dwordx4 v[248:251], v247, s[72:75], 0 offen offset:2048
    buffer_load_dwordx4 v[248:251], v247, s[72:75], 0 offen offset:2432
    v_lshlrev_b32 v16, 16, v240
    v_lshlrev_b32 v17, 16, v241
    v_mul_f32 v16, v8, v16
    v_mul_f32 v17, v8, v17
    v_mul_f32 v24, 0x3fb8aa3b, v16
    v_mul_f32 v26, 0.15915494, v17
    v_lshlrev_b32 v16, 16, v242
    v_lshlrev_b32 v17, 16, v243
    v_mul_f32 v16, v8, v16
    v_mul_f32 v17, v8, v17
    v_lshlrev_b32 v18, 16, v244
    v_lshlrev_b32 v19, 16, v245
    v_pk_mul_f32 v[20:21], v[18:19], v[16:17] op_sel:[0,0] op_sel_hi:[0,1]
    v_pk_fma_f32 v[28:29], v[18:19], v[16:17], v[20:21] op_sel:[1,1,0] op_sel_hi:[1,0,1] neg_lo:[1,0,0]
    v_and_b32 v16, 0xffff0000, v240
    v_and_b32 v17, 0xffff0000, v241
    v_mul_f32 v16, v8, v16
    v_mul_f32 v17, v8, v17
    v_mul_f32 v25, 0x3fb8aa3b, v16
    v_mul_f32 v27, 0.15915494, v17
    v_and_b32 v16, 0xffff0000, v242
    v_and_b32 v17, 0xffff0000, v243
    v_mul_f32 v16, v8, v16
    v_mul_f32 v17, v8, v17
    v_and_b32 v18, 0xffff0000, v244
    v_and_b32 v19, 0xffff0000, v245
    v_pk_mul_f32 v[20:21], v[18:19], v[16:17] op_sel:[0,0] op_sel_hi:[0,1]
    v_pk_fma_f32 v[30:31], v[18:19], v[16:17], v[20:21] op_sel:[1,1,0] op_sel_hi:[1,0,1] neg_lo:[1,0,0]
    v_mul_f32 v16, 0x3f800000, v24
    v_mul_f32 v17, 0x3f800000, v26
    v_exp_f32 v16, v16
    v_fract_f32 v17, v17
    v_cos_f32 v32, v17
    v_sin_f32 v33, v17
    s_nop 0
    v_pk_mul_f32 v[32:33], v[32:33], v[16:17] op_sel:[0,0] op_sel_hi:[1,0]
    v_mul_f32 v18, 0x3f800000, v25
    v_mul_f32 v19, 0x3f800000, v27
    v_exp_f32 v18, v18
    v_fract_f32 v19, v19
    v_cos_f32 v34, v19
    v_sin_f32 v35, v19
    s_nop 0
    v_pk_mul_f32 v[34:35], v[34:35], v[18:19] op_sel:[0,0] op_sel_hi:[1,0]
    v_mul_f32 v16, 0x41000000, v24
    v_mul_f32 v17, 0x41000000, v26
    v_exp_f32 v16, v16
    v_fract_f32 v17, v17
    v_cos_f32 v36, v17
    v_sin_f32 v37, v17
    s_nop 0
    v_pk_mul_f32 v[36:37], v[36:37], v[16:17] op_sel:[0,0] op_sel_hi:[1,0]
    v_mul_f32 v18, 0x41000000, v25
    v_mul_f32 v19, 0x41000000, v27
    v_exp_f32 v18, v18
    v_fract_f32 v19, v19
    v_cos_f32 v38, v19
    v_sin_f32 v39, v19
    s_nop 0
    v_pk_mul_f32 v[38:39], v[38:39], v[18:19] op_sel:[0,0] op_sel_hi:[1,0]
    v_mul_f32 v16, 0x43800000, v24
    v_mul_f32 v17, 0x43800000, v26
    v_exp_f32 v16, v16
    v_fract_f32 v17, v17
    v_cos_f32 v44, v17
    v_sin_f32 v45, v17
    s_nop 0
    v_pk_mul_f32 v[44:45], v[44:45], v[16:17] op_sel:[0,0] op_sel_hi:[1,0]
    v_mul_f32 v18, 0x43800000, v25
    v_mul_f32 v19, 0x43800000, v27
    v_exp_f32 v18, v18
    v_fract_f32 v19, v19
    v_cos_f32 v46, v19
    v_sin_f32 v47, v19
    s_nop 0
    v_pk_mul_f32 v[46:47], v[46:47], v[18:19] op_sel:[0,0] op_sel_hi:[1,0]
    v_mov_b32 v56, 1.0
    v_mov_b32 v57, 0
    v_mov_b32 v60, v36
    v_mov_b32 v61, v37
    v_mov_b32 v58, 1.0
    v_mov_b32 v59, 0
    v_mov_b32 v62, v38
    v_mov_b32 v63, v39
    v_pk_mul_f32 v[16:17], v[60:61], v[60:61] op_sel:[0,0] op_sel_hi:[0,1]
    v_pk_mul_f32 v[18:19], v[62:63], v[62:63] op_sel:[0,0] op_sel_hi:[0,1]
    v_pk_fma_f32 v[64:65], v[60:61], v[60:61], v[16:17] op_sel:[1,1,0] op_sel_hi:[1,0,1] neg_lo:[1,0,0]
    v_pk_fma_f32 v[66:67], v[62:63], v[62:63], v[18:19] op_sel:[1,1,0] op_sel_hi:[1,0,1] neg_lo:[1,0,0]
    v_pk_mul_f32 v[20:21], v[64:65], v[60:61] op_sel:[0,0] op_sel_hi:[0,1]
    v_pk_mul_f32 v[22:23], v[66:67], v[62:63] op_sel:[0,0] op_sel_hi:[0,1]
    v_pk_fma_f32 v[68:69], v[64:65], v[60:61], v[20:21] op_sel:[1,1,0] op_sel_hi:[1,0,1] neg_lo:[1,0,0]
    v_pk_fma_f32 v[70:71], v[66:67], v[62:63], v[22:23] op_sel:[1,1,0] op_sel_hi:[1,0,1] neg_lo:[1,0,0]
    v_pk_mul_f32 v[16:17], v[64:65], v[64:65] op_sel:[0,0] op_sel_hi:[0,1]
    v_pk_mul_f32 v[18:19], v[66:67], v[66:67] op_sel:[0,0] op_sel_hi:[0,1]
    v_pk_fma_f32 v[72:73], v[64:65], v[64:65], v[16:17] op_sel:[1,1,0] op_sel_hi:[1,0,1] neg_lo:[1,0,0]
    v_pk_fma_f32 v[74:75], v[66:67], v[66:67], v[18:19] op_sel:[1,1,0] op_sel_hi:[1,0,1] neg_lo:[1,0,0]
    v_pk_mul_f32 v[20:21], v[72:73], v[60:61] op_sel:[0,0] op_sel_hi:[0,1]
    v_pk_mul_f32 v[22:23], v[74:75], v[62:63] op_sel:[0,0] op_sel_hi:[0,1]
    v_pk_fma_f32 v[76:77], v[72:73], v[60:61], v[20:21] op_sel:[1,1,0] op_sel_hi:[1,0,1] neg_lo:[1,0,0]
    v_pk_fma_f32 v[78:79], v[74:75], v[62:63], v[22:23] op_sel:[1,1,0] op_sel_hi:[1,0,1] neg_lo:[1,0,0]
    v_pk_mul_f32 v[16:17], v[72:73], v[64:65] op_sel:[0,0] op_sel_hi:[0,1]
    v_pk_mul_f32 v[18:19], v[74:75], v[66:67] op_sel:[0,0] op_sel_hi:[0,1]
    v_pk_fma_f32 v[80:81], v[72:73], v[64:65], v[16:17] op_sel:[1,1,0] op_sel_hi:[1,0,1] neg_lo:[1,0,0]
    v_pk_fma_f32 v[82:83], v[74:75], v[66:67], v[18:19] op_sel:[1,1,0] op_sel_hi:[1,0,1] neg_lo:[1,0,0]
    v_pk_mul_f32 v[20:21], v[72:73], v[68:69] op_sel:[0,0] op_sel_hi:[0,1]
    v_pk_mul_f32 v[22:23], v[74:75], v[70:71] op_sel:[0,0] op_sel_hi:[0,1]
    v_pk_fma_f32 v[84:85], v[72:73], v[68:69], v[20:21] op_sel:[1,1,0] op_sel_hi:[1,0,1] neg_lo:[1,0,0]
    v_pk_fma_f32 v[86:87], v[74:75], v[70:71], v[22:23] op_sel:[1,1,0] op_sel_hi:[1,0,1] neg_lo:[1,0,0]
    v_pk_mul_f32 v[16:17], v[72:73], v[72:73] op_sel:[0,0] op_sel_hi:[0,1]
    v_pk_mul_f32 v[18:19], v[74:75], v[74:75] op_sel:[0,0] op_sel_hi:[0,1]
    v_pk_fma_f32 v[40:41], v[72:73], v[72:73], v[16:17] op_sel:[1,1,0] op_sel_hi:[1,0,1] neg_lo:[1,0,0]
    v_pk_fma_f32 v[42:43], v[74:75], v[74:75], v[18:19] op_sel:[1,1,0] op_sel_hi:[1,0,1] neg_lo:[1,0,0]
    v_cvt_pk_bf16_f32 v192, v56, v60
    v_cvt_pk_bf16_f32 v193, v64, v68
    v_cvt_pk_bf16_f32 v194, v72, v76
    v_cvt_pk_bf16_f32 v195, v80, v84
    ds_write_b128 v10, v[192:195] offset:16384
    v_cvt_pk_bf16_f32 v196, v57, v61
    v_cvt_pk_bf16_f32 v197, v65, v69
    v_cvt_pk_bf16_f32 v198, v73, v77
    v_cvt_pk_bf16_f32 v199, v81, v85
    ds_write_b128 v10, v[196:199] offset:20480
    v_cvt_pk_bf16_f32 v200, v58, v62
    v_cvt_pk_bf16_f32 v201, v66, v70
    v_cvt_pk_bf16_f32 v202, v74, v78
    v_cvt_pk_bf16_f32 v203, v82, v86
    ds_write_b128 v10, v[200:203] offset:24576
    v_cvt_pk_bf16_f32 v204, v59, v63
    v_cvt_pk_bf16_f32 v205, v67, v71
    v_cvt_pk_bf16_f32 v206, v75, v79
    v_cvt_pk_bf16_f32 v207, v83, v87
    ds_write_b128 v10, v[204:207] offset:28672
    v_pk_mul_f32 v[20:21], v[56:57], v[40:41] op_sel:[0,0] op_sel_hi:[0,1]
    v_pk_mul_f32 v[22:23], v[58:59], v[42:43] op_sel:[0,0] op_sel_hi:[0,1]
    v_pk_fma_f32 v[56:57], v[56:57], v[40:41], v[20:21] op_sel:[1,1,0] op_sel_hi:[1,0,1] neg_lo:[1,0,0]
    v_pk_fma_f32 v[58:59], v[58:59], v[42:43], v[22:23] op_sel:[1,1,0] op_sel_hi:[1,0,1] neg_lo:[1,0,0]
    v_pk_mul_f32 v[16:17], v[60:61], v[40:41] op_sel:[0,0] op_sel_hi:[0,1]
    v_pk_mul_f32 v[18:19], v[62:63], v[42:43] op_sel:[0,0] op_sel_hi:[0,1]
    v_pk_fma_f32 v[60:61], v[60:61], v[40:41], v[16:17] op_sel:[1,1,0] op_sel_hi:[1,0,1] neg_lo:[1,0,0]
    v_pk_fma_f32 v[62:63], v[62:63], v[42:43], v[18:19] op_sel:[1,1,0] op_sel_hi:[1,0,1] neg_lo:[1,0,0]
    v_pk_mul_f32 v[20:21], v[64:65], v[40:41] op_sel:[0,0] op_sel_hi:[0,1]
    v_pk_mul_f32 v[22:23], v[66:67], v[42:43] op_sel:[0,0] op_sel_hi:[0,1]
    v_pk_fma_f32 v[64:65], v[64:65], v[40:41], v[20:21] op_sel:[1,1,0] op_sel_hi:[1,0,1] neg_lo:[1,0,0]
    v_pk_fma_f32 v[66:67], v[66:67], v[42:43], v[22:23] op_sel:[1,1,0] op_sel_hi:[1,0,1] neg_lo:[1,0,0]
    v_pk_mul_f32 v[16:17], v[68:69], v[40:41] op_sel:[0,0] op_sel_hi:[0,1]
    v_pk_mul_f32 v[18:19], v[70:71], v[42:43] op_sel:[0,0] op_sel_hi:[0,1]
    v_pk_fma_f32 v[68:69], v[68:69], v[40:41], v[16:17] op_sel:[1,1,0] op_sel_hi:[1,0,1] neg_lo:[1,0,0]
    v_pk_fma_f32 v[70:71], v[70:71], v[42:43], v[18:19] op_sel:[1,1,0] op_sel_hi:[1,0,1] neg_lo:[1,0,0]
    v_pk_mul_f32 v[20:21], v[72:73], v[40:41] op_sel:[0,0] op_sel_hi:[0,1]
    v_pk_mul_f32 v[22:23], v[74:75], v[42:43] op_sel:[0,0] op_sel_hi:[0,1]
    v_pk_fma_f32 v[72:73], v[72:73], v[40:41], v[20:21] op_sel:[1,1,0] op_sel_hi:[1,0,1] neg_lo:[1,0,0]
    v_pk_fma_f32 v[74:75], v[74:75], v[42:43], v[22:23] op_sel:[1,1,0] op_sel_hi:[1,0,1] neg_lo:[1,0,0]
    v_pk_mul_f32 v[16:17], v[76:77], v[40:41] op_sel:[0,0] op_sel_hi:[0,1]
    v_pk_mul_f32 v[18:19], v[78:79], v[42:43] op_sel:[0,0] op_sel_hi:[0,1]
    v_pk_fma_f32 v[76:77], v[76:77], v[40:41], v[16:17] op_sel:[1,1,0] op_sel_hi:[1,0,1] neg_lo:[1,0,0]
    v_pk_fma_f32 v[78:79], v[78:79], v[42:43], v[18:19] op_sel:[1,1,0] op_sel_hi:[1,0,1] neg_lo:[1,0,0]
    v_pk_mul_f32 v[20:21], v[80:81], v[40:41] op_sel:[0,0] op_sel_hi:[0,1]
    v_pk_mul_f32 v[22:23], v[82:83], v[42:43] op_sel:[0,0] op_sel_hi:[0,1]
    v_pk_fma_f32 v[80:81], v[80:81], v[40:41], v[20:21] op_sel:[1,1,0] op_sel_hi:[1,0,1] neg_lo:[1,0,0]
    v_pk_fma_f32 v[82:83], v[82:83], v[42:43], v[22:23] op_sel:[1,1,0] op_sel_hi:[1,0,1] neg_lo:[1,0,0]
    v_pk_mul_f32 v[16:17], v[84:85], v[40:41] op_sel:[0,0] op_sel_hi:[0,1]
    v_pk_mul_f32 v[18:19], v[86:87], v[42:43] op_sel:[0,0] op_sel_hi:[0,1]
    v_pk_fma_f32 v[84:85], v[84:85], v[40:41], v[16:17] op_sel:[1,1,0] op_sel_hi:[1,0,1] neg_lo:[1,0,0]
    v_pk_fma_f32 v[86:87], v[86:87], v[42:43], v[18:19] op_sel:[1,1,0] op_sel_hi:[1,0,1] neg_lo:[1,0,0]
    v_cvt_pk_bf16_f32 v192, v56, v60
    v_cvt_pk_bf16_f32 v193, v64, v68
    v_cvt_pk_bf16_f32 v194, v72, v76
    v_cvt_pk_bf16_f32 v195, v80, v84
    ds_write_b128 v11, v[192:195] offset:16384
    v_cvt_pk_bf16_f32 v196, v57, v61
    v_cvt_pk_bf16_f32 v197, v65, v69
    v_cvt_pk_bf16_f32 v198, v73, v77
    v_cvt_pk_bf16_f32 v199, v81, v85
    ds_write_b128 v11, v[196:199] offset:20480
    v_cvt_pk_bf16_f32 v200, v58, v62
    v_cvt_pk_bf16_f32 v201, v66, v70
    v_cvt_pk_bf16_f32 v202, v74, v78
    v_cvt_pk_bf16_f32 v203, v82, v86
    ds_write_b128 v11, v[200:203] offset:24576
    v_cvt_pk_bf16_f32 v204, v59, v63
    v_cvt_pk_bf16_f32 v205, v67, v71
    v_cvt_pk_bf16_f32 v206, v75, v79
    v_cvt_pk_bf16_f32 v207, v83, v87
    ds_write_b128 v11, v[204:207] offset:28672
    v_pk_mul_f32 v[20:21], v[56:57], v[40:41] op_sel:[0,0] op_sel_hi:[0,1]
    v_pk_mul_f32 v[22:23], v[58:59], v[42:43] op_sel:[0,0] op_sel_hi:[0,1]
    v_pk_fma_f32 v[56:57], v[56:57], v[40:41], v[20:21] op_sel:[1,1,0] op_sel_hi:[1,0,1] neg_lo:[1,0,0]
    v_pk_fma_f32 v[58:59], v[58:59], v[42:43], v[22:23] op_sel:[1,1,0] op_sel_hi:[1,0,1] neg_lo:[1,0,0]
    v_pk_mul_f32 v[16:17], v[60:61], v[40:41] op_sel:[0,0] op_sel_hi:[0,1]
    v_pk_mul_f32 v[18:19], v[62:63], v[42:43] op_sel:[0,0] op_sel_hi:[0,1]
    v_pk_fma_f32 v[60:61], v[60:61], v[40:41], v[16:17] op_sel:[1,1,0] op_sel_hi:[1,0,1] neg_lo:[1,0,0]
    v_pk_fma_f32 v[62:63], v[62:63], v[42:43], v[18:19] op_sel:[1,1,0] op_sel_hi:[1,0,1] neg_lo:[1,0,0]
    v_pk_mul_f32 v[20:21], v[64:65], v[40:41] op_sel:[0,0] op_sel_hi:[0,1]
    v_pk_mul_f32 v[22:23], v[66:67], v[42:43] op_sel:[0,0] op_sel_hi:[0,1]
    v_pk_fma_f32 v[64:65], v[64:65], v[40:41], v[20:21] op_sel:[1,1,0] op_sel_hi:[1,0,1] neg_lo:[1,0,0]
    v_pk_fma_f32 v[66:67], v[66:67], v[42:43], v[22:23] op_sel:[1,1,0] op_sel_hi:[1,0,1] neg_lo:[1,0,0]
    v_pk_mul_f32 v[16:17], v[68:69], v[40:41] op_sel:[0,0] op_sel_hi:[0,1]
    v_pk_mul_f32 v[18:19], v[70:71], v[42:43] op_sel:[0,0] op_sel_hi:[0,1]
    v_pk_fma_f32 v[68:69], v[68:69], v[40:41], v[16:17] op_sel:[1,1,0] op_sel_hi:[1,0,1] neg_lo:[1,0,0]
    v_pk_fma_f32 v[70:71], v[70:71], v[42:43], v[18:19] op_sel:[1,1,0] op_sel_hi:[1,0,1] neg_lo:[1,0,0]
    v_pk_mul_f32 v[20:21], v[72:73], v[40:41] op_sel:[0,0] op_sel_hi:[0,1]
    v_pk_mul_f32 v[22:23], v[74:75], v[42:43] op_sel:[0,0] op_sel_hi:[0,1]
    v_pk_fma_f32 v[72:73], v[72:73], v[40:41], v[20:21] op_sel:[1,1,0] op_sel_hi:[1,0,1] neg_lo:[1,0,0]
    v_pk_fma_f32 v[74:75], v[74:75], v[42:43], v[22:23] op_sel:[1,1,0] op_sel_hi:[1,0,1] neg_lo:[1,0,0]
    v_pk_mul_f32 v[16:17], v[76:77], v[40:41] op_sel:[0,0] op_sel_hi:[0,1]
    v_pk_mul_f32 v[18:19], v[78:79], v[42:43] op_sel:[0,0] op_sel_hi:[0,1]
    v_pk_fma_f32 v[76:77], v[76:77], v[40:41], v[16:17] op_sel:[1,1,0] op_sel_hi:[1,0,1] neg_lo:[1,0,0]
    v_pk_fma_f32 v[78:79], v[78:79], v[42:43], v[18:19] op_sel:[1,1,0] op_sel_hi:[1,0,1] neg_lo:[1,0,0]
    v_pk_mul_f32 v[20:21], v[80:81], v[40:41] op_sel:[0,0] op_sel_hi:[0,1]
    v_pk_mul_f32 v[22:23], v[82:83], v[42:43] op_sel:[0,0] op_sel_hi:[0,1]
    v_pk_fma_f32 v[80:81], v[80:81], v[40:41], v[20:21] op_sel:[1,1,0] op_sel_hi:[1,0,1] neg_lo:[1,0,0]
    v_pk_fma_f32 v[82:83], v[82:83], v[42:43], v[22:23] op_sel:[1,1,0] op_sel_hi:[1,0,1] neg_lo:[1,0,0]
    v_pk_mul_f32 v[16:17], v[84:85], v[40:41] op_sel:[0,0] op_sel_hi:[0,1]
    v_pk_mul_f32 v[18:19], v[86:87], v[42:43] op_sel:[0,0] op_sel_hi:[0,1]
    v_pk_fma_f32 v[84:85], v[84:85], v[40:41], v[16:17] op_sel:[1,1,0] op_sel_hi:[1,0,1] neg_lo:[1,0,0]
    v_pk_fma_f32 v[86:87], v[86:87], v[42:43], v[18:19] op_sel:[1,1,0] op_sel_hi:[1,0,1] neg_lo:[1,0,0]
    v_cvt_pk_bf16_f32 v192, v56, v60
    v_cvt_pk_bf16_f32 v193, v64, v68
    v_cvt_pk_bf16_f32 v194, v72, v76
    v_cvt_pk_bf16_f32 v195, v80, v84
    ds_write_b128 v12, v[192:195] offset:16384
    v_cvt_pk_bf16_f32 v196, v57, v61
    v_cvt_pk_bf16_f32 v197, v65, v69
    v_cvt_pk_bf16_f32 v198, v73, v77
    v_cvt_pk_bf16_f32 v199, v81, v85
    ds_write_b128 v12, v[196:199] offset:20480
    v_cvt_pk_bf16_f32 v200, v58, v62
    v_cvt_pk_bf16_f32 v201, v66, v70
    v_cvt_pk_bf16_f32 v202, v74, v78
    v_cvt_pk_bf16_f32 v203, v82, v86
    ds_write_b128 v12, v[200:203] offset:24576
    v_cvt_pk_bf16_f32 v204, v59, v63
    v_cvt_pk_bf16_f32 v205, v67, v71
    v_cvt_pk_bf16_f32 v206, v75, v79
    v_cvt_pk_bf16_f32 v207, v83, v87
    ds_write_b128 v12, v[204:207] offset:28672
    v_pk_mul_f32 v[20:21], v[56:57], v[40:41] op_sel:[0,0] op_sel_hi:[0,1]
    v_pk_mul_f32 v[22:23], v[58:59], v[42:43] op_sel:[0,0] op_sel_hi:[0,1]
    v_pk_fma_f32 v[56:57], v[56:57], v[40:41], v[20:21] op_sel:[1,1,0] op_sel_hi:[1,0,1] neg_lo:[1,0,0]
    v_pk_fma_f32 v[58:59], v[58:59], v[42:43], v[22:23] op_sel:[1,1,0] op_sel_hi:[1,0,1] neg_lo:[1,0,0]
    v_pk_mul_f32 v[16:17], v[60:61], v[40:41] op_sel:[0,0] op_sel_hi:[0,1]
    v_pk_mul_f32 v[18:19], v[62:63], v[42:43] op_sel:[0,0] op_sel_hi:[0,1]
    v_pk_fma_f32 v[60:61], v[60:61], v[40:41], v[16:17] op_sel:[1,1,0] op_sel_hi:[1,0,1] neg_lo:[1,0,0]
    v_pk_fma_f32 v[62:63], v[62:63], v[42:43], v[18:19] op_sel:[1,1,0] op_sel_hi:[1,0,1] neg_lo:[1,0,0]
    v_pk_mul_f32 v[20:21], v[64:65], v[40:41] op_sel:[0,0] op_sel_hi:[0,1]
    v_pk_mul_f32 v[22:23], v[66:67], v[42:43] op_sel:[0,0] op_sel_hi:[0,1]
    v_pk_fma_f32 v[64:65], v[64:65], v[40:41], v[20:21] op_sel:[1,1,0] op_sel_hi:[1,0,1] neg_lo:[1,0,0]
    v_pk_fma_f32 v[66:67], v[66:67], v[42:43], v[22:23] op_sel:[1,1,0] op_sel_hi:[1,0,1] neg_lo:[1,0,0]
    v_pk_mul_f32 v[16:17], v[68:69], v[40:41] op_sel:[0,0] op_sel_hi:[0,1]
    v_pk_mul_f32 v[18:19], v[70:71], v[42:43] op_sel:[0,0] op_sel_hi:[0,1]
    v_pk_fma_f32 v[68:69], v[68:69], v[40:41], v[16:17] op_sel:[1,1,0] op_sel_hi:[1,0,1] neg_lo:[1,0,0]
    v_pk_fma_f32 v[70:71], v[70:71], v[42:43], v[18:19] op_sel:[1,1,0] op_sel_hi:[1,0,1] neg_lo:[1,0,0]
    v_pk_mul_f32 v[20:21], v[72:73], v[40:41] op_sel:[0,0] op_sel_hi:[0,1]
    v_pk_mul_f32 v[22:23], v[74:75], v[42:43] op_sel:[0,0] op_sel_hi:[0,1]
    v_pk_fma_f32 v[72:73], v[72:73], v[40:41], v[20:21] op_sel:[1,1,0] op_sel_hi:[1,0,1] neg_lo:[1,0,0]
    v_pk_fma_f32 v[74:75], v[74:75], v[42:43], v[22:23] op_sel:[1,1,0] op_sel_hi:[1,0,1] neg_lo:[1,0,0]
    v_pk_mul_f32 v[16:17], v[76:77], v[40:41] op_sel:[0,0] op_sel_hi:[0,1]
    v_pk_mul_f32 v[18:19], v[78:79], v[42:43] op_sel:[0,0] op_sel_hi:[0,1]
    v_pk_fma_f32 v[76:77], v[76:77], v[40:41], v[16:17] op_sel:[1,1,0] op_sel_hi:[1,0,1] neg_lo:[1,0,0]
    v_pk_fma_f32 v[78:79], v[78:79], v[42:43], v[18:19] op_sel:[1,1,0] op_sel_hi:[1,0,1] neg_lo:[1,0,0]
    v_pk_mul_f32 v[20:21], v[80:81], v[40:41] op_sel:[0,0] op_sel_hi:[0,1]
    v_pk_mul_f32 v[22:23], v[82:83], v[42:43] op_sel:[0,0] op_sel_hi:[0,1]
    v_pk_fma_f32 v[80:81], v[80:81], v[40:41], v[20:21] op_sel:[1,1,0] op_sel_hi:[1,0,1] neg_lo:[1,0,0]
    v_pk_fma_f32 v[82:83], v[82:83], v[42:43], v[22:23] op_sel:[1,1,0] op_sel_hi:[1,0,1] neg_lo:[1,0,0]
    v_pk_mul_f32 v[16:17], v[84:85], v[40:41] op_sel:[0,0] op_sel_hi:[0,1]
    v_pk_mul_f32 v[18:19], v[86:87], v[42:43] op_sel:[0,0] op_sel_hi:[0,1]
    v_pk_fma_f32 v[84:85], v[84:85], v[40:41], v[16:17] op_sel:[1,1,0] op_sel_hi:[1,0,1] neg_lo:[1,0,0]
    v_pk_fma_f32 v[86:87], v[86:87], v[42:43], v[18:19] op_sel:[1,1,0] op_sel_hi:[1,0,1] neg_lo:[1,0,0]
    v_cvt_pk_bf16_f32 v192, v56, v60
    v_cvt_pk_bf16_f32 v193, v64, v68
    v_cvt_pk_bf16_f32 v194, v72, v76
    v_cvt_pk_bf16_f32 v195, v80, v84
    ds_write_b128 v13, v[192:195] offset:16384
    v_cvt_pk_bf16_f32 v196, v57, v61
    v_cvt_pk_bf16_f32 v197, v65, v69
    v_cvt_pk_bf16_f32 v198, v73, v77
    v_cvt_pk_bf16_f32 v199, v81, v85
    ds_write_b128 v13, v[196:199] offset:20480
    v_cvt_pk_bf16_f32 v200, v58, v62
    v_cvt_pk_bf16_f32 v201, v66, v70
    v_cvt_pk_bf16_f32 v202, v74, v78
    v_cvt_pk_bf16_f32 v203, v82, v86
    ds_write_b128 v13, v[200:203] offset:24576
    v_cvt_pk_bf16_f32 v204, v59, v63
    v_cvt_pk_bf16_f32 v205, v67, v71
    v_cvt_pk_bf16_f32 v206, v75, v79
    v_cvt_pk_bf16_f32 v207, v83, v87
    ds_write_b128 v13, v[204:207] offset:28672
    v_pk_mul_f32 v[20:21], v[28:29], v[32:33] op_sel:[0,0] op_sel_hi:[0,1]
    v_pk_mul_f32 v[22:23], v[30:31], v[34:35] op_sel:[0,0] op_sel_hi:[0,1]
    v_pk_fma_f32 v[88:89], v[28:29], v[32:33], v[20:21] op_sel:[1,1,0] op_sel_hi:[1,0,1] neg_lo:[1,0,0]
    v_pk_fma_f32 v[90:91], v[30:31], v[34:35], v[22:23] op_sel:[1,1,0] op_sel_hi:[1,0,1] neg_lo:[1,0,0]
    v_pk_mul_f32 v[16:17], v[88:89], v[32:33] op_sel:[0,0] op_sel_hi:[0,1]
    v_pk_mul_f32 v[18:19], v[90:91], v[34:35] op_sel:[0,0] op_sel_hi:[0,1]
    v_pk_fma_f32 v[92:93], v[88:89], v[32:33], v[16:17] op_sel:[1,1,0] op_sel_hi:[1,0,1] neg_lo:[1,0,0]
    v_pk_fma_f32 v[94:95], v[90:91], v[34:35], v[18:19] op_sel:[1,1,0] op_sel_hi:[1,0,1] neg_lo:[1,0,0]
    v_pk_mul_f32 v[20:21], v[92:93], v[32:33] op_sel:[0,0] op_sel_hi:[0,1]
    v_pk_mul_f32 v[22:23], v[94:95], v[34:35] op_sel:[0,0] op_sel_hi:[0,1]
    v_pk_fma_f32 v[96:97], v[92:93], v[32:33], v[20:21] op_sel:[1,1,0] op_sel_hi:[1,0,1] neg_lo:[1,0,0]
    v_pk_fma_f32 v[98:99], v[94:95], v[34:35], v[22:23] op_sel:[1,1,0] op_sel_hi:[1,0,1] neg_lo:[1,0,0]
    v_pk_mul_f32 v[16:17], v[96:97], v[32:33] op_sel:[0,0] op_sel_hi:[0,1]
    v_pk_mul_f32 v[18:19], v[98:99], v[34:35] op_sel:[0,0] op_sel_hi:[0,1]
    v_pk_fma_f32 v[100:101], v[96:97], v[32:33], v[16:17] op_sel:[1,1,0] op_sel_hi:[1,0,1] neg_lo:[1,0,0]
    v_pk_fma_f32 v[102:103], v[98:99], v[34:35], v[18:19] op_sel:[1,1,0] op_sel_hi:[1,0,1] neg_lo:[1,0,0]
    v_pk_mul_f32 v[20:21], v[100:101], v[32:33] op_sel:[0,0] op_sel_hi:[0,1]
    v_pk_mul_f32 v[22:23], v[102:103], v[34:35] op_sel:[0,0] op_sel_hi:[0,1]
    v_pk_fma_f32 v[104:105], v[100:101], v[32:33], v[20:21] op_sel:[1,1,0] op_sel_hi:[1,0,1] neg_lo:[1,0,0]
    v_pk_fma_f32 v[106:107], v[102:103], v[34:35], v[22:23] op_sel:[1,1,0] op_sel_hi:[1,0,1] neg_lo:[1,0,0]
    v_pk_mul_f32 v[16:17], v[104:105], v[32:33] op_sel:[0,0] op_sel_hi:[0,1]
    v_pk_mul_f32 v[18:19], v[106:107], v[34:35] op_sel:[0,0] op_sel_hi:[0,1]
    v_pk_fma_f32 v[108:109], v[104:105], v[32:33], v[16:17] op_sel:[1,1,0] op_sel_hi:[1,0,1] neg_lo:[1,0,0]
    v_pk_fma_f32 v[110:111], v[106:107], v[34:35], v[18:19] op_sel:[1,1,0] op_sel_hi:[1,0,1] neg_lo:[1,0,0]
    v_pk_mul_f32 v[20:21], v[108:109], v[32:33] op_sel:[0,0] op_sel_hi:[0,1]
    v_pk_mul_f32 v[22:23], v[110:111], v[34:35] op_sel:[0,0] op_sel_hi:[0,1]
    v_pk_fma_f32 v[112:113], v[108:109], v[32:33], v[20:21] op_sel:[1,1,0] op_sel_hi:[1,0,1] neg_lo:[1,0,0]
    v_pk_fma_f32 v[114:115], v[110:111], v[34:35], v[22:23] op_sel:[1,1,0] op_sel_hi:[1,0,1] neg_lo:[1,0,0]
    v_cvt_pk_bf16_f32 v192, v28, v88
    v_cvt_pk_bf16_f32 v193, v92, v96
    v_cvt_pk_bf16_f32 v194, v100, v104
    v_cvt_pk_bf16_f32 v195, v108, v112
    ds_write_b128 v10, v[192:195] offset:0
    v_cvt_pk_bf16_f32 v196, -v29, -v89
    v_cvt_pk_bf16_f32 v197, -v93, -v97
    v_cvt_pk_bf16_f32 v198, -v101, -v105
    v_cvt_pk_bf16_f32 v199, -v109, -v113
    ds_write_b128 v10, v[196:199] offset:4096
    v_cvt_pk_bf16_f32 v200, v30, v90
    v_cvt_pk_bf16_f32 v201, v94, v98
    v_cvt_pk_bf16_f32 v202, v102, v106
    v_cvt_pk_bf16_f32 v203, v110, v114
    ds_write_b128 v10, v[200:203] offset:8192
    v_cvt_pk_bf16_f32 v204, -v31, -v91
    v_cvt_pk_bf16_f32 v205, -v95, -v99
    v_cvt_pk_bf16_f32 v206, -v103, -v107
    v_cvt_pk_bf16_f32 v207, -v111, -v115
    ds_write_b128 v10, v[204:207] offset:12288
    v_pk_mul_f32 v[16:17], v[44:45], v[44:45] op_sel:[0,0] op_sel_hi:[0,1]
    v_pk_mul_f32 v[18:19], v[46:47], v[46:47] op_sel:[0,0] op_sel_hi:[0,1]
    v_pk_fma_f32 v[48:49], v[44:45], v[44:45], v[16:17] op_sel:[1,1,0] op_sel_hi:[1,0,1] neg_lo:[1,0,0]
    v_pk_fma_f32 v[50:51], v[46:47], v[46:47], v[18:19] op_sel:[1,1,0] op_sel_hi:[1,0,1] neg_lo:[1,0,0]
    v_pk_mul_f32 v[20:21], v[28:29], v[44:45] op_sel:[0,0] op_sel_hi:[0,1]
    v_pk_mul_f32 v[22:23], v[30:31], v[46:47] op_sel:[0,0] op_sel_hi:[0,1]
    v_pk_fma_f32 v[116:117], v[28:29], v[44:45], v[20:21] op_sel:[1,1,0] op_sel_hi:[1,0,1] neg_lo:[1,0,0]
    v_pk_fma_f32 v[118:119], v[30:31], v[46:47], v[22:23] op_sel:[1,1,0] op_sel_hi:[1,0,1] neg_lo:[1,0,0]
    v_pk_mul_f32 v[16:17], v[92:93], v[44:45] op_sel:[0,0] op_sel_hi:[0,1]
    v_pk_mul_f32 v[18:19], v[94:95], v[46:47] op_sel:[0,0] op_sel_hi:[0,1]
    v_pk_fma_f32 v[120:121], v[92:93], v[44:45], v[16:17] op_sel:[1,1,0] op_sel_hi:[1,0,1] neg_lo:[1,0,0]
    v_pk_fma_f32 v[122:123], v[94:95], v[46:47], v[18:19] op_sel:[1,1,0] op_sel_hi:[1,0,1] neg_lo:[1,0,0]
    v_pk_mul_f32 v[20:21], v[100:101], v[44:45] op_sel:[0,0] op_sel_hi:[0,1]
    v_pk_mul_f32 v[22:23], v[102:103], v[46:47] op_sel:[0,0] op_sel_hi:[0,1]
    v_pk_fma_f32 v[124:125], v[100:101], v[44:45], v[20:21] op_sel:[1,1,0] op_sel_hi:[1,0,1] neg_lo:[1,0,0]
    v_pk_fma_f32 v[126:127], v[102:103], v[46:47], v[22:23] op_sel:[1,1,0] op_sel_hi:[1,0,1] neg_lo:[1,0,0]
    v_pk_mul_f32 v[16:17], v[108:109], v[44:45] op_sel:[0,0] op_sel_hi:[0,1]
    v_pk_mul_f32 v[18:19], v[110:111], v[46:47] op_sel:[0,0] op_sel_hi:[0,1]
    v_pk_fma_f32 v[128:129], v[108:109], v[44:45], v[16:17] op_sel:[1,1,0] op_sel_hi:[1,0,1] neg_lo:[1,0,0]
    v_pk_fma_f32 v[130:131], v[110:111], v[46:47], v[18:19] op_sel:[1,1,0] op_sel_hi:[1,0,1] neg_lo:[1,0,0]
    v_pk_mul_f32 v[20:21], v[28:29], v[48:49] op_sel:[0,0] op_sel_hi:[0,1]
    v_pk_mul_f32 v[22:23], v[30:31], v[50:51] op_sel:[0,0] op_sel_hi:[0,1]
    v_pk_fma_f32 v[136:137], v[28:29], v[48:49], v[20:21] op_sel:[1,1,0] op_sel_hi:[1,0,1] neg_lo:[1,0,0]
    v_pk_fma_f32 v[138:139], v[30:31], v[50:51], v[22:23] op_sel:[1,1,0] op_sel_hi:[1,0,1] neg_lo:[1,0,0]
    v_pk_mul_f32 v[16:17], v[100:101], v[48:49] op_sel:[0,0] op_sel_hi:[0,1]
    v_pk_mul_f32 v[18:19], v[102:103], v[50:51] op_sel:[0,0] op_sel_hi:[0,1]
    v_pk_fma_f32 v[140:141], v[100:101], v[48:49], v[16:17] op_sel:[1,1,0] op_sel_hi:[1,0,1] neg_lo:[1,0,0]
    v_pk_fma_f32 v[142:143], v[102:103], v[50:51], v[18:19] op_sel:[1,1,0] op_sel_hi:[1,0,1] neg_lo:[1,0,0]
    v_pk_mul_f32 v[20:21], v[48:49], v[48:49] op_sel:[0,0] op_sel_hi:[0,1]
    v_pk_mul_f32 v[22:23], v[50:51], v[50:51] op_sel:[0,0] op_sel_hi:[0,1]
    v_pk_fma_f32 v[52:53], v[48:49], v[48:49], v[20:21] op_sel:[1,1,0] op_sel_hi:[1,0,1] neg_lo:[1,0,0]
    v_pk_fma_f32 v[54:55], v[50:51], v[50:51], v[22:23] op_sel:[1,1,0] op_sel_hi:[1,0,1] neg_lo:[1,0,0]
    v_pk_mul_f32 v[16:17], v[116:117], v[36:37] op_sel:[0,0] op_sel_hi:[0,1]
    v_pk_mul_f32 v[18:19], v[118:119], v[38:39] op_sel:[0,0] op_sel_hi:[0,1]
    v_pk_fma_f32 v[132:133], v[116:117], v[36:37], v[16:17] op_sel:[1,1,0] op_sel_hi:[1,0,1] neg_lo:[1,0,0]
    v_pk_fma_f32 v[134:135], v[118:119], v[38:39], v[18:19] op_sel:[1,1,0] op_sel_hi:[1,0,1] neg_lo:[1,0,0]
    v_pk_mul_f32 v[20:21], v[136:137], v[36:37] op_sel:[0,0] op_sel_hi:[0,1]
    v_pk_mul_f32 v[22:23], v[138:139], v[38:39] op_sel:[0,0] op_sel_hi:[0,1]
    v_pk_fma_f32 v[144:145], v[136:137], v[36:37], v[20:21] op_sel:[1,1,0] op_sel_hi:[1,0,1] neg_lo:[1,0,0]
    v_pk_fma_f32 v[146:147], v[138:139], v[38:39], v[22:23] op_sel:[1,1,0] op_sel_hi:[1,0,1] neg_lo:[1,0,0]
    v_pk_mul_f32 v[16:17], v[28:29], v[52:53] op_sel:[0,0] op_sel_hi:[0,1]
    v_pk_mul_f32 v[18:19], v[30:31], v[54:55] op_sel:[0,0] op_sel_hi:[0,1]
    v_pk_fma_f32 v[160:161], v[28:29], v[52:53], v[16:17] op_sel:[1,1,0] op_sel_hi:[1,0,1] neg_lo:[1,0,0]
    v_pk_fma_f32 v[162:163], v[30:31], v[54:55], v[18:19] op_sel:[1,1,0] op_sel_hi:[1,0,1] neg_lo:[1,0,0]
    v_pk_mul_f32 v[20:21], v[136:137], v[44:45] op_sel:[0,0] op_sel_hi:[0,1]
    v_pk_mul_f32 v[22:23], v[138:139], v[46:47] op_sel:[0,0] op_sel_hi:[0,1]
    v_pk_fma_f32 v[148:149], v[136:137], v[44:45], v[20:21] op_sel:[1,1,0] op_sel_hi:[1,0,1] neg_lo:[1,0,0]
    v_pk_fma_f32 v[150:151], v[138:139], v[46:47], v[22:23] op_sel:[1,1,0] op_sel_hi:[1,0,1] neg_lo:[1,0,0]
    v_pk_mul_f32 v[16:17], v[140:141], v[44:45] op_sel:[0,0] op_sel_hi:[0,1]
    v_pk_mul_f32 v[18:19], v[142:143], v[46:47] op_sel:[0,0] op_sel_hi:[0,1]
    v_pk_fma_f32 v[152:153], v[140:141], v[44:45], v[16:17] op_sel:[1,1,0] op_sel_hi:[1,0,1] neg_lo:[1,0,0]
    v_pk_fma_f32 v[154:155], v[142:143], v[46:47], v[18:19] op_sel:[1,1,0] op_sel_hi:[1,0,1] neg_lo:[1,0,0]
    v_pk_mul_f32 v[20:21], v[144:145], v[44:45] op_sel:[0,0] op_sel_hi:[0,1]
    v_pk_mul_f32 v[22:23], v[146:147], v[46:47] op_sel:[0,0] op_sel_hi:[0,1]
    v_pk_fma_f32 v[156:157], v[144:145], v[44:45], v[20:21] op_sel:[1,1,0] op_sel_hi:[1,0,1] neg_lo:[1,0,0]
    v_pk_fma_f32 v[158:159], v[146:147], v[46:47], v[22:23] op_sel:[1,1,0] op_sel_hi:[1,0,1] neg_lo:[1,0,0]
    v_cvt_pk_bf16_f32 v192, v116, v120
    v_cvt_pk_bf16_f32 v193, v124, v128
    v_cvt_pk_bf16_f32 v194, v148, v152
    v_cvt_pk_bf16_f32 v195, v156, v156
    ds_write_b128 v11, v[192:195] offset:0
    v_cvt_pk_bf16_f32 v196, -v117, -v121
    v_cvt_pk_bf16_f32 v197, -v125, -v129
    v_cvt_pk_bf16_f32 v198, -v149, -v153
    v_cvt_pk_bf16_f32 v199, -v157, -v157
    ds_write_b128 v11, v[196:199] offset:4096
    v_cvt_pk_bf16_f32 v200, v118, v122
    v_cvt_pk_bf16_f32 v201, v126, v130
    v_cvt_pk_bf16_f32 v202, v150, v154
    v_cvt_pk_bf16_f32 v203, v158, v158
    ds_write_b128 v11, v[200:203] offset:8192
    v_cvt_pk_bf16_f32 v204, -v119, -v123
    v_cvt_pk_bf16_f32 v205, -v127, -v131
    v_cvt_pk_bf16_f32 v206, -v151, -v155
    v_cvt_pk_bf16_f32 v207, -v159, -v159
    ds_write_b128 v11, v[204:207] offset:12288
    v_pk_mul_f32 v[16:17], v[160:161], v[36:37] op_sel:[0,0] op_sel_hi:[0,1]
    v_pk_mul_f32 v[18:19], v[162:163], v[38:39] op_sel:[0,0] op_sel_hi:[0,1]
    v_pk_fma_f32 v[164:165], v[160:161], v[36:37], v[16:17] op_sel:[1,1,0] op_sel_hi:[1,0,1] neg_lo:[1,0,0]
    v_pk_fma_f32 v[166:167], v[162:163], v[38:39], v[18:19] op_sel:[1,1,0] op_sel_hi:[1,0,1] neg_lo:[1,0,0]
    v_pk_mul_f32 v[20:21], v[160:161], v[48:49] op_sel:[0,0] op_sel_hi:[0,1]
    v_pk_mul_f32 v[22:23], v[162:163], v[50:51] op_sel:[0,0] op_sel_hi:[0,1]
    v_pk_fma_f32 v[176:177], v[160:161], v[48:49], v[20:21] op_sel:[1,1,0] op_sel_hi:[1,0,1] neg_lo:[1,0,0]
    v_pk_fma_f32 v[178:179], v[162:163], v[50:51], v[22:23] op_sel:[1,1,0] op_sel_hi:[1,0,1] neg_lo:[1,0,0]
    v_pk_mul_f32 v[16:17], v[160:161], v[44:45] op_sel:[0,0] op_sel_hi:[0,1]
    v_pk_mul_f32 v[18:19], v[162:163], v[46:47] op_sel:[0,0] op_sel_hi:[0,1]
    v_pk_fma_f32 v[168:169], v[160:161], v[44:45], v[16:17] op_sel:[1,1,0] op_sel_hi:[1,0,1] neg_lo:[1,0,0]
    v_pk_fma_f32 v[170:171], v[162:163], v[46:47], v[18:19] op_sel:[1,1,0] op_sel_hi:[1,0,1] neg_lo:[1,0,0]
    v_pk_mul_f32 v[20:21], v[164:165], v[48:49] op_sel:[0,0] op_sel_hi:[0,1]
    v_pk_mul_f32 v[22:23], v[166:167], v[50:51] op_sel:[0,0] op_sel_hi:[0,1]
    v_pk_fma_f32 v[180:181], v[164:165], v[48:49], v[20:21] op_sel:[1,1,0] op_sel_hi:[1,0,1] neg_lo:[1,0,0]
    v_pk_fma_f32 v[182:183], v[166:167], v[50:51], v[22:23] op_sel:[1,1,0] op_sel_hi:[1,0,1] neg_lo:[1,0,0]
    v_pk_mul_f32 v[16:17], v[164:165], v[44:45] op_sel:[0,0] op_sel_hi:[0,1]
    v_pk_mul_f32 v[18:19], v[166:167], v[46:47] op_sel:[0,0] op_sel_hi:[0,1]
    v_pk_fma_f32 v[172:173], v[164:165], v[44:45], v[16:17] op_sel:[1,1,0] op_sel_hi:[1,0,1] neg_lo:[1,0,0]
    v_pk_fma_f32 v[174:175], v[166:167], v[46:47], v[18:19] op_sel:[1,1,0] op_sel_hi:[1,0,1] neg_lo:[1,0,0]
    v_pk_mul_f32 v[20:21], v[176:177], v[44:45] op_sel:[0,0] op_sel_hi:[0,1]
    v_pk_mul_f32 v[22:23], v[178:179], v[46:47] op_sel:[0,0] op_sel_hi:[0,1]
    v_pk_fma_f32 v[184:185], v[176:177], v[44:45], v[20:21] op_sel:[1,1,0] op_sel_hi:[1,0,1] neg_lo:[1,0,0]
    v_pk_fma_f32 v[186:187], v[178:179], v[46:47], v[22:23] op_sel:[1,1,0] op_sel_hi:[1,0,1] neg_lo:[1,0,0]
    v_pk_mul_f32 v[16:17], v[180:181], v[44:45] op_sel:[0,0] op_sel_hi:[0,1]
    v_pk_mul_f32 v[18:19], v[182:183], v[46:47] op_sel:[0,0] op_sel_hi:[0,1]
    v_pk_fma_f32 v[188:189], v[180:181], v[44:45], v[16:17] op_sel:[1,1,0] op_sel_hi:[1,0,1] neg_lo:[1,0,0]
    v_pk_fma_f32 v[190:191], v[182:183], v[46:47], v[18:19] op_sel:[1,1,0] op_sel_hi:[1,0,1] neg_lo:[1,0,0]
    v_cvt_pk_bf16_f32 v192, v132, v136
    v_cvt_pk_bf16_f32 v193, v140, v144
    v_cvt_pk_bf16_f32 v194, v176, v180
    v_cvt_pk_bf16_f32 v195, v184, v188
    ds_write_b128 v12, v[192:195] offset:0
    v_cvt_pk_bf16_f32 v196, -v133, -v137
    v_cvt_pk_bf16_f32 v197, -v141, -v145
    v_cvt_pk_bf16_f32 v198, -v177, -v181
    v_cvt_pk_bf16_f32 v199, -v185, -v189
    ds_write_b128 v12, v[196:199] offset:4096
    v_cvt_pk_bf16_f32 v200, v134, v138
    v_cvt_pk_bf16_f32 v201, v142, v146
    v_cvt_pk_bf16_f32 v202, v178, v182
    v_cvt_pk_bf16_f32 v203, v186, v190
    ds_write_b128 v12, v[200:203] offset:8192
    v_cvt_pk_bf16_f32 v204, -v135, -v139
    v_cvt_pk_bf16_f32 v205, -v143, -v147
    v_cvt_pk_bf16_f32 v206, -v179, -v183
    v_cvt_pk_bf16_f32 v207, -v187, -v191
    ds_write_b128 v12, v[204:207] offset:12288
    v_cvt_pk_bf16_f32 v192, v160, v164
    v_cvt_pk_bf16_f32 v193, v168, v172
    v_cvt_pk_bf16_f32 v194, v172, v172
    v_cvt_pk_bf16_f32 v195, v172, v172
    ds_write_b128 v13, v[192:195] offset:0
    v_cvt_pk_bf16_f32 v196, -v161, -v165
    v_cvt_pk_bf16_f32 v197, -v169, -v173
    v_cvt_pk_bf16_f32 v198, -v173, -v173
    v_cvt_pk_bf16_f32 v199, -v173, -v173
    ds_write_b128 v13, v[196:199] offset:4096
    v_cvt_pk_bf16_f32 v200, v162, v166
    v_cvt_pk_bf16_f32 v201, v170, v174
    v_cvt_pk_bf16_f32 v202, v174, v174
    v_cvt_pk_bf16_f32 v203, v174, v174
    ds_write_b128 v13, v[200:203] offset:8192
    v_cvt_pk_bf16_f32 v204, -v163, -v167
    v_cvt_pk_bf16_f32 v205, -v171, -v175
    v_cvt_pk_bf16_f32 v206, -v175, -v175
    v_cvt_pk_bf16_f32 v207, -v175, -v175
    ds_write_b128 v13, v[204:207] offset:12288
    s_waitcnt lgkmcnt(0)
    v_mov_b32 v40, 0
    v_mov_b32 v41, 0
    v_mov_b32 v42, 0
    v_mov_b32 v43, 0
    v_mov_b32 v44, 0
    v_mov_b32 v45, 0
    v_mov_b32 v46, 0
    v_mov_b32 v47, 0
    v_mov_b32 v48, 0
    v_mov_b32 v49, 0
    v_mov_b32 v50, 0
    v_mov_b32 v51, 0
    v_mov_b32 v52, 0
    v_mov_b32 v53, 0
    v_mov_b32 v54, 0
    v_mov_b32 v55, 0
    ds_read_b64_tr_b16 v[56:57], v14 offset:0
    ds_read_b64_tr_b16 v[58:59], v15 offset:0
    ds_read_b64_tr_b16 v[60:61], v14 offset:16384
    ds_read_b64_tr_b16 v[62:63], v15 offset:16384
    ds_read_b64_tr_b16 v[64:65], v14 offset:1024
    ds_read_b64_tr_b16 v[66:67], v15 offset:1024
    ds_read_b64_tr_b16 v[68:69], v14 offset:17408
    ds_read_b64_tr_b16 v[70:71], v15 offset:17408
    ds_read_b64_tr_b16 v[72:73], v14 offset:2048
    ds_read_b64_tr_b16 v[74:75], v15 offset:2048
    ds_read_b64_tr_b16 v[76:77], v14 offset:18432
    ds_read_b64_tr_b16 v[78:79], v15 offset:18432
    s_waitcnt lgkmcnt(8)
    v_mfma_f32_32x32x16_bf16 v[40:55], v[56:59], v[60:63], v[40:55]
    ds_read_b64_tr_b16 v[80:81], v14 offset:3072
    ds_read_b64_tr_b16 v[82:83], v15 offset:3072
    ds_read_b64_tr_b16 v[84:85], v14 offset:19456
    ds_read_b64_tr_b16 v[86:87], v15 offset:19456
    s_waitcnt lgkmcnt(8)
    v_mfma_f32_32x32x16_bf16 v[40:55], v[64:67], v[68:71], v[40:55]
    ds_read_b64_tr_b16 v[56:57], v14 offset:4096
    ds_read_b64_tr_b16 v[58:59], v15 offset:4096
    ds_read_b64_tr_b16 v[60:61], v14 offset:20480
    ds_read_b64_tr_b16 v[62:63], v15 offset:20480
    s_waitcnt lgkmcnt(8)
    v_mfma_f32_32x32x16_bf16 v[40:55], v[72:75], v[76:79], v[40:55]
    ds_read_b64_tr_b16 v[64:65], v14 offset:5120
    ds_read_b64_tr_b16 v[66:67], v15 offset:5120
    ds_read_b64_tr_b16 v[68:69], v14 offset:21504
    ds_read_b64_tr_b16 v[70:71], v15 offset:21504
    s_waitcnt lgkmcnt(8)
    v_mfma_f32_32x32x16_bf16 v[40:55], v[80:83], v[84:87], v[40:55]
    ds_read_b64_tr_b16 v[72:73], v14 offset:6144
    ds_read_b64_tr_b16 v[74:75], v15 offset:6144
    ds_read_b64_tr_b16 v[76:77], v14 offset:22528
    ds_read_b64_tr_b16 v[78:79], v15 offset:22528
    s_waitcnt lgkmcnt(8)
    v_mfma_f32_32x32x16_bf16 v[40:55], v[56:59], v[60:63], v[40:55]
    ds_read_b64_tr_b16 v[80:81], v14 offset:7168
    ds_read_b64_tr_b16 v[82:83], v15 offset:7168
    ds_read_b64_tr_b16 v[84:85], v14 offset:23552
    ds_read_b64_tr_b16 v[86:87], v15 offset:23552
    s_waitcnt lgkmcnt(8)
    v_mfma_f32_32x32x16_bf16 v[40:55], v[64:67], v[68:71], v[40:55]
    ds_read_b64_tr_b16 v[56:57], v14 offset:8192
    ds_read_b64_tr_b16 v[58:59], v15 offset:8192
    ds_read_b64_tr_b16 v[60:61], v14 offset:24576
    ds_read_b64_tr_b16 v[62:63], v15 offset:24576
    s_waitcnt lgkmcnt(8)
    v_mfma_f32_32x32x16_bf16 v[40:55], v[72:75], v[76:79], v[40:55]
    ds_read_b64_tr_b16 v[64:65], v14 offset:9216
    ds_read_b64_tr_b16 v[66:67], v15 offset:9216
    ds_read_b64_tr_b16 v[68:69], v14 offset:25600
    ds_read_b64_tr_b16 v[70:71], v15 offset:25600
    s_waitcnt lgkmcnt(8)
    v_mfma_f32_32x32x16_bf16 v[40:55], v[80:83], v[84:87], v[40:55]
    ds_read_b64_tr_b16 v[72:73], v14 offset:10240
    ds_read_b64_tr_b16 v[74:75], v15 offset:10240
    ds_read_b64_tr_b16 v[76:77], v14 offset:26624
    ds_read_b64_tr_b16 v[78:79], v15 offset:26624
    s_waitcnt lgkmcnt(8)
    v_mfma_f32_32x32x16_bf16 v[40:55], v[56:59], v[60:63], v[40:55]
    ds_read_b64_tr_b16 v[80:81], v14 offset:11264
    ds_read_b64_tr_b16 v[82:83], v15 offset:11264
    ds_read_b64_tr_b16 v[84:85], v14 offset:27648
    ds_read_b64_tr_b16 v[86:87], v15 offset:27648
    s_waitcnt lgkmcnt(8)
    v_mfma_f32_32x32x16_bf16 v[40:55], v[64:67], v[68:71], v[40:55]
    ds_read_b64_tr_b16 v[56:57], v14 offset:12288
    ds_read_b64_tr_b16 v[58:59], v15 offset:12288
    ds_read_b64_tr_b16 v[60:61], v14 offset:28672
    ds_read_b64_tr_b16 v[62:63], v15 offset:28672
    s_waitcnt lgkmcnt(8)
    v_mfma_f32_32x32x16_bf16 v[40:55], v[72:75], v[76:79], v[40:55]
    ds_read_b64_tr_b16 v[64:65], v14 offset:13312
    ds_read_b64_tr_b16 v[66:67], v15 offset:13312
    ds_read_b64_tr_b16 v[68:69], v14 offset:29696
    ds_read_b64_tr_b16 v[70:71], v15 offset:29696
    s_waitcnt lgkmcnt(8)
    v_mfma_f32_32x32x16_bf16 v[40:55], v[80:83], v[84:87], v[40:55]
    ds_read_b64_tr_b16 v[72:73], v14 offset:14336
    ds_read_b64_tr_b16 v[74:75], v15 offset:14336
    ds_read_b64_tr_b16 v[76:77], v14 offset:30720
    ds_read_b64_tr_b16 v[78:79], v15 offset:30720
    s_waitcnt lgkmcnt(8)
    v_mfma_f32_32x32x16_bf16 v[40:55], v[56:59], v[60:63], v[40:55]
    ds_read_b64_tr_b16 v[80:81], v14 offset:15360
    ds_read_b64_tr_b16 v[82:83], v15 offset:15360
    ds_read_b64_tr_b16 v[84:85], v14 offset:31744
    ds_read_b64_tr_b16 v[86:87], v15 offset:31744
    s_waitcnt lgkmcnt(8)
    v_mfma_f32_32x32x16_bf16 v[40:55], v[64:67], v[68:71], v[40:55]
    s_waitcnt lgkmcnt(4)
    v_mfma_f32_32x32x16_bf16 v[40:55], v[72:75], v[76:79], v[40:55]
    s_waitcnt lgkmcnt(0)
    v_mfma_f32_32x32x16_bf16 v[40:55], v[80:83], v[84:87], v[40:55]
    s_nop 3
    s_barrier
    v_and_b32 v4, 31, v1
    v_sub_u32 v5, 31, v4
    v_lshl_add_u32 v16, v5, 4, s38
    v_lshrrev_b32 v6, 5, v1
    v_and_b32 v7, 1, v1
    v_cmp_eq_u32 vcc, 1, v7
    v_xor_b32 v6, 1, v6
    v_lshl_add_u32 v6, v6, 3, v16
    v_cvt_pk_bf16_f32 v56, v43, v42
    v_cvt_pk_bf16_f32 v57, v41, v40
    ds_write_b64 v6, v[56:57] offset:3584
    s_mov_b32 exec_lo, -1
    s_mov_b32 exec_hi, 0
    v_cvt_pk_bf16_f32 v72, v48, v47
    v_cvt_pk_bf16_f32 v73, v46, v46
    v_cvt_pk_bf16_f32 v74, v46, v45
    v_cvt_pk_bf16_f32 v75, v44, v44
    ds_write_b128 v16, v[72:75] offset:3072
    v_cvt_pk_bf16_f32 v76, v51, v51
    v_cvt_pk_bf16_f32 v77, v50, v50
    v_cvt_pk_bf16_f32 v78, v50, v49
    v_cvt_pk_bf16_f32 v79, v49, v49
    ds_write_b128 v16, v[76:79] offset:2560
    v_cndmask_b32 v7, v52, v53, vcc
    v_cvt_pk_bf16_f32 v80, v53, v53
    v_cvt_pk_bf16_f32 v82, v52, v52
    v_cvt_pk_bf16_f32 v81, v53, v7
    v_mov_b32 v83, v82
    ds_write_b128 v16, v[80:83] offset:1536
    v_cndmask_b32 v7, v54, v55, vcc
    v_cvt_pk_bf16_f32 v84, v55, v55
    v_cvt_pk_bf16_f32 v86, v54, v54
    v_cvt_pk_bf16_f32 v85, v55, v7
    v_mov_b32 v87, v86
    ds_write_b128 v16, v[84:87] offset:1024
    v_mov_b32 v64, 0
    v_mov_b32 v65, 0
    v_mov_b32 v66, 0
    v_mov_b32 v67, 0
    v_lshrrev_b32 v4, 2, v1
    v_mul_u32_u24 v4, 4160, v4
    v_and_b32 v5, 3, v1
    v_lshl_add_u32 v4, v5, 4, v4
    v_add_u32 v4, s38, v4
    ds_write_b128 v4, v[64:67] offset:4096
    s_mov_b32 exec_lo, 0
    s_mov_b32 exec_hi, -1
    v_cvt_pk_bf16_f32 v56, v46, v46
    v_cvt_pk_bf16_f32 v57, v45, v45
    v_cvt_pk_bf16_f32 v58, v45, v44
    v_cvt_pk_bf16_f32 v59, v44, v44
    ds_write_b128 v16, v[56:59] offset:2048
    v_cndmask_b32 v7, v48, v49, vcc
    v_cvt_pk_bf16_f32 v60, v49, v49
    v_cvt_pk_bf16_f32 v62, v48, v48
    v_cvt_pk_bf16_f32 v61, v49, v7
    v_mov_b32 v63, v62
    ds_write_b128 v16, v[60:63] offset:512
    v_cndmask_b32 v7, v50, v51, vcc
    v_cvt_pk_bf16_f32 v64, v51, v51
    v_cvt_pk_bf16_f32 v66, v50, v50
    v_cvt_pk_bf16_f32 v65, v51, v7
    v_mov_b32 v67, v66
    ds_write_b128 v16, v[64:67] offset:0
    s_mov_b64 exec, -1
    v_lshl_add_u32 v17, v1, 4, s38
    s_waitcnt lgkmcnt(0)
    ds_read_b128 v[124:127], v17 offset:0
    ds_read_b128 v[128:131], v17 offset:16
    ds_read_b128 v[132:135], v17 offset:1024
    ds_read_b128 v[136:139], v17 offset:1040
    ds_read_b128 v[140:143], v17 offset:2048
    ds_read_b128 v[144:147], v17 offset:2064
    ds_read_b128 v[148:151], v17 offset:3072
    ds_read_b128 v[152:155], v17 offset:3088
    v_mul_u32_u24 v4, 1280, v3
    v_lshl_add_u32 v4, v2, 4, v4
    v_add_u32 v18, s38, v4
    v_mov_b32 v64, 0
    v_mov_b32 v65, 0
    v_mov_b32 v66, 0
    v_mov_b32 v67, 0
    ds_write_b128 v18, v[64:67] offset:33280
    s_waitcnt lgkmcnt(0)
    v_alignbit_b32 v162, v125, v124, 16
    v_alignbit_b32 v163, v126, v125, 16
    v_alignbit_b32 v164, v127, v126, 16
    v_alignbit_b32 v165, v128, v127, 16
    v_alignbit_b32 v166, v129, v128, 16
    v_alignbit_b32 v167, v130, v129, 16
    v_alignbit_b32 v168, v126, v125, 16
    v_alignbit_b32 v169, v127, v126, 16
    v_alignbit_b32 v170, v128, v127, 16
    v_alignbit_b32 v171, v129, v128, 16
    v_alignbit_b32 v172, v130, v129, 16
    v_alignbit_b32 v173, v131, v130, 16
    v_mov_b32 v156, v125
    v_mov_b32 v157, v126
    v_mov_b32 v158, v127
    v_mov_b32 v159, v128
    v_mov_b32 v160, v129
    v_mov_b32 v161, v130
    ds_write_b128 v17, v[162:165] offset:4160
    ds_write_b128 v17, v[164:167] offset:20800
    ds_write_b128 v17, v[168:171] offset:12480
    ds_write_b128 v17, v[170:173] offset:29120
    ds_write_b128 v17, v[126:129] offset:16640
    ds_write_b128 v17, v[156:159] offset:8320
    ds_write_b128 v17, v[158:161] offset:24960
    v_alignbit_b32 v162, v133, v132, 16
    v_alignbit_b32 v163, v134, v133, 16
    v_alignbit_b32 v164, v135, v134, 16
    v_alignbit_b32 v165, v136, v135, 16
    v_alignbit_b32 v166, v137, v136, 16
    v_alignbit_b32 v167, v138, v137, 16
    v_alignbit_b32 v168, v134, v133, 16
    v_alignbit_b32 v169, v135, v134, 16
    v_alignbit_b32 v170, v136, v135, 16
    v_alignbit_b32 v171, v137, v136, 16
    v_alignbit_b32 v172, v138, v137, 16
    v_alignbit_b32 v173, v139, v138, 16
    v_mov_b32 v156, v133
    v_mov_b32 v157, v134
    v_mov_b32 v158, v135
    v_mov_b32 v159, v136
    v_mov_b32 v160, v137
    v_mov_b32 v161, v138
    ds_write_b128 v17, v[162:165] offset:5184
    ds_write_b128 v17, v[164:167] offset:21824
    ds_write_b128 v17, v[168:171] offset:13504
    ds_write_b128 v17, v[170:173] offset:30144
    ds_write_b128 v17, v[134:137] offset:17664
    ds_write_b128 v17, v[156:159] offset:9344
    ds_write_b128 v17, v[158:161] offset:25984
    v_alignbit_b32 v162, v141, v140, 16
    v_alignbit_b32 v163, v142, v141, 16
    v_alignbit_b32 v164, v143, v142, 16
    v_alignbit_b32 v165, v144, v143, 16
    v_alignbit_b32 v166, v145, v144, 16
    v_alignbit_b32 v167, v146, v145, 16
    v_alignbit_b32 v168, v142, v141, 16
    v_alignbit_b32 v169, v143, v142, 16
    v_alignbit_b32 v170, v144, v143, 16
    v_alignbit_b32 v171, v145, v144, 16
    v_alignbit_b32 v172, v146, v145, 16
    v_alignbit_b32 v173, v147, v146, 16
    v_mov_b32 v156, v141
    v_mov_b32 v157, v142
    v_mov_b32 v158, v143
    v_mov_b32 v159, v144
    v_mov_b32 v160, v145
    v_mov_b32 v161, v146
    ds_write_b128 v17, v[162:165] offset:6208
    ds_write_b128 v17, v[164:167] offset:22848
    ds_write_b128 v17, v[168:171] offset:14528
    ds_write_b128 v17, v[170:173] offset:31168
    ds_write_b128 v17, v[142:145] offset:18688
    ds_write_b128 v17, v[156:159] offset:10368
    ds_write_b128 v17, v[158:161] offset:27008
    v_alignbit_b32 v162, v149, v148, 16
    v_alignbit_b32 v163, v150, v149, 16
    v_alignbit_b32 v164, v151, v150, 16
    v_alignbit_b32 v165, v152, v151, 16
    v_alignbit_b32 v166, v153, v152, 16
    v_alignbit_b32 v167, v154, v153, 16
    v_alignbit_b32 v168, v150, v149, 16
    v_alignbit_b32 v169, v151, v150, 16
    v_alignbit_b32 v170, v152, v151, 16
    v_alignbit_b32 v171, v153, v152, 16
    v_alignbit_b32 v172, v154, v153, 16
    v_alignbit_b32 v173, v155, v154, 16
    v_mov_b32 v156, v149
    v_mov_b32 v157, v150
    v_mov_b32 v158, v151
    v_mov_b32 v159, v152
    v_mov_b32 v160, v153
    v_mov_b32 v161, v154
    ds_write_b128 v17, v[162:165] offset:7232
    ds_write_b128 v17, v[164:167] offset:23872
    ds_write_b128 v17, v[168:171] offset:15552
    ds_write_b128 v17, v[170:173] offset:32192
    ds_write_b128 v17, v[150:153] offset:19712
    ds_write_b128 v17, v[156:159] offset:11392
    ds_write_b128 v17, v[158:161] offset:28032
    v_lshrrev_b32 v4, 2, v1
    v_and_b32 v5, 3, v4
    v_lshrrev_b32 v4, 2, v4
    v_and_b32 v6, 3, v1
    v_lshl_add_u32 v7, v5, 2, v4
    s_lshl_b32 s40, s36, 6
    v_add_u32 v7, s40, v7
    v_lshlrev_b32 v120, 6, v7
    v_lshl_add_u32 v120, v6, 4, v120
    v_mul_u32_u24 v7, 640, v7
    s_lshl_b32 s40, s39, 2
    v_add3_u32 v7, v7, v6, s40
    v_lshlrev_b32 v21, 4, v7
    v_mul_u32_u24 v6, 38432, v6
    s_lshl_b32 s40, s36, 8
    v_lshl_add_u32 v6, v5, 4, v6
    v_add_u32 v6, s40, v6
    v_mul_u32_u24 v5, 1280, v4
    v_add_u32 v22, v5, v6
    v_lshl_add_u32 v23, v4, 10, v6
    s_cmp_lg_u32 s36, 0
    s_cbranch_scc1 nopoll_sequential_preLN__ssm_conv_s4__glu_gated_swiglu__prompt_kernel_24
    v_mov_b32 v4, 128
    s_mov_b32 s45, 0x40000
poll_sequential_preLN__ssm_conv_s4__glu_gated_swiglu__prompt_kernel_25:
    buffer_load_dword v5, v4, s[32:35], 0 offen sc1
    s_waitcnt vmcnt(0)
    v_readfirstlane_b32 s46, v5
    s_nop 1
    s_cmp_lg_u32 s46, 0
    s_cbranch_scc1 polled_sequential_preLN__ssm_conv_s4__glu_gated_swiglu__prompt_kernel_26
    s_sleep 4
    s_sub_u32 s45, s45, 1
    s_cmp_lg_u32 s45, 0
    s_cbranch_scc1 poll_sequential_preLN__ssm_conv_s4__glu_gated_swiglu__prompt_kernel_25
polled_sequential_preLN__ssm_conv_s4__glu_gated_swiglu__prompt_kernel_26:
nopoll_sequential_preLN__ssm_conv_s4__glu_gated_swiglu__prompt_kernel_24:
    s_barrier
    s_mov_b32 s40, 2621440
    buffer_load_dwordx4 v[24:27], v21, s[24:27], s40 offen sc1
    s_mov_b32 s40, 0
    buffer_load_dwordx4 v[104:107], v120, s[24:27], s40 offen sc1
    s_mov_b32 s40, 2785280
    buffer_load_dwordx4 v[28:31], v21, s[24:27], s40 offen sc1
    s_mov_b32 s40, 1024
    buffer_load_dwordx4 v[108:111], v120, s[24:27], s40 offen sc1
    s_mov_b32 s40, 2949120
    buffer_load_dwordx4 v[32:35], v21, s[24:27], s40 offen sc1
    s_mov_b32 s40, 2048
    buffer_load_dwordx4 v[112:115], v120, s[24:27], s40 offen sc1
    s_mov_b32 s40, 3112960
    buffer_load_dwordx4 v[36:39], v21, s[24:27], s40 offen sc1
    s_mov_b32 s40, 3072
    buffer_load_dwordx4 v[116:119], v120, s[24:27], s40 offen sc1
    s_waitcnt vmcnt(6)
    v_lshlrev_b32 v56, 16, v24
    v_and_b32 v57, 0xffff0000, v24
    v_lshlrev_b32 v60, 16, v25
    v_and_b32 v61, 0xffff0000, v25
    v_subrev_f32_dpp v56, v104, v56 quad_perm:[0,0,0,0] row_mask:0xf bank_mask:0xf
    v_subrev_f32_dpp v57, v106, v57 quad_perm:[0,0,0,0] row_mask:0xf bank_mask:0xf
    v_subrev_f32_dpp v60, v104, v60 quad_perm:[1,1,1,1] row_mask:0xf bank_mask:0xf
    v_subrev_f32_dpp v61, v106, v61 quad_perm:[1,1,1,1] row_mask:0xf bank_mask:0xf
    v_cvt_pk_bf16_f32 v58, v56, v57
    v_cvt_pk_bf16_f32 v62, v60, v61
    v_lshlrev_b32 v56, 16, v58
    v_and_b32 v57, 0xffff0000, v58
    v_lshlrev_b32 v60, 16, v62
    v_and_b32 v61, 0xffff0000, v62
    v_mul_f32_dpp v56, v105, v56 quad_perm:[0,0,0,0] row_mask:0xf bank_mask:0xf
    v_mul_f32_dpp v57, v107, v57 quad_perm:[0,0,0,0] row_mask:0xf bank_mask:0xf
    v_mul_f32_dpp v60, v105, v60 quad_perm:[1,1,1,1] row_mask:0xf bank_mask:0xf
    v_mul_f32_dpp v61, v107, v61 quad_perm:[1,1,1,1] row_mask:0xf bank_mask:0xf
    v_cvt_pk_bf16_f32 v88, v56, v57
    v_cvt_pk_bf16_f32 v89, v60, v61
    v_lshlrev_b32 v56, 16, v26
    v_and_b32 v57, 0xffff0000, v26
    v_lshlrev_b32 v60, 16, v27
    v_and_b32 v61, 0xffff0000, v27
    v_subrev_f32_dpp v56, v104, v56 quad_perm:[2,2,2,2] row_mask:0xf bank_mask:0xf
    v_subrev_f32_dpp v57, v106, v57 quad_perm:[2,2,2,2] row_mask:0xf bank_mask:0xf
    v_subrev_f32_dpp v60, v104, v60 quad_perm:[3,3,3,3] row_mask:0xf bank_mask:0xf
    v_subrev_f32_dpp v61, v106, v61 quad_perm:[3,3,3,3] row_mask:0xf bank_mask:0xf
    v_cvt_pk_bf16_f32 v58, v56, v57
    v_cvt_pk_bf16_f32 v62, v60, v61
    v_lshlrev_b32 v56, 16, v58
    v_and_b32 v57, 0xffff0000, v58
    v_lshlrev_b32 v60, 16, v62
    v_and_b32 v61, 0xffff0000, v62
    v_mul_f32_dpp v56, v105, v56 quad_perm:[2,2,2,2] row_mask:0xf bank_mask:0xf
    v_mul_f32_dpp v57, v107, v57 quad_perm:[2,2,2,2] row_mask:0xf bank_mask:0xf
    v_mul_f32_dpp v60, v105, v60 quad_perm:[3,3,3,3] row_mask:0xf bank_mask:0xf
    v_mul_f32_dpp v61, v107, v61 quad_perm:[3,3,3,3] row_mask:0xf bank_mask:0xf
    v_cvt_pk_bf16_f32 v90, v56, v57
    v_cvt_pk_bf16_f32 v91, v60, v61
    s_waitcnt vmcnt(4)
    v_lshlrev_b32 v56, 16, v28
    v_and_b32 v57, 0xffff0000, v28
    v_lshlrev_b32 v60, 16, v29
    v_and_b32 v61, 0xffff0000, v29
    v_subrev_f32_dpp v56, v108, v56 quad_perm:[0,0,0,0] row_mask:0xf bank_mask:0xf
    v_subrev_f32_dpp v57, v110, v57 quad_perm:[0,0,0,0] row_mask:0xf bank_mask:0xf
    v_subrev_f32_dpp v60, v108, v60 quad_perm:[1,1,1,1] row_mask:0xf bank_mask:0xf
    v_subrev_f32_dpp v61, v110, v61 quad_perm:[1,1,1,1] row_mask:0xf bank_mask:0xf
    v_cvt_pk_bf16_f32 v58, v56, v57
    v_cvt_pk_bf16_f32 v62, v60, v61
    v_lshlrev_b32 v56, 16, v58
    v_and_b32 v57, 0xffff0000, v58
    v_lshlrev_b32 v60, 16, v62
    v_and_b32 v61, 0xffff0000, v62
    v_mul_f32_dpp v56, v109, v56 quad_perm:[0,0,0,0] row_mask:0xf bank_mask:0xf
    v_mul_f32_dpp v57, v111, v57 quad_perm:[0,0,0,0] row_mask:0xf bank_mask:0xf
    v_mul_f32_dpp v60, v109, v60 quad_perm:[1,1,1,1] row_mask:0xf bank_mask:0xf
    v_mul_f32_dpp v61, v111, v61 quad_perm:[1,1,1,1] row_mask:0xf bank_mask:0xf
    v_cvt_pk_bf16_f32 v92, v56, v57
    v_cvt_pk_bf16_f32 v93, v60, v61
    v_lshlrev_b32 v56, 16, v30
    v_and_b32 v57, 0xffff0000, v30
    v_lshlrev_b32 v60, 16, v31
    v_and_b32 v61, 0xffff0000, v31
    v_subrev_f32_dpp v56, v108, v56 quad_perm:[2,2,2,2] row_mask:0xf bank_mask:0xf
    v_subrev_f32_dpp v57, v110, v57 quad_perm:[2,2,2,2] row_mask:0xf bank_mask:0xf
    v_subrev_f32_dpp v60, v108, v60 quad_perm:[3,3,3,3] row_mask:0xf bank_mask:0xf
    v_subrev_f32_dpp v61, v110, v61 quad_perm:[3,3,3,3] row_mask:0xf bank_mask:0xf
    v_cvt_pk_bf16_f32 v58, v56, v57
    v_cvt_pk_bf16_f32 v62, v60, v61
    v_lshlrev_b32 v56, 16, v58
    v_and_b32 v57, 0xffff0000, v58
    v_lshlrev_b32 v60, 16, v62
    v_and_b32 v61, 0xffff0000, v62
    v_mul_f32_dpp v56, v109, v56 quad_perm:[2,2,2,2] row_mask:0xf bank_mask:0xf
    v_mul_f32_dpp v57, v111, v57 quad_perm:[2,2,2,2] row_mask:0xf bank_mask:0xf
    v_mul_f32_dpp v60, v109, v60 quad_perm:[3,3,3,3] row_mask:0xf bank_mask:0xf
    v_mul_f32_dpp v61, v111, v61 quad_perm:[3,3,3,3] row_mask:0xf bank_mask:0xf
    v_cvt_pk_bf16_f32 v94, v56, v57
    v_cvt_pk_bf16_f32 v95, v60, v61
    s_waitcnt vmcnt(2)
    v_lshlrev_b32 v56, 16, v32
    v_and_b32 v57, 0xffff0000, v32
    v_lshlrev_b32 v60, 16, v33
    v_and_b32 v61, 0xffff0000, v33
    v_subrev_f32_dpp v56, v112, v56 quad_perm:[0,0,0,0] row_mask:0xf bank_mask:0xf
    v_subrev_f32_dpp v57, v114, v57 quad_perm:[0,0,0,0] row_mask:0xf bank_mask:0xf
    v_subrev_f32_dpp v60, v112, v60 quad_perm:[1,1,1,1] row_mask:0xf bank_mask:0xf
    v_subrev_f32_dpp v61, v114, v61 quad_perm:[1,1,1,1] row_mask:0xf bank_mask:0xf
    v_cvt_pk_bf16_f32 v58, v56, v57
    v_cvt_pk_bf16_f32 v62, v60, v61
    v_lshlrev_b32 v56, 16, v58
    v_and_b32 v57, 0xffff0000, v58
    v_lshlrev_b32 v60, 16, v62
    v_and_b32 v61, 0xffff0000, v62
    v_mul_f32_dpp v56, v113, v56 quad_perm:[0,0,0,0] row_mask:0xf bank_mask:0xf
    v_mul_f32_dpp v57, v115, v57 quad_perm:[0,0,0,0] row_mask:0xf bank_mask:0xf
    v_mul_f32_dpp v60, v113, v60 quad_perm:[1,1,1,1] row_mask:0xf bank_mask:0xf
    v_mul_f32_dpp v61, v115, v61 quad_perm:[1,1,1,1] row_mask:0xf bank_mask:0xf
    v_cvt_pk_bf16_f32 v96, v56, v57
    v_cvt_pk_bf16_f32 v97, v60, v61
    v_lshlrev_b32 v56, 16, v34
    v_and_b32 v57, 0xffff0000, v34
    v_lshlrev_b32 v60, 16, v35
    v_and_b32 v61, 0xffff0000, v35
    v_subrev_f32_dpp v56, v112, v56 quad_perm:[2,2,2,2] row_mask:0xf bank_mask:0xf
    v_subrev_f32_dpp v57, v114, v57 quad_perm:[2,2,2,2] row_mask:0xf bank_mask:0xf
    v_subrev_f32_dpp v60, v112, v60 quad_perm:[3,3,3,3] row_mask:0xf bank_mask:0xf
    v_subrev_f32_dpp v61, v114, v61 quad_perm:[3,3,3,3] row_mask:0xf bank_mask:0xf
    v_cvt_pk_bf16_f32 v58, v56, v57
    v_cvt_pk_bf16_f32 v62, v60, v61
    v_lshlrev_b32 v56, 16, v58
    v_and_b32 v57, 0xffff0000, v58
    v_lshlrev_b32 v60, 16, v62
    v_and_b32 v61, 0xffff0000, v62
    v_mul_f32_dpp v56, v113, v56 quad_perm:[2,2,2,2] row_mask:0xf bank_mask:0xf
    v_mul_f32_dpp v57, v115, v57 quad_perm:[2,2,2,2] row_mask:0xf bank_mask:0xf
    v_mul_f32_dpp v60, v113, v60 quad_perm:[3,3,3,3] row_mask:0xf bank_mask:0xf
    v_mul_f32_dpp v61, v115, v61 quad_perm:[3,3,3,3] row_mask:0xf bank_mask:0xf
    v_cvt_pk_bf16_f32 v98, v56, v57
    v_cvt_pk_bf16_f32 v99, v60, v61
    s_waitcnt vmcnt(0)
    v_lshlrev_b32 v56, 16, v36
    v_and_b32 v57, 0xffff0000, v36
    v_lshlrev_b32 v60, 16, v37
    v_and_b32 v61, 0xffff0000, v37
    v_subrev_f32_dpp v56, v116, v56 quad_perm:[0,0,0,0] row_mask:0xf bank_mask:0xf
    v_subrev_f32_dpp v57, v118, v57 quad_perm:[0,0,0,0] row_mask:0xf bank_mask:0xf
    v_subrev_f32_dpp v60, v116, v60 quad_perm:[1,1,1,1] row_mask:0xf bank_mask:0xf
    v_subrev_f32_dpp v61, v118, v61 quad_perm:[1,1,1,1] row_mask:0xf bank_mask:0xf
    v_cvt_pk_bf16_f32 v58, v56, v57
    v_cvt_pk_bf16_f32 v62, v60, v61
    v_lshlrev_b32 v56, 16, v58
    v_and_b32 v57, 0xffff0000, v58
    v_lshlrev_b32 v60, 16, v62
    v_and_b32 v61, 0xffff0000, v62
    v_mul_f32_dpp v56, v117, v56 quad_perm:[0,0,0,0] row_mask:0xf bank_mask:0xf
    v_mul_f32_dpp v57, v119, v57 quad_perm:[0,0,0,0] row_mask:0xf bank_mask:0xf
    v_mul_f32_dpp v60, v117, v60 quad_perm:[1,1,1,1] row_mask:0xf bank_mask:0xf
    v_mul_f32_dpp v61, v119, v61 quad_perm:[1,1,1,1] row_mask:0xf bank_mask:0xf
    v_cvt_pk_bf16_f32 v100, v56, v57
    v_cvt_pk_bf16_f32 v101, v60, v61
    v_lshlrev_b32 v56, 16, v38
    v_and_b32 v57, 0xffff0000, v38
    v_lshlrev_b32 v60, 16, v39
    v_and_b32 v61, 0xffff0000, v39
    v_subrev_f32_dpp v56, v116, v56 quad_perm:[2,2,2,2] row_mask:0xf bank_mask:0xf
    v_subrev_f32_dpp v57, v118, v57 quad_perm:[2,2,2,2] row_mask:0xf bank_mask:0xf
    v_subrev_f32_dpp v60, v116, v60 quad_perm:[3,3,3,3] row_mask:0xf bank_mask:0xf
    v_subrev_f32_dpp v61, v118, v61 quad_perm:[3,3,3,3] row_mask:0xf bank_mask:0xf
    v_cvt_pk_bf16_f32 v58, v56, v57
    v_cvt_pk_bf16_f32 v62, v60, v61
    v_lshlrev_b32 v56, 16, v58
    v_and_b32 v57, 0xffff0000, v58
    v_lshlrev_b32 v60, 16, v62
    v_and_b32 v61, 0xffff0000, v62
    v_mul_f32_dpp v56, v117, v56 quad_perm:[2,2,2,2] row_mask:0xf bank_mask:0xf
    v_mul_f32_dpp v57, v119, v57 quad_perm:[2,2,2,2] row_mask:0xf bank_mask:0xf
    v_mul_f32_dpp v60, v117, v60 quad_perm:[3,3,3,3] row_mask:0xf bank_mask:0xf
    v_mul_f32_dpp v61, v119, v61 quad_perm:[3,3,3,3] row_mask:0xf bank_mask:0xf
    v_cvt_pk_bf16_f32 v102, v56, v57
    v_cvt_pk_bf16_f32 v103, v60, v61
    ds_write_b128 v22, v[88:91] offset:33536
    ds_write_b128 v22, v[92:95] offset:33600
    ds_write_b128 v22, v[96:99] offset:33664
    ds_write_b128 v22, v[100:103] offset:33728
    v_and_b32 v4, 7, v1
    v_sub_u32 v4, 7, v4
    v_mul_u32_u24 v4, 4160, v4
    v_bfe_u32 v5, v1, 3, 1
    v_sub_u32 v5, v3, v5
    v_lshl_add_u32 v4, v5, 4, v4
    v_add_u32 v19, s38, v4
    v_lshrrev_b32 v4, 1, v3
    v_mul_u32_u24 v4, 1280, v4
    v_lshl_add_u32 v4, v2, 4, v4
    v_and_b32 v5, 1, v3
    v_lshl_add_u32 v4, v5, 3, v4
    v_add_u32 v20, s38, v4
    s_waitcnt lgkmcnt(0)
    s_barrier
    v_mov_b32 v40, 0
    v_mov_b32 v41, 0
    v_mov_b32 v42, 0
    v_mov_b32 v43, 0
    v_mov_b32 v44, 0
    v_mov_b32 v45, 0
    v_mov_b32 v46, 0
    v_mov_b32 v47, 0
    v_mov_b32 v48, 0
    v_mov_b32 v49, 0
    v_mov_b32 v50, 0
    v_mov_b32 v51, 0
    v_mov_b32 v52, 0
    v_mov_b32 v53, 0
    v_mov_b32 v54, 0
    v_mov_b32 v55, 0
    v_mov_b32 v56, 0
    v_mov_b32 v57, 0
    v_mov_b32 v58, 0
    v_mov_b32 v59, 0
    v_mov_b32 v60, 0
    v_mov_b32 v61, 0
    v_mov_b32 v62, 0
    v_mov_b32 v63, 0
    v_mov_b32 v64, 0
    v_mov_b32 v65, 0
    v_mov_b32 v66, 0
    v_mov_b32 v67, 0
    v_mov_b32 v68, 0
    v_mov_b32 v69, 0
    v_mov_b32 v70, 0
    v_mov_b32 v71, 0
    ds_read_b128 v[104:107], v19 offset:4080
    ds_read_b128 v[108:111], v19 offset:4048
    ds_read_b128 v[72:75], v18 offset:33536
    ds_read_b128 v[76:79], v18 offset:33792
    ds_read_b128 v[80:83], v18 offset:34048
    ds_read_b128 v[84:87], v18 offset:34304
    ds_read_b128 v[112:115], v19 offset:3056
    ds_read_b128 v[116:119], v19 offset:3024
    ds_read_b128 v[120:123], v19 offset:2032
    ds_read_b128 v[124:127], v19 offset:2000
    ds_read_b128 v[128:131], v19 offset:1008
    ds_read_b128 v[132:135], v19 offset:976
    s_add_u32 s56, s22, 22134784
    s_addc_u32 s57, s23, 0
    s_mov_b32 s58, 16384
    s_mov_b32 s59, 0x20000
    s_cmp_lg_u32 s36, 0
    s_cbranch_scc1 w13arr_sequential_preLN__ssm_conv_s4__glu_gated_swiglu__prompt_kernel_27
    s_cmp_ge_u32 s39, 128
    s_cbranch_scc1 w13arr_sequential_preLN__ssm_conv_s4__glu_gated_swiglu__prompt_kernel_27
    v_mov_b32 v252, 12544
    v_mov_b32 v253, 1
    s_mov_b64 exec, 1
    buffer_atomic_add v253, v252, s[56:59], 0 offen sc0
    s_mov_b64 exec, -1
w13arr_sequential_preLN__ssm_conv_s4__glu_gated_swiglu__prompt_kernel_27:
    s_mov_b32 s44, 4
conv_sequential_preLN__ssm_conv_s4__glu_gated_swiglu__prompt_kernel_28:
    s_waitcnt lgkmcnt(0)
    v_mfma_f32_16x16x32_bf16 v[40:43], v[104:107], v[72:75], v[40:43]
    ds_read_b128 v[136:139], v19 offset:4016
    v_mfma_f32_16x16x32_bf16 v[44:47], v[108:111], v[72:75], v[44:47]
    ds_read_b128 v[140:143], v19 offset:3984
    v_mfma_f32_16x16x32_bf16 v[48:51], v[104:107], v[76:79], v[48:51]
    ds_read_b128 v[88:91], v18 offset:33520
    v_mfma_f32_16x16x32_bf16 v[52:55], v[108:111], v[76:79], v[52:55]
    ds_read_b128 v[92:95], v18 offset:33776
    v_mfma_f32_16x16x32_bf16 v[56:59], v[104:107], v[80:83], v[56:59]
    ds_read_b128 v[96:99], v18 offset:34032
    v_mfma_f32_16x16x32_bf16 v[60:63], v[108:111], v[80:83], v[60:63]
    ds_read_b128 v[100:103], v18 offset:34288
    v_mfma_f32_16x16x32_bf16 v[64:67], v[104:107], v[84:87], v[64:67]
    ds_read_b128 v[144:147], v19 offset:2992
    v_mfma_f32_16x16x32_bf16 v[68:71], v[108:111], v[84:87], v[68:71]
    ds_read_b128 v[148:151], v19 offset:2960
    v_mfma_f32_16x16x32_bf16 v[48:51], v[112:115], v[72:75], v[48:51]
    ds_read_b128 v[152:155], v19 offset:1968
    v_mfma_f32_16x16x32_bf16 v[52:55], v[116:119], v[72:75], v[52:55]
    ds_read_b128 v[156:159], v19 offset:1936
    v_mfma_f32_16x16x32_bf16 v[56:59], v[112:115], v[76:79], v[56:59]
    ds_read_b128 v[160:163], v19 offset:944
    v_mfma_f32_16x16x32_bf16 v[60:63], v[116:119], v[76:79], v[60:63]
    ds_read_b128 v[164:167], v19 offset:912
    v_mfma_f32_16x16x32_bf16 v[64:67], v[112:115], v[80:83], v[64:67]
    v_mfma_f32_16x16x32_bf16 v[68:71], v[116:119], v[80:83], v[68:71]
    v_mfma_f32_16x16x32_bf16 v[56:59], v[120:123], v[72:75], v[56:59]
    v_mfma_f32_16x16x32_bf16 v[60:63], v[124:127], v[72:75], v[60:63]
    v_mfma_f32_16x16x32_bf16 v[64:67], v[120:123], v[76:79], v[64:67]
    v_mfma_f32_16x16x32_bf16 v[68:71], v[124:127], v[76:79], v[68:71]
    v_mfma_f32_16x16x32_bf16 v[64:67], v[128:131], v[72:75], v[64:67]
    v_mfma_f32_16x16x32_bf16 v[68:71], v[132:135], v[72:75], v[68:71]
    s_waitcnt lgkmcnt(0)
    v_mfma_f32_16x16x32_bf16 v[40:43], v[136:139], v[88:91], v[40:43]
    ds_read_b128 v[104:107], v19 offset:3952
    v_mfma_f32_16x16x32_bf16 v[44:47], v[140:143], v[88:91], v[44:47]
    ds_read_b128 v[108:111], v19 offset:3920
    v_mfma_f32_16x16x32_bf16 v[48:51], v[136:139], v[92:95], v[48:51]
    ds_read_b128 v[72:75], v18 offset:33504
    v_mfma_f32_16x16x32_bf16 v[52:55], v[140:143], v[92:95], v[52:55]
    ds_read_b128 v[76:79], v18 offset:33760
    v_mfma_f32_16x16x32_bf16 v[56:59], v[136:139], v[96:99], v[56:59]
    ds_read_b128 v[80:83], v18 offset:34016
    v_mfma_f32_16x16x32_bf16 v[60:63], v[140:143], v[96:99], v[60:63]
    ds_read_b128 v[84:87], v18 offset:34272
    v_mfma_f32_16x16x32_bf16 v[64:67], v[136:139], v[100:103], v[64:67]
    ds_read_b128 v[112:115], v19 offset:2928
    v_mfma_f32_16x16x32_bf16 v[68:71], v[140:143], v[100:103], v[68:71]
    ds_read_b128 v[116:119], v19 offset:2896
    v_mfma_f32_16x16x32_bf16 v[48:51], v[144:147], v[88:91], v[48:51]
    ds_read_b128 v[120:123], v19 offset:1904
    v_mfma_f32_16x16x32_bf16 v[52:55], v[148:151], v[88:91], v[52:55]
    ds_read_b128 v[124:127], v19 offset:1872
    v_mfma_f32_16x16x32_bf16 v[56:59], v[144:147], v[92:95], v[56:59]
    ds_read_b128 v[128:131], v19 offset:880
    v_mfma_f32_16x16x32_bf16 v[60:63], v[148:151], v[92:95], v[60:63]
    ds_read_b128 v[132:135], v19 offset:848
    v_mfma_f32_16x16x32_bf16 v[64:67], v[144:147], v[96:99], v[64:67]
    v_mfma_f32_16x16x32_bf16 v[68:71], v[148:151], v[96:99], v[68:71]
    v_mfma_f32_16x16x32_bf16 v[56:59], v[152:155], v[88:91], v[56:59]
    v_mfma_f32_16x16x32_bf16 v[60:63], v[156:159], v[88:91], v[60:63]
    v_mfma_f32_16x16x32_bf16 v[64:67], v[152:155], v[92:95], v[64:67]
    v_mfma_f32_16x16x32_bf16 v[68:71], v[156:159], v[92:95], v[68:71]
    v_mfma_f32_16x16x32_bf16 v[64:67], v[160:163], v[88:91], v[64:67]
    v_mfma_f32_16x16x32_bf16 v[68:71], v[164:167], v[88:91], v[68:71]
    v_subrev_u32 v18, 32, v18
    v_subrev_u32 v19, 128, v19
    s_sub_u32 s44, s44, 1
    s_cmp_lg_u32 s44, 0
    s_cbranch_scc1 conv_sequential_preLN__ssm_conv_s4__glu_gated_swiglu__prompt_kernel_28
    s_waitcnt vmcnt(0)
    s_cmp_lg_u32 s36, 0
    s_cbranch_scc1 w13flag_sequential_preLN__ssm_conv_s4__glu_gated_swiglu__prompt_kernel_29
    s_cmp_ge_u32 s39, 128
    s_cbranch_scc1 w13flag_sequential_preLN__ssm_conv_s4__glu_gated_swiglu__prompt_kernel_29
    v_readfirstlane_b32 s45, v253
    s_nop 1
    s_cmp_lg_u32 s45, 127
    s_cbranch_scc1 w13flag_sequential_preLN__ssm_conv_s4__glu_gated_swiglu__prompt_kernel_29
    v_mov_b32 v252, 12672
    v_mov_b32 v253, 1
    s_mov_b64 exec, 1
    buffer_store_dword v253, v252, s[56:59], 0 offen sc1
    s_mov_b64 exec, -1
w13flag_sequential_preLN__ssm_conv_s4__glu_gated_swiglu__prompt_kernel_29:
    s_mov_b32 s44, 4
conv_sequential_preLN__ssm_conv_s4__glu_gated_swiglu__prompt_kernel_30:
    s_waitcnt lgkmcnt(0)
    v_mfma_f32_16x16x32_bf16 v[40:43], v[104:107], v[72:75], v[40:43]
    ds_read_b128 v[136:139], v19 offset:4016
    v_mfma_f32_16x16x32_bf16 v[44:47], v[108:111], v[72:75], v[44:47]
    ds_read_b128 v[140:143], v19 offset:3984
    v_mfma_f32_16x16x32_bf16 v[48:51], v[104:107], v[76:79], v[48:51]
    ds_read_b128 v[88:91], v18 offset:33520
    v_mfma_f32_16x16x32_bf16 v[52:55], v[108:111], v[76:79], v[52:55]
    ds_read_b128 v[92:95], v18 offset:33776
    v_mfma_f32_16x16x32_bf16 v[56:59], v[104:107], v[80:83], v[56:59]
    ds_read_b128 v[96:99], v18 offset:34032
    v_mfma_f32_16x16x32_bf16 v[60:63], v[108:111], v[80:83], v[60:63]
    ds_read_b128 v[100:103], v18 offset:34288
    v_mfma_f32_16x16x32_bf16 v[64:67], v[104:107], v[84:87], v[64:67]
    ds_read_b128 v[144:147], v19 offset:2992
    v_mfma_f32_16x16x32_bf16 v[68:71], v[108:111], v[84:87], v[68:71]
    ds_read_b128 v[148:151], v19 offset:2960
    v_mfma_f32_16x16x32_bf16 v[48:51], v[112:115], v[72:75], v[48:51]
    ds_read_b128 v[152:155], v19 offset:1968
    v_mfma_f32_16x16x32_bf16 v[52:55], v[116:119], v[72:75], v[52:55]
    ds_read_b128 v[156:159], v19 offset:1936
    v_mfma_f32_16x16x32_bf16 v[56:59], v[112:115], v[76:79], v[56:59]
    ds_read_b128 v[160:163], v19 offset:944
    v_mfma_f32_16x16x32_bf16 v[60:63], v[116:119], v[76:79], v[60:63]
    ds_read_b128 v[164:167], v19 offset:912
    v_mfma_f32_16x16x32_bf16 v[64:67], v[112:115], v[80:83], v[64:67]
    v_mfma_f32_16x16x32_bf16 v[68:71], v[116:119], v[80:83], v[68:71]
    v_mfma_f32_16x16x32_bf16 v[56:59], v[120:123], v[72:75], v[56:59]
    v_mfma_f32_16x16x32_bf16 v[60:63], v[124:127], v[72:75], v[60:63]
    v_mfma_f32_16x16x32_bf16 v[64:67], v[120:123], v[76:79], v[64:67]
    v_mfma_f32_16x16x32_bf16 v[68:71], v[124:127], v[76:79], v[68:71]
    v_mfma_f32_16x16x32_bf16 v[64:67], v[128:131], v[72:75], v[64:67]
    v_mfma_f32_16x16x32_bf16 v[68:71], v[132:135], v[72:75], v[68:71]
    s_waitcnt lgkmcnt(0)
    v_mfma_f32_16x16x32_bf16 v[40:43], v[136:139], v[88:91], v[40:43]
    ds_read_b128 v[104:107], v19 offset:3952
    v_mfma_f32_16x16x32_bf16 v[44:47], v[140:143], v[88:91], v[44:47]
    ds_read_b128 v[108:111], v19 offset:3920
    v_mfma_f32_16x16x32_bf16 v[48:51], v[136:139], v[92:95], v[48:51]
    ds_read_b128 v[72:75], v18 offset:33504
    v_mfma_f32_16x16x32_bf16 v[52:55], v[140:143], v[92:95], v[52:55]
    ds_read_b128 v[76:79], v18 offset:33760
    v_mfma_f32_16x16x32_bf16 v[56:59], v[136:139], v[96:99], v[56:59]
    ds_read_b128 v[80:83], v18 offset:34016
    v_mfma_f32_16x16x32_bf16 v[60:63], v[140:143], v[96:99], v[60:63]
    ds_read_b128 v[84:87], v18 offset:34272
    v_mfma_f32_16x16x32_bf16 v[64:67], v[136:139], v[100:103], v[64:67]
    ds_read_b128 v[112:115], v19 offset:2928
    v_mfma_f32_16x16x32_bf16 v[68:71], v[140:143], v[100:103], v[68:71]
    ds_read_b128 v[116:119], v19 offset:2896
    v_mfma_f32_16x16x32_bf16 v[48:51], v[144:147], v[88:91], v[48:51]
    ds_read_b128 v[120:123], v19 offset:1904
    v_mfma_f32_16x16x32_bf16 v[52:55], v[148:151], v[88:91], v[52:55]
    ds_read_b128 v[124:127], v19 offset:1872
    v_mfma_f32_16x16x32_bf16 v[56:59], v[144:147], v[92:95], v[56:59]
    ds_read_b128 v[128:131], v19 offset:880
    v_mfma_f32_16x16x32_bf16 v[60:63], v[148:151], v[92:95], v[60:63]
    ds_read_b128 v[132:135], v19 offset:848
    v_mfma_f32_16x16x32_bf16 v[64:67], v[144:147], v[96:99], v[64:67]
    v_mfma_f32_16x16x32_bf16 v[68:71], v[148:151], v[96:99], v[68:71]
    v_mfma_f32_16x16x32_bf16 v[56:59], v[152:155], v[88:91], v[56:59]
    v_mfma_f32_16x16x32_bf16 v[60:63], v[156:159], v[88:91], v[60:63]
    v_mfma_f32_16x16x32_bf16 v[64:67], v[152:155], v[92:95], v[64:67]
    v_mfma_f32_16x16x32_bf16 v[68:71], v[156:159], v[92:95], v[68:71]
    v_mfma_f32_16x16x32_bf16 v[64:67], v[160:163], v[88:91], v[64:67]
    v_mfma_f32_16x16x32_bf16 v[68:71], v[164:167], v[88:91], v[68:71]
    v_subrev_u32 v18, 32, v18
    v_subrev_u32 v19, 128, v19
    s_sub_u32 s44, s44, 1
    s_cmp_lg_u32 s44, 0
    s_cbranch_scc1 conv_sequential_preLN__ssm_conv_s4__glu_gated_swiglu__prompt_kernel_30
    s_waitcnt vmcnt(0) lgkmcnt(0)
    s_barrier
    ds_write_b128 v23, v[24:27] offset:8192
    ds_write_b128 v23, v[28:31] offset:8256
    ds_write_b128 v23, v[32:35] offset:8320
    ds_write_b128 v23, v[36:39] offset:8384
    s_waitcnt lgkmcnt(0)
    s_barrier
    v_lshrrev_b32 v4, 1, v3
    v_and_b32 v5, 1, v3
    v_lshlrev_b32 v5, 3, v5
    v_lshl_add_u32 v5, v2, 4, v5
    v_add_u32 v5, s38, v5
    v_lshl_add_u32 v6, v4, 10, v5
    v_mul_u32_u24 v4, 1088, v4
    v_add_u32 v7, v4, v5
    ds_read_b64 v[72:73], v20 offset:33536
    ds_read_b64 v[88:89], v6 offset:8192
    ds_read_b64 v[74:75], v20 offset:36096
    ds_read_b64 v[90:91], v6 offset:10240
    ds_read_b64 v[76:77], v20 offset:33792
    ds_read_b64 v[92:93], v6 offset:8448
    ds_read_b64 v[78:79], v20 offset:36352
    ds_read_b64 v[94:95], v6 offset:10496
    ds_read_b64 v[80:81], v20 offset:34048
    ds_read_b64 v[96:97], v6 offset:8704
    ds_read_b64 v[82:83], v20 offset:36608
    ds_read_b64 v[98:99], v6 offset:10752
    ds_read_b64 v[84:85], v20 offset:34304
    ds_read_b64 v[100:101], v6 offset:8960
    ds_read_b64 v[86:87], v20 offset:36864
    ds_read_b64 v[102:103], v6 offset:11008
    s_waitcnt lgkmcnt(0)
    v_lshlrev_b32 v136, 16, v72
    v_and_b32 v137, 0xffff0000, v72
    v_lshlrev_b32 v138, 16, v88
    v_and_b32 v139, 0xffff0000, v88
    v_fmac_f32 v40, v136, v9
    v_fmac_f32 v41, v137, v9
    v_add_f32 v40, v40, v138
    v_add_f32 v41, v41, v139
    v_cvt_pk_bf16_f32 v104, v40, v41
    v_lshlrev_b32 v136, 16, v73
    v_and_b32 v137, 0xffff0000, v73
    v_lshlrev_b32 v138, 16, v89
    v_and_b32 v139, 0xffff0000, v89
    v_fmac_f32 v42, v136, v9
    v_fmac_f32 v43, v137, v9
    v_add_f32 v42, v42, v138
    v_add_f32 v43, v43, v139
    v_cvt_pk_bf16_f32 v105, v42, v43
    ds_write_b64 v7, v[104:105] offset:0
    v_lshlrev_b32 v140, 16, v74
    v_and_b32 v141, 0xffff0000, v74
    v_lshlrev_b32 v142, 16, v90
    v_and_b32 v143, 0xffff0000, v90
    v_fmac_f32 v44, v140, v9
    v_fmac_f32 v45, v141, v9
    v_add_f32 v44, v44, v142
    v_add_f32 v45, v45, v143
    v_cvt_pk_bf16_f32 v108, v44, v45
    v_lshlrev_b32 v140, 16, v75
    v_and_b32 v141, 0xffff0000, v75
    v_lshlrev_b32 v142, 16, v91
    v_and_b32 v143, 0xffff0000, v91
    v_fmac_f32 v46, v140, v9
    v_fmac_f32 v47, v141, v9
    v_add_f32 v46, v46, v142
    v_add_f32 v47, v47, v143
    v_cvt_pk_bf16_f32 v109, v46, v47
    ds_write_b64 v7, v[108:109] offset:2176
    v_lshlrev_b32 v136, 16, v76
    v_and_b32 v137, 0xffff0000, v76
    v_lshlrev_b32 v138, 16, v92
    v_and_b32 v139, 0xffff0000, v92
    v_fmac_f32 v48, v136, v9
    v_fmac_f32 v49, v137, v9
    v_add_f32 v48, v48, v138
    v_add_f32 v49, v49, v139
    v_cvt_pk_bf16_f32 v112, v48, v49
    v_lshlrev_b32 v136, 16, v77
    v_and_b32 v137, 0xffff0000, v77
    v_lshlrev_b32 v138, 16, v93
    v_and_b32 v139, 0xffff0000, v93
    v_fmac_f32 v50, v136, v9
    v_fmac_f32 v51, v137, v9
    v_add_f32 v50, v50, v138
    v_add_f32 v51, v51, v139
    v_cvt_pk_bf16_f32 v113, v50, v51
    ds_write_b64 v7, v[112:113] offset:256
    v_lshlrev_b32 v140, 16, v78
    v_and_b32 v141, 0xffff0000, v78
    v_lshlrev_b32 v142, 16, v94
    v_and_b32 v143, 0xffff0000, v94
    v_fmac_f32 v52, v140, v9
    v_fmac_f32 v53, v141, v9
    v_add_f32 v52, v52, v142
    v_add_f32 v53, v53, v143
    v_cvt_pk_bf16_f32 v116, v52, v53
    v_lshlrev_b32 v140, 16, v79
    v_and_b32 v141, 0xffff0000, v79
    v_lshlrev_b32 v142, 16, v95
    v_and_b32 v143, 0xffff0000, v95
    v_fmac_f32 v54, v140, v9
    v_fmac_f32 v55, v141, v9
    v_add_f32 v54, v54, v142
    v_add_f32 v55, v55, v143
    v_cvt_pk_bf16_f32 v117, v54, v55
    ds_write_b64 v7, v[116:117] offset:2432
    v_lshlrev_b32 v136, 16, v80
    v_and_b32 v137, 0xffff0000, v80
    v_lshlrev_b32 v138, 16, v96
    v_and_b32 v139, 0xffff0000, v96
    v_fmac_f32 v56, v136, v9
    v_fmac_f32 v57, v137, v9
    v_add_f32 v56, v56, v138
    v_add_f32 v57, v57, v139
    v_cvt_pk_bf16_f32 v120, v56, v57
    v_lshlrev_b32 v136, 16, v81
    v_and_b32 v137, 0xffff0000, v81
    v_lshlrev_b32 v138, 16, v97
    v_and_b32 v139, 0xffff0000, v97
    v_fmac_f32 v58, v136, v9
    v_fmac_f32 v59, v137, v9
    v_add_f32 v58, v58, v138
    v_add_f32 v59, v59, v139
    v_cvt_pk_bf16_f32 v121, v58, v59
    ds_write_b64 v7, v[120:121] offset:512
    v_lshlrev_b32 v140, 16, v82
    v_and_b32 v141, 0xffff0000, v82
    v_lshlrev_b32 v142, 16, v98
    v_and_b32 v143, 0xffff0000, v98
    v_fmac_f32 v60, v140, v9
    v_fmac_f32 v61, v141, v9
    v_add_f32 v60, v60, v142
    v_add_f32 v61, v61, v143
    v_cvt_pk_bf16_f32 v124, v60, v61
    v_lshlrev_b32 v140, 16, v83
    v_and_b32 v141, 0xffff0000, v83
    v_lshlrev_b32 v142, 16, v99
    v_and_b32 v143, 0xffff0000, v99
    v_fmac_f32 v62, v140, v9
    v_fmac_f32 v63, v141, v9
    v_add_f32 v62, v62, v142
    v_add_f32 v63, v63, v143
    v_cvt_pk_bf16_f32 v125, v62, v63
    ds_write_b64 v7, v[124:125] offset:2688
    v_lshlrev_b32 v136, 16, v84
    v_and_b32 v137, 0xffff0000, v84
    v_lshlrev_b32 v138, 16, v100
    v_and_b32 v139, 0xffff0000, v100
    v_fmac_f32 v64, v136, v9
    v_fmac_f32 v65, v137, v9
    v_add_f32 v64, v64, v138
    v_add_f32 v65, v65, v139
    v_cvt_pk_bf16_f32 v128, v64, v65
    v_lshlrev_b32 v136, 16, v85
    v_and_b32 v137, 0xffff0000, v85
    v_lshlrev_b32 v138, 16, v101
    v_and_b32 v139, 0xffff0000, v101
    v_fmac_f32 v66, v136, v9
    v_fmac_f32 v67, v137, v9
    v_add_f32 v66, v66, v138
    v_add_f32 v67, v67, v139
    v_cvt_pk_bf16_f32 v129, v66, v67
    ds_write_b64 v7, v[128:129] offset:768
    v_lshlrev_b32 v140, 16, v86
    v_and_b32 v141, 0xffff0000, v86
    v_lshlrev_b32 v142, 16, v102
    v_and_b32 v143, 0xffff0000, v102
    v_fmac_f32 v68, v140, v9
    v_fmac_f32 v69, v141, v9
    v_add_f32 v68, v68, v142
    v_add_f32 v69, v69, v143
    v_cvt_pk_bf16_f32 v132, v68, v69
    v_lshlrev_b32 v140, 16, v87
    v_and_b32 v141, 0xffff0000, v87
    v_lshlrev_b32 v142, 16, v103
    v_and_b32 v143, 0xffff0000, v103
    v_fmac_f32 v70, v140, v9
    v_fmac_f32 v71, v141, v9
    v_add_f32 v70, v70, v142
    v_add_f32 v71, v71, v143
    v_cvt_pk_bf16_f32 v133, v70, v71
    ds_write_b64 v7, v[132:133] offset:2944
    v_and_b32 v4, 3, v1
    v_mul_u32_u24 v4, 1088, v4
    v_lshrrev_b32 v5, 2, v1
    v_lshl_add_u32 v4, v5, 4, v4
    v_add_u32 v4, s38, v4
    s_lshl_b32 s40, s37, 12
    v_lshl_add_u32 v16, v1, 4, s40
    s_waitcnt lgkmcnt(0)
    ds_read_b128 v[104:107], v4 offset:0
    ds_read_b128 v[108:111], v4 offset:256
    ds_read_b128 v[112:115], v4 offset:512
    ds_read_b128 v[116:119], v4 offset:768
    s_waitcnt lgkmcnt(3)
    buffer_store_dwordx4 v[104:107], v16, s[28:31], 0 offen offset:0 sc1
    s_waitcnt lgkmcnt(2)
    buffer_store_dwordx4 v[108:111], v16, s[28:31], 0 offen offset:1024 sc1
    s_waitcnt lgkmcnt(1)
    buffer_store_dwordx4 v[112:115], v16, s[28:31], 0 offen offset:2048 sc1
    s_waitcnt lgkmcnt(0)
    buffer_store_dwordx4 v[116:119], v16, s[28:31], 0 offen offset:3072 sc1
    s_add_u32 s56, s22, 22134784
    s_addc_u32 s57, s23, 0
    s_mov_b32 s58, 16384
    s_mov_b32 s59, 0x20000
    s_waitcnt vmcnt(0)
    s_barrier
    s_lshr_b32 s40, s39, 4
    s_add_u32 s40, s40, 64
    s_cmp_lg_u32 s36, 0
    s_cbranch_scc1 arr_sequential_preLN__ssm_conv_s4__glu_gated_swiglu__prompt_kernel_31
    s_lshl_b32 s45, s40, 7
    v_mov_b32 v4, s45
    v_mov_b32 v5, 1
    s_mov_b64 exec, 1
    buffer_atomic_add v5, v4, s[56:59], 0 offen sc0
    s_waitcnt vmcnt(0)
    v_readfirstlane_b32 s46, v5
    s_nop 1
    s_cmp_lg_u32 s46, 15
    s_cbranch_scc1 arr_notlast_sequential_preLN__ssm_conv_s4__glu_gated_swiglu__prompt_kernel_32
    s_add_u32 s45, s45, 2048
    v_mov_b32 v4, s45
    v_mov_b32 v5, 1
    buffer_store_dword v5, v4, s[56:59], 0 offen sc1
arr_notlast_sequential_preLN__ssm_conv_s4__glu_gated_swiglu__prompt_kernel_32:
    s_mov_b64 exec, -1
arr_sequential_preLN__ssm_conv_s4__glu_gated_swiglu__prompt_kernel_31:
    s_branch ffn_sequential_preLN__ssm_conv_s4__glu_gated_swiglu__prompt_kernel_2
comp_w13_sequential_preLN__ssm_conv_s4__glu_gated_swiglu__prompt_kernel_9:
    s_load_dwordx4 s[4:7], s[0:1], 80
    s_sub_u32 s39, s2, 96
    s_sub_u32 s70, s36, 4
    s_mov_b32 s22, s50
    s_mov_b32 s23, s51
    s_add_u32 s24, s22, 15335424
    s_addc_u32 s25, s23, 0
    s_mov_b32 s26, 4587520
    s_mov_b32 s27, 0x20000
    s_add_u32 s52, s22, 14942208
    s_addc_u32 s53, s23, 0
    s_mov_b32 s54, 114688
    s_mov_b32 s55, 0x20000
    s_waitcnt lgkmcnt(0)
    s_barrier
    s_lshr_b32 s64, s39, 3
    s_and_b32 s66, s39, 7
    s_mul_i32 s42, s64, 27
    s_lshr_b32 s42, s42, 1
    v_and_b32 v1, 63, v0
    v_mul_u32_u24 v4, 2341, v1
    v_lshrrev_b32 v2, 16, v4
    v_mul_u32_u24 v4, 28, v2
    v_sub_u32 v3, v1, v4
    s_mul_i32 s43, s66, 80
    s_mul_i32 s44, s70, 20
    s_add_u32 s43, s43, s44
    v_add_u32 v4, s43, v2
    v_mul_u32_u24 v5, 3456, v4
    s_lshl_b32 s44, s42, 4
    v_lshl_add_u32 v5, v3, 3, v5
    v_add_u32 v7, s44, v5
    v_mul_u32_u24 v5, 448, v4
    s_mul_i32 s44, s64, 286720
    v_add_u32 v5, s44, v5
    v_lshrrev_b32 v6, 1, v3
    v_and_b32 v4, 1, v3
    v_lshl_add_u32 v5, v4, 4, v5
    s_and_b32 s65, s70, 1
    s_xor_b32 s44, s65, 0
    v_xor_b32 v4, s44, v6
    v_lshl_add_u32 v8, v4, 5, v5
    s_xor_b32 s44, s65, 1
    v_xor_b32 v4, s44, v6
    v_lshl_add_u32 v9, v4, 5, v5
    v_mov_b32 v10, 0x00003f80
    v_mov_b32 v11, 0x3f800000
    v_mov_b32 v12, 0
    v_mov_b32 v13, 0
    v_mov_b32 v14, 0
    v_mov_b32 v15, 0
    v_mov_b32 v16, 0
    v_mov_b32 v17, 0
    v_mov_b32 v18, 0
    v_mov_b32 v19, 0
    s_mov_b32 exec_lo, -1
    s_mov_b32 exec_hi, 0x00ffffff
    global_load_dwordx2 v[20:21], v7, s[4:5]
    global_load_dwordx2 v[22:23], v7, s[6:7]
    v_add_u32 v7, 6912, v7
    global_load_dwordx2 v[24:25], v7, s[4:5]
    global_load_dwordx2 v[26:27], v7, s[6:7]
    v_add_u32 v7, 6912, v7
    global_load_dwordx2 v[28:29], v7, s[4:5]
    global_load_dwordx2 v[30:31], v7, s[6:7]
    v_add_u32 v7, 6912, v7
    global_load_dwordx2 v[32:33], v7, s[4:5]
    global_load_dwordx2 v[34:35], v7, s[6:7]
    v_add_u32 v7, 6912, v7
    global_load_dwordx2 v[36:37], v7, s[4:5]
    global_load_dwordx2 v[38:39], v7, s[6:7]
    v_add_u32 v7, 6912, v7
    global_load_dwordx2 v[40:41], v7, s[4:5]
    global_load_dwordx2 v[42:43], v7, s[6:7]
    v_add_u32 v7, 6912, v7
    global_load_dwordx2 v[44:45], v7, s[4:5]
    global_load_dwordx2 v[46:47], v7, s[6:7]
    v_add_u32 v7, 6912, v7
    global_load_dwordx2 v[48:49], v7, s[4:5]
    global_load_dwordx2 v[50:51], v7, s[6:7]
    v_add_u32 v7, 6912, v7
    global_load_dwordx2 v[52:53], v7, s[4:5]
    global_load_dwordx2 v[54:55], v7, s[6:7]
    v_add_u32 v7, 6912, v7
    global_load_dwordx2 v[56:57], v7, s[4:5]
    global_load_dwordx2 v[58:59], v7, s[6:7]
    v_add_u32 v7, 6912, v7
    s_mov_b64 exec, -1
    s_mov_b32 exec_lo, -1
    s_mov_b32 exec_hi, 0x00ffffff
    s_waitcnt vmcnt(18)
    v_dot2_f32_bf16 v12, v20, v10, v12
    v_dot2_f32_bf16 v13, v20, v11, v13
    v_dot2_f32_bf16 v14, v22, v10, v14
    v_dot2_f32_bf16 v15, v22, v11, v15
    v_dot2_f32_bf16 v16, v21, v10, v16
    v_dot2_f32_bf16 v17, v21, v11, v17
    v_dot2_f32_bf16 v18, v23, v10, v18
    v_dot2_f32_bf16 v19, v23, v11, v19
    v_swap_b32 v21, v22
    s_mov_b32 s47, 0
    buffer_store_dwordx4 v[20:23], v8, s[24:27], s47 offen sc1
    s_waitcnt vmcnt(17)
    v_dot2_f32_bf16 v12, v24, v10, v12
    v_dot2_f32_bf16 v13, v24, v11, v13
    v_dot2_f32_bf16 v14, v26, v10, v14
    v_dot2_f32_bf16 v15, v26, v11, v15
    v_dot2_f32_bf16 v16, v25, v10, v16
    v_dot2_f32_bf16 v17, v25, v11, v17
    v_dot2_f32_bf16 v18, v27, v10, v18
    v_dot2_f32_bf16 v19, v27, v11, v19
    v_swap_b32 v25, v26
    s_mov_b32 s47, 896
    buffer_store_dwordx4 v[24:27], v8, s[24:27], s47 offen sc1
    s_waitcnt vmcnt(16)
    v_dot2_f32_bf16 v12, v28, v10, v12
    v_dot2_f32_bf16 v13, v28, v11, v13
    v_dot2_f32_bf16 v14, v30, v10, v14
    v_dot2_f32_bf16 v15, v30, v11, v15
    v_dot2_f32_bf16 v16, v29, v10, v16
    v_dot2_f32_bf16 v17, v29, v11, v17
    v_dot2_f32_bf16 v18, v31, v10, v18
    v_dot2_f32_bf16 v19, v31, v11, v19
    v_swap_b32 v29, v30
    s_mov_b32 s47, 1792
    buffer_store_dwordx4 v[28:31], v9, s[24:27], s47 offen sc1
    s_waitcnt vmcnt(15)
    v_dot2_f32_bf16 v12, v32, v10, v12
    v_dot2_f32_bf16 v13, v32, v11, v13
    v_dot2_f32_bf16 v14, v34, v10, v14
    v_dot2_f32_bf16 v15, v34, v11, v15
    v_dot2_f32_bf16 v16, v33, v10, v16
    v_dot2_f32_bf16 v17, v33, v11, v17
    v_dot2_f32_bf16 v18, v35, v10, v18
    v_dot2_f32_bf16 v19, v35, v11, v19
    v_swap_b32 v33, v34
    s_mov_b32 s47, 2688
    buffer_store_dwordx4 v[32:35], v9, s[24:27], s47 offen sc1
    s_waitcnt vmcnt(14)
    v_dot2_f32_bf16 v12, v36, v10, v12
    v_dot2_f32_bf16 v13, v36, v11, v13
    v_dot2_f32_bf16 v14, v38, v10, v14
    v_dot2_f32_bf16 v15, v38, v11, v15
    v_dot2_f32_bf16 v16, v37, v10, v16
    v_dot2_f32_bf16 v17, v37, v11, v17
    v_dot2_f32_bf16 v18, v39, v10, v18
    v_dot2_f32_bf16 v19, v39, v11, v19
    v_swap_b32 v37, v38
    s_mov_b32 s47, 3584
    buffer_store_dwordx4 v[36:39], v8, s[24:27], s47 offen sc1
    s_waitcnt vmcnt(13)
    v_dot2_f32_bf16 v12, v40, v10, v12
    v_dot2_f32_bf16 v13, v40, v11, v13
    v_dot2_f32_bf16 v14, v42, v10, v14
    v_dot2_f32_bf16 v15, v42, v11, v15
    v_dot2_f32_bf16 v16, v41, v10, v16
    v_dot2_f32_bf16 v17, v41, v11, v17
    v_dot2_f32_bf16 v18, v43, v10, v18
    v_dot2_f32_bf16 v19, v43, v11, v19
    v_swap_b32 v41, v42
    s_mov_b32 s47, 4480
    buffer_store_dwordx4 v[40:43], v8, s[24:27], s47 offen sc1
    s_waitcnt vmcnt(12)
    v_dot2_f32_bf16 v12, v44, v10, v12
    v_dot2_f32_bf16 v13, v44, v11, v13
    v_dot2_f32_bf16 v14, v46, v10, v14
    v_dot2_f32_bf16 v15, v46, v11, v15
    v_dot2_f32_bf16 v16, v45, v10, v16
    v_dot2_f32_bf16 v17, v45, v11, v17
    v_dot2_f32_bf16 v18, v47, v10, v18
    v_dot2_f32_bf16 v19, v47, v11, v19
    v_swap_b32 v45, v46
    s_mov_b32 s47, 5376
    buffer_store_dwordx4 v[44:47], v9, s[24:27], s47 offen sc1
    s_waitcnt vmcnt(11)
    v_dot2_f32_bf16 v12, v48, v10, v12
    v_dot2_f32_bf16 v13, v48, v11, v13
    v_dot2_f32_bf16 v14, v50, v10, v14
    v_dot2_f32_bf16 v15, v50, v11, v15
    v_dot2_f32_bf16 v16, v49, v10, v16
    v_dot2_f32_bf16 v17, v49, v11, v17
    v_dot2_f32_bf16 v18, v51, v10, v18
    v_dot2_f32_bf16 v19, v51, v11, v19
    v_swap_b32 v49, v50
    s_mov_b32 s47, 6272
    buffer_store_dwordx4 v[48:51], v9, s[24:27], s47 offen sc1
    s_waitcnt vmcnt(10)
    v_dot2_f32_bf16 v12, v52, v10, v12
    v_dot2_f32_bf16 v13, v52, v11, v13
    v_dot2_f32_bf16 v14, v54, v10, v14
    v_dot2_f32_bf16 v15, v54, v11, v15
    v_dot2_f32_bf16 v16, v53, v10, v16
    v_dot2_f32_bf16 v17, v53, v11, v17
    v_dot2_f32_bf16 v18, v55, v10, v18
    v_dot2_f32_bf16 v19, v55, v11, v19
    v_swap_b32 v53, v54
    s_mov_b32 s47, 7168
    buffer_store_dwordx4 v[52:55], v8, s[24:27], s47 offen sc1
    s_waitcnt vmcnt(9)
    v_dot2_f32_bf16 v12, v56, v10, v12
    v_dot2_f32_bf16 v13, v56, v11, v13
    v_dot2_f32_bf16 v14, v58, v10, v14
    v_dot2_f32_bf16 v15, v58, v11, v15
    v_dot2_f32_bf16 v16, v57, v10, v16
    v_dot2_f32_bf16 v17, v57, v11, v17
    v_dot2_f32_bf16 v18, v59, v10, v18
    v_dot2_f32_bf16 v19, v59, v11, v19
    v_swap_b32 v57, v58
    s_mov_b32 s47, 8064
    buffer_store_dwordx4 v[56:59], v8, s[24:27], s47 offen sc1
    v_lshlrev_b32 v4, 5, v1
    s_mul_i32 s44, s70, 1792
    s_add_u32 s44, s44, 153728
    v_add_u32 v4, s44, v4
    s_nop 1
    v_mov_b32 v24, v12
    v_mov_b32 v25, v13
    v_mov_b32 v26, v14
    v_mov_b32 v27, v15
    ds_write_b128 v4, v[24:27] offset:0
    v_mov_b32 v28, v16
    v_mov_b32 v29, v17
    v_mov_b32 v30, v18
    v_mov_b32 v31, v19
    ds_write_b128 v4, v[28:31] offset:16
    s_mov_b64 exec, -1
    s_waitcnt lgkmcnt(0)
    s_barrier
    v_subrev_u32 v6, 256, v0
    v_lshlrev_b32 v4, 2, v6
    v_add_u32 v5, 153728, v4
    ds_read_b32 v32, v5 offset:0
    ds_read_b32 v33, v5 offset:896
    ds_read_b32 v34, v5 offset:1792
    ds_read_b32 v35, v5 offset:2688
    ds_read_b32 v36, v5 offset:3584
    ds_read_b32 v37, v5 offset:4480
    ds_read_b32 v38, v5 offset:5376
    ds_read_b32 v39, v5 offset:6272
    s_waitcnt lgkmcnt(0)
    v_add_f32 v32, v32, v33
    v_add_f32 v32, v32, v34
    v_add_f32 v32, v32, v35
    v_add_f32 v32, v32, v36
    v_add_f32 v32, v32, v37
    v_add_f32 v32, v32, v38
    v_add_f32 v32, v32, v39
    s_mul_i32 s44, s64, 896
    s_mul_i32 s45, s66, 14336
    s_add_u32 s44, s44, s45
    s_mov_b64 s[68:69], exec
    v_cmp_gt_u32 vcc, 224, v6
    s_nop 1
    s_and_b64 exec, exec, vcc
    buffer_store_dword v32, v4, s[52:55], s44 offen sc1
    s_mov_b64 exec, -1
    s_waitcnt vmcnt(0)
    s_barrier
    s_barrier
    s_barrier
    s_barrier
    s_branch ffn_sequential_preLN__ssm_conv_s4__glu_gated_swiglu__prompt_kernel_2
ffn_sequential_preLN__ssm_conv_s4__glu_gated_swiglu__prompt_kernel_2:
    s_load_dwordx2 s[8:9], s[0:1], 120
    s_load_dwordx2 s[96:97], s[0:1], 104
    v_lshrrev_b32 v1, 6, v0
    v_and_b32 v2, 63, v0
    v_readfirstlane_b32 s30, v1
    s_and_b32 s34, s2, 7
    s_lshr_b32 s35, s2, 3
    s_and_b32 s36, s34, 1
    s_lshl_b32 s36, s36, 3
    s_and_b32 s37, s35, 7
    s_add_u32 s28, s36, s37
    s_lshr_b32 s36, s34, 1
    s_lshl_b32 s36, s36, 2
    s_lshr_b32 s37, s35, 3
    s_add_u32 s29, s36, s37
    s_mul_i32 s33, s29, 27
    s_lshr_b32 s33, s33, 1
    v_lshrrev_b32 v3, 4, v2
    v_bfe_u32 v4, v2, 2, 2
    v_lshl_add_u32 v4, v3, 2, v4
    v_and_b32 v5, 3, v2
    s_waitcnt lgkmcnt(0)
    s_add_u32 s16, s8, 5242880
    s_addc_u32 s17, s9, 0
    s_mov_b32 s18, 2621440
    s_mov_b32 s19, 0x20000
    s_add_u32 s4, s8, 22134784
    s_addc_u32 s5, s9, 0
    s_mov_b32 s6, 16384
    s_mov_b32 s7, 0x20000
    s_add_u32 s76, s8, 15073280
    s_addc_u32 s77, s9, 0
    s_mov_b32 s78, 262144
    s_mov_b32 s79, 0x20000
    s_lshl_b32 s80, s28, 7
    s_cmp_ge_u32 s30, 4
    s_cbranch_scc1 loader_sequential_preLN__ssm_conv_s4__glu_gated_swiglu__prompt_kernel_33
    s_and_b32 s36, s30, 1
    s_lshr_b32 s37, s30, 1
    v_mul_u32_u24 v6, 448, v4
    v_lshl_add_u32 v6, v5, 3, v6
    s_mul_i32 s45, s36, 224
    v_add_u32 v6, s45, v6
    v_and_b32 v7, 1, v3
    v_lshlrev_b32 v7, 5, v7
    s_mul_i32 s45, s36, -2
    s_add_u32 s45, s45, 1
    v_mul_lo_u32 v7, v7, s45
    v_add_u32 v10, v6, v7
    v_sub_u32 v11, v6, v7
    v_and_b32 v6, 7, v4
    v_lshlrev_b32 v7, 8, v4
    v_lshl_add_u32 v7, v5, 3, v7
    v_add_u32 v7, 14336, v7
    s_lshl_b32 s45, s37, 2
    s_add_u32 s46, s45, 0
    v_xor_b32 v8, s46, v6
    v_lshl_add_u32 v16, v8, 5, v7
    s_add_u32 s46, s45, 1
    v_xor_b32 v8, s46, v6
    v_lshl_add_u32 v17, v8, 5, v7
    s_add_u32 s46, s45, 2
    v_xor_b32 v8, s46, v6
    v_lshl_add_u32 v18, v8, 5, v7
    s_add_u32 s46, s45, 3
    v_xor_b32 v8, s46, v6
    v_lshl_add_u32 v19, v8, 5, v7
    v_mov_b32 v120, 0
    v_mov_b32 v121, 0
    v_mov_b32 v122, 0
    v_mov_b32 v123, 0
    v_mov_b32 v124, 0
    v_mov_b32 v125, 0
    v_mov_b32 v126, 0
    v_mov_b32 v127, 0
    v_mov_b32 v128, 0
    v_mov_b32 v129, 0
    v_mov_b32 v130, 0
    v_mov_b32 v131, 0
    v_mov_b32 v132, 0
    v_mov_b32 v133, 0
    v_mov_b32 v134, 0
    v_mov_b32 v135, 0
    v_mov_b32 v136, 0
    v_mov_b32 v137, 0
    v_mov_b32 v138, 0
    v_mov_b32 v139, 0
    v_mov_b32 v140, 0
    v_mov_b32 v141, 0
    v_mov_b32 v142, 0
    v_mov_b32 v143, 0
    v_mov_b32 v144, 0
    v_mov_b32 v145, 0
    v_mov_b32 v146, 0
    v_mov_b32 v147, 0
    v_mov_b32 v148, 0
    v_mov_b32 v149, 0
    v_mov_b32 v150, 0
    v_mov_b32 v151, 0
    v_mov_b32 v152, 0
    v_mov_b32 v153, 0
    v_mov_b32 v154, 0
    v_mov_b32 v155, 0
    v_mov_b32 v156, 0
    v_mov_b32 v157, 0
    v_mov_b32 v158, 0
    v_mov_b32 v159, 0
    v_mov_b32 v160, 0
    v_mov_b32 v161, 0
    v_mov_b32 v162, 0
    v_mov_b32 v163, 0
    v_mov_b32 v164, 0
    v_mov_b32 v165, 0
    v_mov_b32 v166, 0
    v_mov_b32 v167, 0
    v_mov_b32 v168, 0
    v_mov_b32 v169, 0
    v_mov_b32 v170, 0
    v_mov_b32 v171, 0
    v_mov_b32 v172, 0
    v_mov_b32 v173, 0
    v_mov_b32 v174, 0
    v_mov_b32 v175, 0
    v_mov_b32 v176, 0
    v_mov_b32 v177, 0
    v_mov_b32 v178, 0
    v_mov_b32 v179, 0
    v_mov_b32 v180, 0
    v_mov_b32 v181, 0
    v_mov_b32 v182, 0
    v_mov_b32 v183, 0
    v_mov_b32 v184, 0
    v_mov_b32 v185, 0
    v_mov_b32 v186, 0
    v_mov_b32 v187, 0
    v_mov_b32 v188, 0
    v_mov_b32 v189, 0
    v_mov_b32 v190, 0
    v_mov_b32 v191, 0
    v_mov_b32 v192, 0
    v_mov_b32 v193, 0
    v_mov_b32 v194, 0
    v_mov_b32 v195, 0
    v_mov_b32 v196, 0
    v_mov_b32 v197, 0
    v_mov_b32 v198, 0
    v_mov_b32 v199, 0
    v_mov_b32 v200, 0
    v_mov_b32 v201, 0
    v_mov_b32 v202, 0
    v_mov_b32 v203, 0
    v_mov_b32 v204, 0
    v_mov_b32 v205, 0
    v_mov_b32 v206, 0
    v_mov_b32 v207, 0
    v_mov_b32 v208, 0
    v_mov_b32 v209, 0
    v_mov_b32 v210, 0
    v_mov_b32 v211, 0
    v_mov_b32 v212, 0
    v_mov_b32 v213, 0
    v_mov_b32 v214, 0
    v_mov_b32 v215, 0
    v_mov_b32 v216, 0
    v_mov_b32 v217, 0
    v_mov_b32 v218, 0
    v_mov_b32 v219, 0
    v_mov_b32 v220, 0
    v_mov_b32 v221, 0
    v_mov_b32 v222, 0
    v_mov_b32 v223, 0
    v_mov_b32 v224, 0
    v_mov_b32 v225, 0
    v_mov_b32 v226, 0
    v_mov_b32 v227, 0
    v_mov_b32 v228, 0
    v_mov_b32 v229, 0
    v_mov_b32 v230, 0
    v_mov_b32 v231, 0
    v_add_u32 v12, 45056, v10
    v_add_u32 v13, 45056, v11
    v_add_u32 v20, 45056, v16
    v_add_u32 v21, 45056, v17
    v_add_u32 v22, 45056, v18
    v_add_u32 v23, 45056, v19
    v_add_u32 v14, 90112, v10
    v_add_u32 v15, 90112, v11
    v_add_u32 v24, 90112, v16
    v_add_u32 v25, 90112, v17
    v_add_u32 v26, 90112, v18
    v_add_u32 v27, 90112, v19
    s_cmp_lg_u32 s30, 0
    s_cbranch_scc1 h_nopoll_sequential_preLN__ssm_conv_s4__glu_gated_swiglu__prompt_kernel_34
    v_min_u32 v6, 9, v2
    v_lshlrev_b32 v6, 7, v6
    v_add_u32 v6, 10240, v6
    s_mov_b32 s47, 0x40000
h_poll_sequential_preLN__ssm_conv_s4__glu_gated_swiglu__prompt_kernel_35:
    buffer_load_dword v7, v6, s[4:7], 0 offen sc1
    s_waitcnt vmcnt(0)
    v_cmp_eq_u32 vcc, 0, v7
    s_nop 1
    s_cmp_eq_u64 vcc, 0
    s_cbranch_scc1 h_done_sequential_preLN__ssm_conv_s4__glu_gated_swiglu__prompt_kernel_36
    s_sleep 2
    s_sub_u32 s47, s47, 1
    s_cmp_lg_u32 s47, 0
    s_cbranch_scc1 h_poll_sequential_preLN__ssm_conv_s4__glu_gated_swiglu__prompt_kernel_35
h_done_sequential_preLN__ssm_conv_s4__glu_gated_swiglu__prompt_kernel_36:
h_nopoll_sequential_preLN__ssm_conv_s4__glu_gated_swiglu__prompt_kernel_34:
    s_barrier
    s_mul_i32 s36, s29, 40
    s_mul_i32 s37, s30, 10
    s_add_u32 s36, s36, s37
    s_lshl_b32 s36, s36, 12
    s_lshl_b32 s37, s28, 8
    s_add_u32 s36, s36, s37
    v_lshl_add_u32 v6, v2, 2, s36
    s_mov_b32 s31, 0
    buffer_load_dword v232, v6, s[16:19], s31 offen sc1
    s_mov_b32 s31, 4096
    buffer_load_dword v233, v6, s[16:19], s31 offen sc1
    s_mov_b32 s31, 8192
    buffer_load_dword v234, v6, s[16:19], s31 offen sc1
    s_mov_b32 s31, 12288
    buffer_load_dword v235, v6, s[16:19], s31 offen sc1
    s_mov_b32 s31, 16384
    buffer_load_dword v236, v6, s[16:19], s31 offen sc1
    s_mov_b32 s31, 20480
    buffer_load_dword v237, v6, s[16:19], s31 offen sc1
    s_mov_b32 s31, 24576
    buffer_load_dword v238, v6, s[16:19], s31 offen sc1
    s_mov_b32 s31, 28672
    buffer_load_dword v239, v6, s[16:19], s31 offen sc1
    s_mov_b32 s31, 32768
    buffer_load_dword v240, v6, s[16:19], s31 offen sc1
    s_mov_b32 s31, 36864
    buffer_load_dword v241, v6, s[16:19], s31 offen sc1
    s_and_b32 s36, s30, 1
    s_lshr_b32 s37, s30, 1
    v_mov_b32 v244, 0
    v_mov_b32 v245, 0
    v_mov_b32 v246, 0
    v_mov_b32 v247, 0
    s_waitcnt vmcnt(0)
    v_lshlrev_b32 v242, 16, v232
    v_and_b32 v232, 0xffff0000, v232
    v_add_f32 v244, v244, v242
    v_add_f32 v245, v245, v232
    v_fmac_f32 v246, v242, v242
    v_fmac_f32 v247, v232, v232
    v_lshlrev_b32 v243, 16, v233
    v_and_b32 v233, 0xffff0000, v233
    v_add_f32 v244, v244, v243
    v_add_f32 v245, v245, v233
    v_fmac_f32 v246, v243, v243
    v_fmac_f32 v247, v233, v233
    v_lshlrev_b32 v242, 16, v234
    v_and_b32 v234, 0xffff0000, v234
    v_add_f32 v244, v244, v242
    v_add_f32 v245, v245, v234
    v_fmac_f32 v246, v242, v242
    v_fmac_f32 v247, v234, v234
    v_lshlrev_b32 v243, 16, v235
    v_and_b32 v235, 0xffff0000, v235
    v_add_f32 v244, v244, v243
    v_add_f32 v245, v245, v235
    v_fmac_f32 v246, v243, v243
    v_fmac_f32 v247, v235, v235
    v_lshlrev_b32 v242, 16, v236
    v_and_b32 v236, 0xffff0000, v236
    v_add_f32 v244, v244, v242
    v_add_f32 v245, v245, v236
    v_fmac_f32 v246, v242, v242
    v_fmac_f32 v247, v236, v236
    v_lshlrev_b32 v243, 16, v237
    v_and_b32 v237, 0xffff0000, v237
    v_add_f32 v244, v244, v243
    v_add_f32 v245, v245, v237
    v_fmac_f32 v246, v243, v243
    v_fmac_f32 v247, v237, v237
    v_lshlrev_b32 v242, 16, v238
    v_and_b32 v238, 0xffff0000, v238
    v_add_f32 v244, v244, v242
    v_add_f32 v245, v245, v238
    v_fmac_f32 v246, v242, v242
    v_fmac_f32 v247, v238, v238
    v_lshlrev_b32 v243, 16, v239
    v_and_b32 v239, 0xffff0000, v239
    v_add_f32 v244, v244, v243
    v_add_f32 v245, v245, v239
    v_fmac_f32 v246, v243, v243
    v_fmac_f32 v247, v239, v239
    v_lshlrev_b32 v242, 16, v240
    v_and_b32 v240, 0xffff0000, v240
    v_add_f32 v244, v244, v242
    v_add_f32 v245, v245, v240
    v_fmac_f32 v246, v242, v242
    v_fmac_f32 v247, v240, v240
    v_lshlrev_b32 v243, 16, v241
    v_and_b32 v241, 0xffff0000, v241
    v_add_f32 v244, v244, v243
    v_add_f32 v245, v245, v241
    v_fmac_f32 v246, v243, v243
    v_fmac_f32 v247, v241, v241
    s_lshl_b32 s45, s30, 10
    s_add_u32 s45, s45, 138240
    v_lshl_add_u32 v6, v2, 4, s45
    ds_write_b128 v6, v[244:247]
    s_waitcnt lgkmcnt(0)
    s_barrier
    s_cmp_lg_u32 s30, 0
    s_cbranch_scc1 nopart_sequential_preLN__ssm_conv_s4__glu_gated_swiglu__prompt_kernel_37
    v_lshlrev_b32 v6, 4, v2
    v_add_u32 v7, 138240, v6
    ds_read_b128 v[232:235], v7 offset:0
    ds_read_b128 v[236:239], v7 offset:1024
    ds_read_b128 v[240:243], v7 offset:2048
    ds_read_b128 v[244:247], v7 offset:3072
    s_lshl_b32 s45, s28, 4
    s_add_u32 s45, s45, s29
    s_lshl_b32 s45, s45, 10
    s_waitcnt lgkmcnt(0)
    v_pk_add_f32 v[232:233], v[232:233], v[236:237]
    v_pk_add_f32 v[234:235], v[234:235], v[238:239]
    v_pk_add_f32 v[232:233], v[232:233], v[240:241]
    v_pk_add_f32 v[234:235], v[234:235], v[242:243]
    v_pk_add_f32 v[232:233], v[232:233], v[244:245]
    v_pk_add_f32 v[234:235], v[234:235], v[246:247]
    buffer_store_dwordx4 v[232:235], v6, s[76:79], s45 offen sc1
nopart_sequential_preLN__ssm_conv_s4__glu_gated_swiglu__prompt_kernel_37:
    ds_read_b64_tr_b16 v[88:89], v16 offset:0
    ds_read_b64_tr_b16 v[90:91], v16 offset:4096
    ds_read_b64_tr_b16 v[32:33], v10 offset:0
    ds_read_b64_tr_b16 v[34:35], v10 offset:7168
    ds_read_b64_tr_b16 v[36:37], v11 offset:32
    ds_read_b64_tr_b16 v[38:39], v11 offset:7200
    ds_read_b64_tr_b16 v[40:41], v10 offset:64
    ds_read_b64_tr_b16 v[42:43], v10 offset:7232
    ds_read_b64_tr_b16 v[44:45], v11 offset:96
    ds_read_b64_tr_b16 v[46:47], v11 offset:7264
    ds_read_b64_tr_b16 v[48:49], v10 offset:128
    ds_read_b64_tr_b16 v[50:51], v10 offset:7296
    ds_read_b64_tr_b16 v[52:53], v11 offset:160
    ds_read_b64_tr_b16 v[54:55], v11 offset:7328
    ds_read_b64_tr_b16 v[56:57], v10 offset:192
    ds_read_b64_tr_b16 v[58:59], v10 offset:7360
    ds_read_b64_tr_b16 v[92:93], v17 offset:0
    ds_read_b64_tr_b16 v[94:95], v17 offset:4096
    ds_read_b64_tr_b16 v[96:97], v18 offset:0
    ds_read_b64_tr_b16 v[98:99], v18 offset:4096
    ds_read_b64_tr_b16 v[100:101], v19 offset:0
    ds_read_b64_tr_b16 v[102:103], v19 offset:4096
    s_waitcnt lgkmcnt(0)
    v_mfma_f32_16x16x32_bf16 v[120:123], v[32:35], v[88:91], v[120:123]
    ds_read_b64_tr_b16 v[104:105], v16 offset:22528
    v_mfma_f32_16x16x32_bf16 v[136:139], v[36:39], v[88:91], v[136:139]
    ds_read_b64_tr_b16 v[106:107], v16 offset:26624
    v_mfma_f32_16x16x32_bf16 v[152:155], v[40:43], v[88:91], v[152:155]
    ds_read_b64_tr_b16 v[60:61], v10 offset:22528
    v_mfma_f32_16x16x32_bf16 v[168:171], v[44:47], v[88:91], v[168:171]
    ds_read_b64_tr_b16 v[62:63], v10 offset:29696
    v_mfma_f32_16x16x32_bf16 v[184:187], v[48:51], v[88:91], v[184:187]
    ds_read_b64_tr_b16 v[64:65], v11 offset:22560
    v_mfma_f32_16x16x32_bf16 v[200:203], v[52:55], v[88:91], v[200:203]
    ds_read_b64_tr_b16 v[66:67], v11 offset:29728
    v_mfma_f32_16x16x32_bf16 v[216:219], v[56:59], v[88:91], v[216:219]
    ds_read_b64_tr_b16 v[68:69], v10 offset:22592
    v_mfma_f32_16x16x32_bf16 v[124:127], v[32:35], v[92:95], v[124:127]
    ds_read_b64_tr_b16 v[70:71], v10 offset:29760
    v_mfma_f32_16x16x32_bf16 v[140:143], v[36:39], v[92:95], v[140:143]
    ds_read_b64_tr_b16 v[72:73], v11 offset:22624
    v_mfma_f32_16x16x32_bf16 v[156:159], v[40:43], v[92:95], v[156:159]
    ds_read_b64_tr_b16 v[74:75], v11 offset:29792
    v_mfma_f32_16x16x32_bf16 v[172:175], v[44:47], v[92:95], v[172:175]
    ds_read_b64_tr_b16 v[76:77], v10 offset:22656
    v_mfma_f32_16x16x32_bf16 v[188:191], v[48:51], v[92:95], v[188:191]
    ds_read_b64_tr_b16 v[78:79], v10 offset:29824
    v_mfma_f32_16x16x32_bf16 v[204:207], v[52:55], v[92:95], v[204:207]
    ds_read_b64_tr_b16 v[80:81], v11 offset:22688
    v_mfma_f32_16x16x32_bf16 v[220:223], v[56:59], v[92:95], v[220:223]
    ds_read_b64_tr_b16 v[82:83], v11 offset:29856
    v_mfma_f32_16x16x32_bf16 v[128:131], v[32:35], v[96:99], v[128:131]
    ds_read_b64_tr_b16 v[84:85], v10 offset:22720
    v_mfma_f32_16x16x32_bf16 v[144:147], v[36:39], v[96:99], v[144:147]
    ds_read_b64_tr_b16 v[86:87], v10 offset:29888
    v_mfma_f32_16x16x32_bf16 v[160:163], v[40:43], v[96:99], v[160:163]
    ds_read_b64_tr_b16 v[108:109], v17 offset:22528
    v_mfma_f32_16x16x32_bf16 v[176:179], v[44:47], v[96:99], v[176:179]
    ds_read_b64_tr_b16 v[110:111], v17 offset:26624
    v_mfma_f32_16x16x32_bf16 v[192:195], v[48:51], v[96:99], v[192:195]
    ds_read_b64_tr_b16 v[112:113], v18 offset:22528
    v_mfma_f32_16x16x32_bf16 v[208:211], v[52:55], v[96:99], v[208:211]
    ds_read_b64_tr_b16 v[114:115], v18 offset:26624
    v_mfma_f32_16x16x32_bf16 v[224:227], v[56:59], v[96:99], v[224:227]
    ds_read_b64_tr_b16 v[116:117], v19 offset:22528
    v_mfma_f32_16x16x32_bf16 v[132:135], v[32:35], v[100:103], v[132:135]
    ds_read_b64_tr_b16 v[118:119], v19 offset:26624
    v_mfma_f32_16x16x32_bf16 v[148:151], v[36:39], v[100:103], v[148:151]
    v_mfma_f32_16x16x32_bf16 v[164:167], v[40:43], v[100:103], v[164:167]
    v_mfma_f32_16x16x32_bf16 v[180:183], v[44:47], v[100:103], v[180:183]
    v_mfma_f32_16x16x32_bf16 v[196:199], v[48:51], v[100:103], v[196:199]
    v_mfma_f32_16x16x32_bf16 v[212:215], v[52:55], v[100:103], v[212:215]
    v_mfma_f32_16x16x32_bf16 v[228:231], v[56:59], v[100:103], v[228:231]
    s_waitcnt lgkmcnt(0)
    s_barrier
    v_mfma_f32_16x16x32_bf16 v[120:123], v[60:63], v[104:107], v[120:123]
    ds_read_b64_tr_b16 v[88:89], v20 offset:0
    v_mfma_f32_16x16x32_bf16 v[136:139], v[64:67], v[104:107], v[136:139]
    ds_read_b64_tr_b16 v[90:91], v20 offset:4096
    v_mfma_f32_16x16x32_bf16 v[152:155], v[68:71], v[104:107], v[152:155]
    ds_read_b64_tr_b16 v[32:33], v12 offset:0
    v_mfma_f32_16x16x32_bf16 v[168:171], v[72:75], v[104:107], v[168:171]
    ds_read_b64_tr_b16 v[34:35], v12 offset:7168
    v_mfma_f32_16x16x32_bf16 v[184:187], v[76:79], v[104:107], v[184:187]
    ds_read_b64_tr_b16 v[36:37], v13 offset:32
    v_mfma_f32_16x16x32_bf16 v[200:203], v[80:83], v[104:107], v[200:203]
    ds_read_b64_tr_b16 v[38:39], v13 offset:7200
    v_mfma_f32_16x16x32_bf16 v[216:219], v[84:87], v[104:107], v[216:219]
    ds_read_b64_tr_b16 v[40:41], v12 offset:64
    v_mfma_f32_16x16x32_bf16 v[124:127], v[60:63], v[108:111], v[124:127]
    ds_read_b64_tr_b16 v[42:43], v12 offset:7232
    v_mfma_f32_16x16x32_bf16 v[140:143], v[64:67], v[108:111], v[140:143]
    ds_read_b64_tr_b16 v[44:45], v13 offset:96
    v_mfma_f32_16x16x32_bf16 v[156:159], v[68:71], v[108:111], v[156:159]
    ds_read_b64_tr_b16 v[46:47], v13 offset:7264
    v_mfma_f32_16x16x32_bf16 v[172:175], v[72:75], v[108:111], v[172:175]
    ds_read_b64_tr_b16 v[48:49], v12 offset:128
    v_mfma_f32_16x16x32_bf16 v[188:191], v[76:79], v[108:111], v[188:191]
    ds_read_b64_tr_b16 v[50:51], v12 offset:7296
    v_mfma_f32_16x16x32_bf16 v[204:207], v[80:83], v[108:111], v[204:207]
    ds_read_b64_tr_b16 v[52:53], v13 offset:160
    v_mfma_f32_16x16x32_bf16 v[220:223], v[84:87], v[108:111], v[220:223]
    ds_read_b64_tr_b16 v[54:55], v13 offset:7328
    v_mfma_f32_16x16x32_bf16 v[128:131], v[60:63], v[112:115], v[128:131]
    ds_read_b64_tr_b16 v[56:57], v12 offset:192
    v_mfma_f32_16x16x32_bf16 v[144:147], v[64:67], v[112:115], v[144:147]
    ds_read_b64_tr_b16 v[58:59], v12 offset:7360
    v_mfma_f32_16x16x32_bf16 v[160:163], v[68:71], v[112:115], v[160:163]
    ds_read_b64_tr_b16 v[92:93], v21 offset:0
    v_mfma_f32_16x16x32_bf16 v[176:179], v[72:75], v[112:115], v[176:179]
    ds_read_b64_tr_b16 v[94:95], v21 offset:4096
    v_mfma_f32_16x16x32_bf16 v[192:195], v[76:79], v[112:115], v[192:195]
    ds_read_b64_tr_b16 v[96:97], v22 offset:0
    v_mfma_f32_16x16x32_bf16 v[208:211], v[80:83], v[112:115], v[208:211]
    ds_read_b64_tr_b16 v[98:99], v22 offset:4096
    v_mfma_f32_16x16x32_bf16 v[224:227], v[84:87], v[112:115], v[224:227]
    ds_read_b64_tr_b16 v[100:101], v23 offset:0
    v_mfma_f32_16x16x32_bf16 v[132:135], v[60:63], v[116:119], v[132:135]
    ds_read_b64_tr_b16 v[102:103], v23 offset:4096
    v_mfma_f32_16x16x32_bf16 v[148:151], v[64:67], v[116:119], v[148:151]
    v_mfma_f32_16x16x32_bf16 v[164:167], v[68:71], v[116:119], v[164:167]
    v_mfma_f32_16x16x32_bf16 v[180:183], v[72:75], v[116:119], v[180:183]
    v_mfma_f32_16x16x32_bf16 v[196:199], v[76:79], v[116:119], v[196:199]
    v_mfma_f32_16x16x32_bf16 v[212:215], v[80:83], v[116:119], v[212:215]
    v_mfma_f32_16x16x32_bf16 v[228:231], v[84:87], v[116:119], v[228:231]
    s_waitcnt lgkmcnt(0)
    v_mfma_f32_16x16x32_bf16 v[120:123], v[32:35], v[88:91], v[120:123]
    ds_read_b64_tr_b16 v[104:105], v20 offset:22528
    v_mfma_f32_16x16x32_bf16 v[136:139], v[36:39], v[88:91], v[136:139]
    ds_read_b64_tr_b16 v[106:107], v20 offset:26624
    v_mfma_f32_16x16x32_bf16 v[152:155], v[40:43], v[88:91], v[152:155]
    ds_read_b64_tr_b16 v[60:61], v12 offset:22528
    v_mfma_f32_16x16x32_bf16 v[168:171], v[44:47], v[88:91], v[168:171]
    ds_read_b64_tr_b16 v[62:63], v12 offset:29696
    v_mfma_f32_16x16x32_bf16 v[184:187], v[48:51], v[88:91], v[184:187]
    ds_read_b64_tr_b16 v[64:65], v13 offset:22560
    v_mfma_f32_16x16x32_bf16 v[200:203], v[52:55], v[88:91], v[200:203]
    ds_read_b64_tr_b16 v[66:67], v13 offset:29728
    v_mfma_f32_16x16x32_bf16 v[216:219], v[56:59], v[88:91], v[216:219]
    ds_read_b64_tr_b16 v[68:69], v12 offset:22592
    v_mfma_f32_16x16x32_bf16 v[124:127], v[32:35], v[92:95], v[124:127]
    ds_read_b64_tr_b16 v[70:71], v12 offset:29760
    v_mfma_f32_16x16x32_bf16 v[140:143], v[36:39], v[92:95], v[140:143]
    ds_read_b64_tr_b16 v[72:73], v13 offset:22624
    v_mfma_f32_16x16x32_bf16 v[156:159], v[40:43], v[92:95], v[156:159]
    ds_read_b64_tr_b16 v[74:75], v13 offset:29792
    v_mfma_f32_16x16x32_bf16 v[172:175], v[44:47], v[92:95], v[172:175]
    ds_read_b64_tr_b16 v[76:77], v12 offset:22656
    v_mfma_f32_16x16x32_bf16 v[188:191], v[48:51], v[92:95], v[188:191]
    ds_read_b64_tr_b16 v[78:79], v12 offset:29824
    v_mfma_f32_16x16x32_bf16 v[204:207], v[52:55], v[92:95], v[204:207]
    ds_read_b64_tr_b16 v[80:81], v13 offset:22688
    v_mfma_f32_16x16x32_bf16 v[220:223], v[56:59], v[92:95], v[220:223]
    ds_read_b64_tr_b16 v[82:83], v13 offset:29856
    v_mfma_f32_16x16x32_bf16 v[128:131], v[32:35], v[96:99], v[128:131]
    ds_read_b64_tr_b16 v[84:85], v12 offset:22720
    v_mfma_f32_16x16x32_bf16 v[144:147], v[36:39], v[96:99], v[144:147]
    ds_read_b64_tr_b16 v[86:87], v12 offset:29888
    v_mfma_f32_16x16x32_bf16 v[160:163], v[40:43], v[96:99], v[160:163]
    ds_read_b64_tr_b16 v[108:109], v21 offset:22528
    v_mfma_f32_16x16x32_bf16 v[176:179], v[44:47], v[96:99], v[176:179]
    ds_read_b64_tr_b16 v[110:111], v21 offset:26624
    v_mfma_f32_16x16x32_bf16 v[192:195], v[48:51], v[96:99], v[192:195]
    ds_read_b64_tr_b16 v[112:113], v22 offset:22528
    v_mfma_f32_16x16x32_bf16 v[208:211], v[52:55], v[96:99], v[208:211]
    ds_read_b64_tr_b16 v[114:115], v22 offset:26624
    v_mfma_f32_16x16x32_bf16 v[224:227], v[56:59], v[96:99], v[224:227]
    ds_read_b64_tr_b16 v[116:117], v23 offset:22528
    v_mfma_f32_16x16x32_bf16 v[132:135], v[32:35], v[100:103], v[132:135]
    ds_read_b64_tr_b16 v[118:119], v23 offset:26624
    v_mfma_f32_16x16x32_bf16 v[148:151], v[36:39], v[100:103], v[148:151]
    v_mfma_f32_16x16x32_bf16 v[164:167], v[40:43], v[100:103], v[164:167]
    v_mfma_f32_16x16x32_bf16 v[180:183], v[44:47], v[100:103], v[180:183]
    v_mfma_f32_16x16x32_bf16 v[196:199], v[48:51], v[100:103], v[196:199]
    v_mfma_f32_16x16x32_bf16 v[212:215], v[52:55], v[100:103], v[212:215]
    v_mfma_f32_16x16x32_bf16 v[228:231], v[56:59], v[100:103], v[228:231]
    s_waitcnt lgkmcnt(0)
    s_barrier
    v_mfma_f32_16x16x32_bf16 v[120:123], v[60:63], v[104:107], v[120:123]
    ds_read_b64_tr_b16 v[88:89], v24 offset:0
    v_mfma_f32_16x16x32_bf16 v[136:139], v[64:67], v[104:107], v[136:139]
    ds_read_b64_tr_b16 v[90:91], v24 offset:4096
    v_mfma_f32_16x16x32_bf16 v[152:155], v[68:71], v[104:107], v[152:155]
    ds_read_b64_tr_b16 v[32:33], v14 offset:0
    v_mfma_f32_16x16x32_bf16 v[168:171], v[72:75], v[104:107], v[168:171]
    ds_read_b64_tr_b16 v[34:35], v14 offset:7168
    v_mfma_f32_16x16x32_bf16 v[184:187], v[76:79], v[104:107], v[184:187]
    ds_read_b64_tr_b16 v[36:37], v15 offset:32
    v_mfma_f32_16x16x32_bf16 v[200:203], v[80:83], v[104:107], v[200:203]
    ds_read_b64_tr_b16 v[38:39], v15 offset:7200
    v_mfma_f32_16x16x32_bf16 v[216:219], v[84:87], v[104:107], v[216:219]
    ds_read_b64_tr_b16 v[40:41], v14 offset:64
    v_mfma_f32_16x16x32_bf16 v[124:127], v[60:63], v[108:111], v[124:127]
    ds_read_b64_tr_b16 v[42:43], v14 offset:7232
    v_mfma_f32_16x16x32_bf16 v[140:143], v[64:67], v[108:111], v[140:143]
    ds_read_b64_tr_b16 v[44:45], v15 offset:96
    v_mfma_f32_16x16x32_bf16 v[156:159], v[68:71], v[108:111], v[156:159]
    ds_read_b64_tr_b16 v[46:47], v15 offset:7264
    v_mfma_f32_16x16x32_bf16 v[172:175], v[72:75], v[108:111], v[172:175]
    ds_read_b64_tr_b16 v[48:49], v14 offset:128
    v_mfma_f32_16x16x32_bf16 v[188:191], v[76:79], v[108:111], v[188:191]
    ds_read_b64_tr_b16 v[50:51], v14 offset:7296
    v_mfma_f32_16x16x32_bf16 v[204:207], v[80:83], v[108:111], v[204:207]
    ds_read_b64_tr_b16 v[52:53], v15 offset:160
    v_mfma_f32_16x16x32_bf16 v[220:223], v[84:87], v[108:111], v[220:223]
    ds_read_b64_tr_b16 v[54:55], v15 offset:7328
    v_mfma_f32_16x16x32_bf16 v[128:131], v[60:63], v[112:115], v[128:131]
    ds_read_b64_tr_b16 v[56:57], v14 offset:192
    v_mfma_f32_16x16x32_bf16 v[144:147], v[64:67], v[112:115], v[144:147]
    ds_read_b64_tr_b16 v[58:59], v14 offset:7360
    v_mfma_f32_16x16x32_bf16 v[160:163], v[68:71], v[112:115], v[160:163]
    ds_read_b64_tr_b16 v[92:93], v25 offset:0
    v_mfma_f32_16x16x32_bf16 v[176:179], v[72:75], v[112:115], v[176:179]
    ds_read_b64_tr_b16 v[94:95], v25 offset:4096
    v_mfma_f32_16x16x32_bf16 v[192:195], v[76:79], v[112:115], v[192:195]
    ds_read_b64_tr_b16 v[96:97], v26 offset:0
    v_mfma_f32_16x16x32_bf16 v[208:211], v[80:83], v[112:115], v[208:211]
    ds_read_b64_tr_b16 v[98:99], v26 offset:4096
    v_mfma_f32_16x16x32_bf16 v[224:227], v[84:87], v[112:115], v[224:227]
    ds_read_b64_tr_b16 v[100:101], v27 offset:0
    v_mfma_f32_16x16x32_bf16 v[132:135], v[60:63], v[116:119], v[132:135]
    ds_read_b64_tr_b16 v[102:103], v27 offset:4096
    v_mfma_f32_16x16x32_bf16 v[148:151], v[64:67], v[116:119], v[148:151]
    v_mfma_f32_16x16x32_bf16 v[164:167], v[68:71], v[116:119], v[164:167]
    v_mfma_f32_16x16x32_bf16 v[180:183], v[72:75], v[116:119], v[180:183]
    v_mfma_f32_16x16x32_bf16 v[196:199], v[76:79], v[116:119], v[196:199]
    v_mfma_f32_16x16x32_bf16 v[212:215], v[80:83], v[116:119], v[212:215]
    v_mfma_f32_16x16x32_bf16 v[228:231], v[84:87], v[116:119], v[228:231]
    s_cmp_lg_u32 s30, 0
    s_cbranch_scc1 nopub_sequential_preLN__ssm_conv_s4__glu_gated_swiglu__prompt_kernel_38
    s_waitcnt vmcnt(0)
    v_mov_b32 v6, s80
    v_mov_b32 v29, 1
    s_mov_b64 exec, 1
    buffer_atomic_add v29, v6, s[4:7], 0 offen sc0
    s_mov_b64 exec, -1
nopub_sequential_preLN__ssm_conv_s4__glu_gated_swiglu__prompt_kernel_38:
    s_waitcnt lgkmcnt(0)
    v_mfma_f32_16x16x32_bf16 v[120:123], v[32:35], v[88:91], v[120:123]
    ds_read_b64_tr_b16 v[104:105], v24 offset:22528
    v_mfma_f32_16x16x32_bf16 v[136:139], v[36:39], v[88:91], v[136:139]
    ds_read_b64_tr_b16 v[106:107], v24 offset:26624
    v_mfma_f32_16x16x32_bf16 v[152:155], v[40:43], v[88:91], v[152:155]
    ds_read_b64_tr_b16 v[60:61], v14 offset:22528
    v_mfma_f32_16x16x32_bf16 v[168:171], v[44:47], v[88:91], v[168:171]
    ds_read_b64_tr_b16 v[62:63], v14 offset:29696
    v_mfma_f32_16x16x32_bf16 v[184:187], v[48:51], v[88:91], v[184:187]
    ds_read_b64_tr_b16 v[64:65], v15 offset:22560
    v_mfma_f32_16x16x32_bf16 v[200:203], v[52:55], v[88:91], v[200:203]
    ds_read_b64_tr_b16 v[66:67], v15 offset:29728
    v_mfma_f32_16x16x32_bf16 v[216:219], v[56:59], v[88:91], v[216:219]
    ds_read_b64_tr_b16 v[68:69], v14 offset:22592
    v_mfma_f32_16x16x32_bf16 v[124:127], v[32:35], v[92:95], v[124:127]
    ds_read_b64_tr_b16 v[70:71], v14 offset:29760
    v_mfma_f32_16x16x32_bf16 v[140:143], v[36:39], v[92:95], v[140:143]
    ds_read_b64_tr_b16 v[72:73], v15 offset:22624
    v_mfma_f32_16x16x32_bf16 v[156:159], v[40:43], v[92:95], v[156:159]
    ds_read_b64_tr_b16 v[74:75], v15 offset:29792
    v_mfma_f32_16x16x32_bf16 v[172:175], v[44:47], v[92:95], v[172:175]
    ds_read_b64_tr_b16 v[76:77], v14 offset:22656
    v_mfma_f32_16x16x32_bf16 v[188:191], v[48:51], v[92:95], v[188:191]
    ds_read_b64_tr_b16 v[78:79], v14 offset:29824
    v_mfma_f32_16x16x32_bf16 v[204:207], v[52:55], v[92:95], v[204:207]
    ds_read_b64_tr_b16 v[80:81], v15 offset:22688
    v_mfma_f32_16x16x32_bf16 v[220:223], v[56:59], v[92:95], v[220:223]
    ds_read_b64_tr_b16 v[82:83], v15 offset:29856
    v_mfma_f32_16x16x32_bf16 v[128:131], v[32:35], v[96:99], v[128:131]
    ds_read_b64_tr_b16 v[84:85], v14 offset:22720
    v_mfma_f32_16x16x32_bf16 v[144:147], v[36:39], v[96:99], v[144:147]
    ds_read_b64_tr_b16 v[86:87], v14 offset:29888
    v_mfma_f32_16x16x32_bf16 v[160:163], v[40:43], v[96:99], v[160:163]
    ds_read_b64_tr_b16 v[108:109], v25 offset:22528
    v_mfma_f32_16x16x32_bf16 v[176:179], v[44:47], v[96:99], v[176:179]
    ds_read_b64_tr_b16 v[110:111], v25 offset:26624
    v_mfma_f32_16x16x32_bf16 v[192:195], v[48:51], v[96:99], v[192:195]
    ds_read_b64_tr_b16 v[112:113], v26 offset:22528
    v_mfma_f32_16x16x32_bf16 v[208:211], v[52:55], v[96:99], v[208:211]
    ds_read_b64_tr_b16 v[114:115], v26 offset:26624
    v_mfma_f32_16x16x32_bf16 v[224:227], v[56:59], v[96:99], v[224:227]
    ds_read_b64_tr_b16 v[116:117], v27 offset:22528
    v_mfma_f32_16x16x32_bf16 v[132:135], v[32:35], v[100:103], v[132:135]
    ds_read_b64_tr_b16 v[118:119], v27 offset:26624
    v_mfma_f32_16x16x32_bf16 v[148:151], v[36:39], v[100:103], v[148:151]
    v_mfma_f32_16x16x32_bf16 v[164:167], v[40:43], v[100:103], v[164:167]
    v_mfma_f32_16x16x32_bf16 v[180:183], v[44:47], v[100:103], v[180:183]
    v_mfma_f32_16x16x32_bf16 v[196:199], v[48:51], v[100:103], v[196:199]
    v_mfma_f32_16x16x32_bf16 v[212:215], v[52:55], v[100:103], v[212:215]
    v_mfma_f32_16x16x32_bf16 v[228:231], v[56:59], v[100:103], v[228:231]
    s_waitcnt lgkmcnt(0)
    s_barrier
    v_mfma_f32_16x16x32_bf16 v[120:123], v[60:63], v[104:107], v[120:123]
    ds_read_b64_tr_b16 v[88:89], v16 offset:0
    v_mfma_f32_16x16x32_bf16 v[136:139], v[64:67], v[104:107], v[136:139]
    ds_read_b64_tr_b16 v[90:91], v16 offset:4096
    v_mfma_f32_16x16x32_bf16 v[152:155], v[68:71], v[104:107], v[152:155]
    ds_read_b64_tr_b16 v[32:33], v10 offset:0
    v_mfma_f32_16x16x32_bf16 v[168:171], v[72:75], v[104:107], v[168:171]
    ds_read_b64_tr_b16 v[34:35], v10 offset:7168
    v_mfma_f32_16x16x32_bf16 v[184:187], v[76:79], v[104:107], v[184:187]
    ds_read_b64_tr_b16 v[36:37], v11 offset:32
    v_mfma_f32_16x16x32_bf16 v[200:203], v[80:83], v[104:107], v[200:203]
    ds_read_b64_tr_b16 v[38:39], v11 offset:7200
    v_mfma_f32_16x16x32_bf16 v[216:219], v[84:87], v[104:107], v[216:219]
    ds_read_b64_tr_b16 v[40:41], v10 offset:64
    v_mfma_f32_16x16x32_bf16 v[124:127], v[60:63], v[108:111], v[124:127]
    ds_read_b64_tr_b16 v[42:43], v10 offset:7232
    v_mfma_f32_16x16x32_bf16 v[140:143], v[64:67], v[108:111], v[140:143]
    ds_read_b64_tr_b16 v[44:45], v11 offset:96
    v_mfma_f32_16x16x32_bf16 v[156:159], v[68:71], v[108:111], v[156:159]
    ds_read_b64_tr_b16 v[46:47], v11 offset:7264
    v_mfma_f32_16x16x32_bf16 v[172:175], v[72:75], v[108:111], v[172:175]
    ds_read_b64_tr_b16 v[48:49], v10 offset:128
    v_mfma_f32_16x16x32_bf16 v[188:191], v[76:79], v[108:111], v[188:191]
    ds_read_b64_tr_b16 v[50:51], v10 offset:7296
    v_mfma_f32_16x16x32_bf16 v[204:207], v[80:83], v[108:111], v[204:207]
    ds_read_b64_tr_b16 v[52:53], v11 offset:160
    v_mfma_f32_16x16x32_bf16 v[220:223], v[84:87], v[108:111], v[220:223]
    ds_read_b64_tr_b16 v[54:55], v11 offset:7328
    v_mfma_f32_16x16x32_bf16 v[128:131], v[60:63], v[112:115], v[128:131]
    ds_read_b64_tr_b16 v[56:57], v10 offset:192
    v_mfma_f32_16x16x32_bf16 v[144:147], v[64:67], v[112:115], v[144:147]
    ds_read_b64_tr_b16 v[58:59], v10 offset:7360
    v_mfma_f32_16x16x32_bf16 v[160:163], v[68:71], v[112:115], v[160:163]
    ds_read_b64_tr_b16 v[92:93], v17 offset:0
    v_mfma_f32_16x16x32_bf16 v[176:179], v[72:75], v[112:115], v[176:179]
    ds_read_b64_tr_b16 v[94:95], v17 offset:4096
    v_mfma_f32_16x16x32_bf16 v[192:195], v[76:79], v[112:115], v[192:195]
    ds_read_b64_tr_b16 v[96:97], v18 offset:0
    v_mfma_f32_16x16x32_bf16 v[208:211], v[80:83], v[112:115], v[208:211]
    ds_read_b64_tr_b16 v[98:99], v18 offset:4096
    v_mfma_f32_16x16x32_bf16 v[224:227], v[84:87], v[112:115], v[224:227]
    ds_read_b64_tr_b16 v[100:101], v19 offset:0
    v_mfma_f32_16x16x32_bf16 v[132:135], v[60:63], v[116:119], v[132:135]
    ds_read_b64_tr_b16 v[102:103], v19 offset:4096
    v_mfma_f32_16x16x32_bf16 v[148:151], v[64:67], v[116:119], v[148:151]
    v_mfma_f32_16x16x32_bf16 v[164:167], v[68:71], v[116:119], v[164:167]
    v_mfma_f32_16x16x32_bf16 v[180:183], v[72:75], v[116:119], v[180:183]
    v_mfma_f32_16x16x32_bf16 v[196:199], v[76:79], v[116:119], v[196:199]
    v_mfma_f32_16x16x32_bf16 v[212:215], v[80:83], v[116:119], v[212:215]
    v_mfma_f32_16x16x32_bf16 v[228:231], v[84:87], v[116:119], v[228:231]
    s_waitcnt lgkmcnt(0)
    v_mfma_f32_16x16x32_bf16 v[120:123], v[32:35], v[88:91], v[120:123]
    ds_read_b64_tr_b16 v[104:105], v16 offset:22528
    v_mfma_f32_16x16x32_bf16 v[136:139], v[36:39], v[88:91], v[136:139]
    ds_read_b64_tr_b16 v[106:107], v16 offset:26624
    v_mfma_f32_16x16x32_bf16 v[152:155], v[40:43], v[88:91], v[152:155]
    ds_read_b64_tr_b16 v[60:61], v10 offset:22528
    v_mfma_f32_16x16x32_bf16 v[168:171], v[44:47], v[88:91], v[168:171]
    ds_read_b64_tr_b16 v[62:63], v10 offset:29696
    v_mfma_f32_16x16x32_bf16 v[184:187], v[48:51], v[88:91], v[184:187]
    ds_read_b64_tr_b16 v[64:65], v11 offset:22560
    v_mfma_f32_16x16x32_bf16 v[200:203], v[52:55], v[88:91], v[200:203]
    ds_read_b64_tr_b16 v[66:67], v11 offset:29728
    v_mfma_f32_16x16x32_bf16 v[216:219], v[56:59], v[88:91], v[216:219]
    ds_read_b64_tr_b16 v[68:69], v10 offset:22592
    v_mfma_f32_16x16x32_bf16 v[124:127], v[32:35], v[92:95], v[124:127]
    ds_read_b64_tr_b16 v[70:71], v10 offset:29760
    v_mfma_f32_16x16x32_bf16 v[140:143], v[36:39], v[92:95], v[140:143]
    ds_read_b64_tr_b16 v[72:73], v11 offset:22624
    v_mfma_f32_16x16x32_bf16 v[156:159], v[40:43], v[92:95], v[156:159]
    ds_read_b64_tr_b16 v[74:75], v11 offset:29792
    v_mfma_f32_16x16x32_bf16 v[172:175], v[44:47], v[92:95], v[172:175]
    ds_read_b64_tr_b16 v[76:77], v10 offset:22656
    v_mfma_f32_16x16x32_bf16 v[188:191], v[48:51], v[92:95], v[188:191]
    ds_read_b64_tr_b16 v[78:79], v10 offset:29824
    v_mfma_f32_16x16x32_bf16 v[204:207], v[52:55], v[92:95], v[204:207]
    ds_read_b64_tr_b16 v[80:81], v11 offset:22688
    v_mfma_f32_16x16x32_bf16 v[220:223], v[56:59], v[92:95], v[220:223]
    ds_read_b64_tr_b16 v[82:83], v11 offset:29856
    v_mfma_f32_16x16x32_bf16 v[128:131], v[32:35], v[96:99], v[128:131]
    ds_read_b64_tr_b16 v[84:85], v10 offset:22720
    v_mfma_f32_16x16x32_bf16 v[144:147], v[36:39], v[96:99], v[144:147]
    ds_read_b64_tr_b16 v[86:87], v10 offset:29888
    v_mfma_f32_16x16x32_bf16 v[160:163], v[40:43], v[96:99], v[160:163]
    ds_read_b64_tr_b16 v[108:109], v17 offset:22528
    v_mfma_f32_16x16x32_bf16 v[176:179], v[44:47], v[96:99], v[176:179]
    ds_read_b64_tr_b16 v[110:111], v17 offset:26624
    v_mfma_f32_16x16x32_bf16 v[192:195], v[48:51], v[96:99], v[192:195]
    ds_read_b64_tr_b16 v[112:113], v18 offset:22528
    v_mfma_f32_16x16x32_bf16 v[208:211], v[52:55], v[96:99], v[208:211]
    ds_read_b64_tr_b16 v[114:115], v18 offset:26624
    v_mfma_f32_16x16x32_bf16 v[224:227], v[56:59], v[96:99], v[224:227]
    ds_read_b64_tr_b16 v[116:117], v19 offset:22528
    v_mfma_f32_16x16x32_bf16 v[132:135], v[32:35], v[100:103], v[132:135]
    ds_read_b64_tr_b16 v[118:119], v19 offset:26624
    v_mfma_f32_16x16x32_bf16 v[148:151], v[36:39], v[100:103], v[148:151]
    v_mfma_f32_16x16x32_bf16 v[164:167], v[40:43], v[100:103], v[164:167]
    v_mfma_f32_16x16x32_bf16 v[180:183], v[44:47], v[100:103], v[180:183]
    v_mfma_f32_16x16x32_bf16 v[196:199], v[48:51], v[100:103], v[196:199]
    v_mfma_f32_16x16x32_bf16 v[212:215], v[52:55], v[100:103], v[212:215]
    v_mfma_f32_16x16x32_bf16 v[228:231], v[56:59], v[100:103], v[228:231]
    s_waitcnt lgkmcnt(0)
    s_barrier
    v_mfma_f32_16x16x32_bf16 v[120:123], v[60:63], v[104:107], v[120:123]
    ds_read_b64_tr_b16 v[88:89], v20 offset:0
    v_mfma_f32_16x16x32_bf16 v[136:139], v[64:67], v[104:107], v[136:139]
    ds_read_b64_tr_b16 v[90:91], v20 offset:4096
    v_mfma_f32_16x16x32_bf16 v[152:155], v[68:71], v[104:107], v[152:155]
    ds_read_b64_tr_b16 v[32:33], v12 offset:0
    v_mfma_f32_16x16x32_bf16 v[168:171], v[72:75], v[104:107], v[168:171]
    ds_read_b64_tr_b16 v[34:35], v12 offset:7168
    v_mfma_f32_16x16x32_bf16 v[184:187], v[76:79], v[104:107], v[184:187]
    ds_read_b64_tr_b16 v[36:37], v13 offset:32
    v_mfma_f32_16x16x32_bf16 v[200:203], v[80:83], v[104:107], v[200:203]
    ds_read_b64_tr_b16 v[38:39], v13 offset:7200
    v_mfma_f32_16x16x32_bf16 v[216:219], v[84:87], v[104:107], v[216:219]
    ds_read_b64_tr_b16 v[40:41], v12 offset:64
    v_mfma_f32_16x16x32_bf16 v[124:127], v[60:63], v[108:111], v[124:127]
    ds_read_b64_tr_b16 v[42:43], v12 offset:7232
    v_mfma_f32_16x16x32_bf16 v[140:143], v[64:67], v[108:111], v[140:143]
    ds_read_b64_tr_b16 v[44:45], v13 offset:96
    v_mfma_f32_16x16x32_bf16 v[156:159], v[68:71], v[108:111], v[156:159]
    ds_read_b64_tr_b16 v[46:47], v13 offset:7264
    v_mfma_f32_16x16x32_bf16 v[172:175], v[72:75], v[108:111], v[172:175]
    ds_read_b64_tr_b16 v[48:49], v12 offset:128
    v_mfma_f32_16x16x32_bf16 v[188:191], v[76:79], v[108:111], v[188:191]
    ds_read_b64_tr_b16 v[50:51], v12 offset:7296
    v_mfma_f32_16x16x32_bf16 v[204:207], v[80:83], v[108:111], v[204:207]
    ds_read_b64_tr_b16 v[52:53], v13 offset:160
    v_mfma_f32_16x16x32_bf16 v[220:223], v[84:87], v[108:111], v[220:223]
    ds_read_b64_tr_b16 v[54:55], v13 offset:7328
    v_mfma_f32_16x16x32_bf16 v[128:131], v[60:63], v[112:115], v[128:131]
    ds_read_b64_tr_b16 v[56:57], v12 offset:192
    v_mfma_f32_16x16x32_bf16 v[144:147], v[64:67], v[112:115], v[144:147]
    ds_read_b64_tr_b16 v[58:59], v12 offset:7360
    v_mfma_f32_16x16x32_bf16 v[160:163], v[68:71], v[112:115], v[160:163]
    ds_read_b64_tr_b16 v[92:93], v21 offset:0
    v_mfma_f32_16x16x32_bf16 v[176:179], v[72:75], v[112:115], v[176:179]
    ds_read_b64_tr_b16 v[94:95], v21 offset:4096
    v_mfma_f32_16x16x32_bf16 v[192:195], v[76:79], v[112:115], v[192:195]
    ds_read_b64_tr_b16 v[96:97], v22 offset:0
    v_mfma_f32_16x16x32_bf16 v[208:211], v[80:83], v[112:115], v[208:211]
    ds_read_b64_tr_b16 v[98:99], v22 offset:4096
    v_mfma_f32_16x16x32_bf16 v[224:227], v[84:87], v[112:115], v[224:227]
    ds_read_b64_tr_b16 v[100:101], v23 offset:0
    v_mfma_f32_16x16x32_bf16 v[132:135], v[60:63], v[116:119], v[132:135]
    ds_read_b64_tr_b16 v[102:103], v23 offset:4096
    v_mfma_f32_16x16x32_bf16 v[148:151], v[64:67], v[116:119], v[148:151]
    v_mfma_f32_16x16x32_bf16 v[164:167], v[68:71], v[116:119], v[164:167]
    v_mfma_f32_16x16x32_bf16 v[180:183], v[72:75], v[116:119], v[180:183]
    v_mfma_f32_16x16x32_bf16 v[196:199], v[76:79], v[116:119], v[196:199]
    v_mfma_f32_16x16x32_bf16 v[212:215], v[80:83], v[116:119], v[212:215]
    v_mfma_f32_16x16x32_bf16 v[228:231], v[84:87], v[116:119], v[228:231]
    s_cmp_lg_u32 s30, 0
    s_cbranch_scc1 noflag_sequential_preLN__ssm_conv_s4__glu_gated_swiglu__prompt_kernel_39
    s_waitcnt vmcnt(0)
    v_readfirstlane_b32 s45, v29
    s_nop 1
    s_cmp_lg_u32 s45, 15
    s_cbranch_scc1 noflag_sequential_preLN__ssm_conv_s4__glu_gated_swiglu__prompt_kernel_39
    s_add_u32 s45, s80, 2048
    v_mov_b32 v6, s45
    v_mov_b32 v7, 1
    s_mov_b64 exec, 1
    buffer_store_dword v7, v6, s[4:7], 0 offen sc1
    s_mov_b64 exec, -1
noflag_sequential_preLN__ssm_conv_s4__glu_gated_swiglu__prompt_kernel_39:
    s_waitcnt lgkmcnt(0)
    v_mfma_f32_16x16x32_bf16 v[120:123], v[32:35], v[88:91], v[120:123]
    ds_read_b64_tr_b16 v[104:105], v20 offset:22528
    v_mfma_f32_16x16x32_bf16 v[136:139], v[36:39], v[88:91], v[136:139]
    ds_read_b64_tr_b16 v[106:107], v20 offset:26624
    v_mfma_f32_16x16x32_bf16 v[152:155], v[40:43], v[88:91], v[152:155]
    ds_read_b64_tr_b16 v[60:61], v12 offset:22528
    v_mfma_f32_16x16x32_bf16 v[168:171], v[44:47], v[88:91], v[168:171]
    ds_read_b64_tr_b16 v[62:63], v12 offset:29696
    v_mfma_f32_16x16x32_bf16 v[184:187], v[48:51], v[88:91], v[184:187]
    ds_read_b64_tr_b16 v[64:65], v13 offset:22560
    v_mfma_f32_16x16x32_bf16 v[200:203], v[52:55], v[88:91], v[200:203]
    ds_read_b64_tr_b16 v[66:67], v13 offset:29728
    v_mfma_f32_16x16x32_bf16 v[216:219], v[56:59], v[88:91], v[216:219]
    ds_read_b64_tr_b16 v[68:69], v12 offset:22592
    v_mfma_f32_16x16x32_bf16 v[124:127], v[32:35], v[92:95], v[124:127]
    ds_read_b64_tr_b16 v[70:71], v12 offset:29760
    v_mfma_f32_16x16x32_bf16 v[140:143], v[36:39], v[92:95], v[140:143]
    ds_read_b64_tr_b16 v[72:73], v13 offset:22624
    v_mfma_f32_16x16x32_bf16 v[156:159], v[40:43], v[92:95], v[156:159]
    ds_read_b64_tr_b16 v[74:75], v13 offset:29792
    v_mfma_f32_16x16x32_bf16 v[172:175], v[44:47], v[92:95], v[172:175]
    ds_read_b64_tr_b16 v[76:77], v12 offset:22656
    v_mfma_f32_16x16x32_bf16 v[188:191], v[48:51], v[92:95], v[188:191]
    ds_read_b64_tr_b16 v[78:79], v12 offset:29824
    v_mfma_f32_16x16x32_bf16 v[204:207], v[52:55], v[92:95], v[204:207]
    ds_read_b64_tr_b16 v[80:81], v13 offset:22688
    v_mfma_f32_16x16x32_bf16 v[220:223], v[56:59], v[92:95], v[220:223]
    ds_read_b64_tr_b16 v[82:83], v13 offset:29856
    v_mfma_f32_16x16x32_bf16 v[128:131], v[32:35], v[96:99], v[128:131]
    ds_read_b64_tr_b16 v[84:85], v12 offset:22720
    v_mfma_f32_16x16x32_bf16 v[144:147], v[36:39], v[96:99], v[144:147]
    ds_read_b64_tr_b16 v[86:87], v12 offset:29888
    v_mfma_f32_16x16x32_bf16 v[160:163], v[40:43], v[96:99], v[160:163]
    ds_read_b64_tr_b16 v[108:109], v21 offset:22528
    v_mfma_f32_16x16x32_bf16 v[176:179], v[44:47], v[96:99], v[176:179]
    ds_read_b64_tr_b16 v[110:111], v21 offset:26624
    v_mfma_f32_16x16x32_bf16 v[192:195], v[48:51], v[96:99], v[192:195]
    ds_read_b64_tr_b16 v[112:113], v22 offset:22528
    v_mfma_f32_16x16x32_bf16 v[208:211], v[52:55], v[96:99], v[208:211]
    ds_read_b64_tr_b16 v[114:115], v22 offset:26624
    v_mfma_f32_16x16x32_bf16 v[224:227], v[56:59], v[96:99], v[224:227]
    ds_read_b64_tr_b16 v[116:117], v23 offset:22528
    v_mfma_f32_16x16x32_bf16 v[132:135], v[32:35], v[100:103], v[132:135]
    ds_read_b64_tr_b16 v[118:119], v23 offset:26624
    v_mfma_f32_16x16x32_bf16 v[148:151], v[36:39], v[100:103], v[148:151]
    v_mfma_f32_16x16x32_bf16 v[164:167], v[40:43], v[100:103], v[164:167]
    v_mfma_f32_16x16x32_bf16 v[180:183], v[44:47], v[100:103], v[180:183]
    v_mfma_f32_16x16x32_bf16 v[196:199], v[48:51], v[100:103], v[196:199]
    v_mfma_f32_16x16x32_bf16 v[212:215], v[52:55], v[100:103], v[212:215]
    v_mfma_f32_16x16x32_bf16 v[228:231], v[56:59], v[100:103], v[228:231]
    s_waitcnt lgkmcnt(0)
    s_barrier
    v_mfma_f32_16x16x32_bf16 v[120:123], v[60:63], v[104:107], v[120:123]
    ds_read_b64_tr_b16 v[88:89], v24 offset:0
    v_mfma_f32_16x16x32_bf16 v[136:139], v[64:67], v[104:107], v[136:139]
    ds_read_b64_tr_b16 v[90:91], v24 offset:4096
    v_mfma_f32_16x16x32_bf16 v[152:155], v[68:71], v[104:107], v[152:155]
    ds_read_b64_tr_b16 v[32:33], v14 offset:0
    v_mfma_f32_16x16x32_bf16 v[168:171], v[72:75], v[104:107], v[168:171]
    ds_read_b64_tr_b16 v[34:35], v14 offset:7168
    v_mfma_f32_16x16x32_bf16 v[184:187], v[76:79], v[104:107], v[184:187]
    ds_read_b64_tr_b16 v[36:37], v15 offset:32
    v_mfma_f32_16x16x32_bf16 v[200:203], v[80:83], v[104:107], v[200:203]
    ds_read_b64_tr_b16 v[38:39], v15 offset:7200
    v_mfma_f32_16x16x32_bf16 v[216:219], v[84:87], v[104:107], v[216:219]
    ds_read_b64_tr_b16 v[40:41], v14 offset:64
    v_mfma_f32_16x16x32_bf16 v[124:127], v[60:63], v[108:111], v[124:127]
    ds_read_b64_tr_b16 v[42:43], v14 offset:7232
    v_mfma_f32_16x16x32_bf16 v[140:143], v[64:67], v[108:111], v[140:143]
    ds_read_b64_tr_b16 v[44:45], v15 offset:96
    v_mfma_f32_16x16x32_bf16 v[156:159], v[68:71], v[108:111], v[156:159]
    ds_read_b64_tr_b16 v[46:47], v15 offset:7264
    v_mfma_f32_16x16x32_bf16 v[172:175], v[72:75], v[108:111], v[172:175]
    ds_read_b64_tr_b16 v[48:49], v14 offset:128
    v_mfma_f32_16x16x32_bf16 v[188:191], v[76:79], v[108:111], v[188:191]
    ds_read_b64_tr_b16 v[50:51], v14 offset:7296
    v_mfma_f32_16x16x32_bf16 v[204:207], v[80:83], v[108:111], v[204:207]
    ds_read_b64_tr_b16 v[52:53], v15 offset:160
    v_mfma_f32_16x16x32_bf16 v[220:223], v[84:87], v[108:111], v[220:223]
    ds_read_b64_tr_b16 v[54:55], v15 offset:7328
    v_mfma_f32_16x16x32_bf16 v[128:131], v[60:63], v[112:115], v[128:131]
    ds_read_b64_tr_b16 v[56:57], v14 offset:192
    v_mfma_f32_16x16x32_bf16 v[144:147], v[64:67], v[112:115], v[144:147]
    ds_read_b64_tr_b16 v[58:59], v14 offset:7360
    v_mfma_f32_16x16x32_bf16 v[160:163], v[68:71], v[112:115], v[160:163]
    ds_read_b64_tr_b16 v[92:93], v25 offset:0
    v_mfma_f32_16x16x32_bf16 v[176:179], v[72:75], v[112:115], v[176:179]
    ds_read_b64_tr_b16 v[94:95], v25 offset:4096
    v_mfma_f32_16x16x32_bf16 v[192:195], v[76:79], v[112:115], v[192:195]
    ds_read_b64_tr_b16 v[96:97], v26 offset:0
    v_mfma_f32_16x16x32_bf16 v[208:211], v[80:83], v[112:115], v[208:211]
    ds_read_b64_tr_b16 v[98:99], v26 offset:4096
    v_mfma_f32_16x16x32_bf16 v[224:227], v[84:87], v[112:115], v[224:227]
    ds_read_b64_tr_b16 v[100:101], v27 offset:0
    v_mfma_f32_16x16x32_bf16 v[132:135], v[60:63], v[116:119], v[132:135]
    ds_read_b64_tr_b16 v[102:103], v27 offset:4096
    v_mfma_f32_16x16x32_bf16 v[148:151], v[64:67], v[116:119], v[148:151]
    v_mfma_f32_16x16x32_bf16 v[164:167], v[68:71], v[116:119], v[164:167]
    v_mfma_f32_16x16x32_bf16 v[180:183], v[72:75], v[116:119], v[180:183]
    v_mfma_f32_16x16x32_bf16 v[196:199], v[76:79], v[116:119], v[196:199]
    v_mfma_f32_16x16x32_bf16 v[212:215], v[80:83], v[116:119], v[212:215]
    v_mfma_f32_16x16x32_bf16 v[228:231], v[84:87], v[116:119], v[228:231]
    s_waitcnt lgkmcnt(0)
    v_mfma_f32_16x16x32_bf16 v[120:123], v[32:35], v[88:91], v[120:123]
    ds_read_b64_tr_b16 v[104:105], v24 offset:22528
    v_mfma_f32_16x16x32_bf16 v[136:139], v[36:39], v[88:91], v[136:139]
    ds_read_b64_tr_b16 v[106:107], v24 offset:26624
    v_mfma_f32_16x16x32_bf16 v[152:155], v[40:43], v[88:91], v[152:155]
    ds_read_b64_tr_b16 v[60:61], v14 offset:22528
    v_mfma_f32_16x16x32_bf16 v[168:171], v[44:47], v[88:91], v[168:171]
    ds_read_b64_tr_b16 v[62:63], v14 offset:29696
    v_mfma_f32_16x16x32_bf16 v[184:187], v[48:51], v[88:91], v[184:187]
    ds_read_b64_tr_b16 v[64:65], v15 offset:22560
    v_mfma_f32_16x16x32_bf16 v[200:203], v[52:55], v[88:91], v[200:203]
    ds_read_b64_tr_b16 v[66:67], v15 offset:29728
    v_mfma_f32_16x16x32_bf16 v[216:219], v[56:59], v[88:91], v[216:219]
    ds_read_b64_tr_b16 v[68:69], v14 offset:22592
    v_mfma_f32_16x16x32_bf16 v[124:127], v[32:35], v[92:95], v[124:127]
    ds_read_b64_tr_b16 v[70:71], v14 offset:29760
    v_mfma_f32_16x16x32_bf16 v[140:143], v[36:39], v[92:95], v[140:143]
    ds_read_b64_tr_b16 v[72:73], v15 offset:22624
    v_mfma_f32_16x16x32_bf16 v[156:159], v[40:43], v[92:95], v[156:159]
    ds_read_b64_tr_b16 v[74:75], v15 offset:29792
    v_mfma_f32_16x16x32_bf16 v[172:175], v[44:47], v[92:95], v[172:175]
    ds_read_b64_tr_b16 v[76:77], v14 offset:22656
    v_mfma_f32_16x16x32_bf16 v[188:191], v[48:51], v[92:95], v[188:191]
    ds_read_b64_tr_b16 v[78:79], v14 offset:29824
    v_mfma_f32_16x16x32_bf16 v[204:207], v[52:55], v[92:95], v[204:207]
    ds_read_b64_tr_b16 v[80:81], v15 offset:22688
    v_mfma_f32_16x16x32_bf16 v[220:223], v[56:59], v[92:95], v[220:223]
    ds_read_b64_tr_b16 v[82:83], v15 offset:29856
    v_mfma_f32_16x16x32_bf16 v[128:131], v[32:35], v[96:99], v[128:131]
    ds_read_b64_tr_b16 v[84:85], v14 offset:22720
    v_mfma_f32_16x16x32_bf16 v[144:147], v[36:39], v[96:99], v[144:147]
    ds_read_b64_tr_b16 v[86:87], v14 offset:29888
    v_mfma_f32_16x16x32_bf16 v[160:163], v[40:43], v[96:99], v[160:163]
    ds_read_b64_tr_b16 v[108:109], v25 offset:22528
    v_mfma_f32_16x16x32_bf16 v[176:179], v[44:47], v[96:99], v[176:179]
    ds_read_b64_tr_b16 v[110:111], v25 offset:26624
    v_mfma_f32_16x16x32_bf16 v[192:195], v[48:51], v[96:99], v[192:195]
    ds_read_b64_tr_b16 v[112:113], v26 offset:22528
    v_mfma_f32_16x16x32_bf16 v[208:211], v[52:55], v[96:99], v[208:211]
    ds_read_b64_tr_b16 v[114:115], v26 offset:26624
    v_mfma_f32_16x16x32_bf16 v[224:227], v[56:59], v[96:99], v[224:227]
    ds_read_b64_tr_b16 v[116:117], v27 offset:22528
    v_mfma_f32_16x16x32_bf16 v[132:135], v[32:35], v[100:103], v[132:135]
    ds_read_b64_tr_b16 v[118:119], v27 offset:26624
    v_mfma_f32_16x16x32_bf16 v[148:151], v[36:39], v[100:103], v[148:151]
    v_mfma_f32_16x16x32_bf16 v[164:167], v[40:43], v[100:103], v[164:167]
    v_mfma_f32_16x16x32_bf16 v[180:183], v[44:47], v[100:103], v[180:183]
    v_mfma_f32_16x16x32_bf16 v[196:199], v[48:51], v[100:103], v[196:199]
    v_mfma_f32_16x16x32_bf16 v[212:215], v[52:55], v[100:103], v[212:215]
    v_mfma_f32_16x16x32_bf16 v[228:231], v[56:59], v[100:103], v[228:231]
    s_waitcnt lgkmcnt(0)
    s_barrier
    v_mfma_f32_16x16x32_bf16 v[120:123], v[60:63], v[104:107], v[120:123]
    ds_read_b64_tr_b16 v[88:89], v16 offset:0
    v_mfma_f32_16x16x32_bf16 v[136:139], v[64:67], v[104:107], v[136:139]
    ds_read_b64_tr_b16 v[90:91], v16 offset:4096
    v_mfma_f32_16x16x32_bf16 v[152:155], v[68:71], v[104:107], v[152:155]
    ds_read_b64_tr_b16 v[32:33], v10 offset:0
    v_mfma_f32_16x16x32_bf16 v[168:171], v[72:75], v[104:107], v[168:171]
    ds_read_b64_tr_b16 v[34:35], v10 offset:7168
    v_mfma_f32_16x16x32_bf16 v[184:187], v[76:79], v[104:107], v[184:187]
    ds_read_b64_tr_b16 v[36:37], v11 offset:32
    v_mfma_f32_16x16x32_bf16 v[200:203], v[80:83], v[104:107], v[200:203]
    ds_read_b64_tr_b16 v[38:39], v11 offset:7200
    v_mfma_f32_16x16x32_bf16 v[216:219], v[84:87], v[104:107], v[216:219]
    ds_read_b64_tr_b16 v[40:41], v10 offset:64
    v_mfma_f32_16x16x32_bf16 v[124:127], v[60:63], v[108:111], v[124:127]
    ds_read_b64_tr_b16 v[42:43], v10 offset:7232
    v_mfma_f32_16x16x32_bf16 v[140:143], v[64:67], v[108:111], v[140:143]
    ds_read_b64_tr_b16 v[44:45], v11 offset:96
    v_mfma_f32_16x16x32_bf16 v[156:159], v[68:71], v[108:111], v[156:159]
    ds_read_b64_tr_b16 v[46:47], v11 offset:7264
    v_mfma_f32_16x16x32_bf16 v[172:175], v[72:75], v[108:111], v[172:175]
    ds_read_b64_tr_b16 v[48:49], v10 offset:128
    v_mfma_f32_16x16x32_bf16 v[188:191], v[76:79], v[108:111], v[188:191]
    ds_read_b64_tr_b16 v[50:51], v10 offset:7296
    v_mfma_f32_16x16x32_bf16 v[204:207], v[80:83], v[108:111], v[204:207]
    ds_read_b64_tr_b16 v[52:53], v11 offset:160
    v_mfma_f32_16x16x32_bf16 v[220:223], v[84:87], v[108:111], v[220:223]
    ds_read_b64_tr_b16 v[54:55], v11 offset:7328
    v_mfma_f32_16x16x32_bf16 v[128:131], v[60:63], v[112:115], v[128:131]
    ds_read_b64_tr_b16 v[56:57], v10 offset:192
    v_mfma_f32_16x16x32_bf16 v[144:147], v[64:67], v[112:115], v[144:147]
    ds_read_b64_tr_b16 v[58:59], v10 offset:7360
    v_mfma_f32_16x16x32_bf16 v[160:163], v[68:71], v[112:115], v[160:163]
    ds_read_b64_tr_b16 v[92:93], v17 offset:0
    v_mfma_f32_16x16x32_bf16 v[176:179], v[72:75], v[112:115], v[176:179]
    ds_read_b64_tr_b16 v[94:95], v17 offset:4096
    v_mfma_f32_16x16x32_bf16 v[192:195], v[76:79], v[112:115], v[192:195]
    ds_read_b64_tr_b16 v[96:97], v18 offset:0
    v_mfma_f32_16x16x32_bf16 v[208:211], v[80:83], v[112:115], v[208:211]
    ds_read_b64_tr_b16 v[98:99], v18 offset:4096
    v_mfma_f32_16x16x32_bf16 v[224:227], v[84:87], v[112:115], v[224:227]
    ds_read_b64_tr_b16 v[100:101], v19 offset:0
    v_mfma_f32_16x16x32_bf16 v[132:135], v[60:63], v[116:119], v[132:135]
    ds_read_b64_tr_b16 v[102:103], v19 offset:4096
    v_mfma_f32_16x16x32_bf16 v[148:151], v[64:67], v[116:119], v[148:151]
    v_mfma_f32_16x16x32_bf16 v[164:167], v[68:71], v[116:119], v[164:167]
    v_mfma_f32_16x16x32_bf16 v[180:183], v[72:75], v[116:119], v[180:183]
    v_mfma_f32_16x16x32_bf16 v[196:199], v[76:79], v[116:119], v[196:199]
    v_mfma_f32_16x16x32_bf16 v[212:215], v[80:83], v[116:119], v[212:215]
    v_mfma_f32_16x16x32_bf16 v[228:231], v[84:87], v[116:119], v[228:231]
    s_waitcnt lgkmcnt(0)
    v_mfma_f32_16x16x32_bf16 v[120:123], v[32:35], v[88:91], v[120:123]
    ds_read_b64_tr_b16 v[104:105], v16 offset:22528
    v_mfma_f32_16x16x32_bf16 v[136:139], v[36:39], v[88:91], v[136:139]
    ds_read_b64_tr_b16 v[106:107], v16 offset:26624
    v_mfma_f32_16x16x32_bf16 v[152:155], v[40:43], v[88:91], v[152:155]
    ds_read_b64_tr_b16 v[60:61], v10 offset:22528
    v_mfma_f32_16x16x32_bf16 v[168:171], v[44:47], v[88:91], v[168:171]
    ds_read_b64_tr_b16 v[62:63], v10 offset:29696
    v_mfma_f32_16x16x32_bf16 v[184:187], v[48:51], v[88:91], v[184:187]
    ds_read_b64_tr_b16 v[64:65], v11 offset:22560
    v_mfma_f32_16x16x32_bf16 v[200:203], v[52:55], v[88:91], v[200:203]
    ds_read_b64_tr_b16 v[66:67], v11 offset:29728
    v_mfma_f32_16x16x32_bf16 v[216:219], v[56:59], v[88:91], v[216:219]
    ds_read_b64_tr_b16 v[68:69], v10 offset:22592
    v_mfma_f32_16x16x32_bf16 v[124:127], v[32:35], v[92:95], v[124:127]
    ds_read_b64_tr_b16 v[70:71], v10 offset:29760
    v_mfma_f32_16x16x32_bf16 v[140:143], v[36:39], v[92:95], v[140:143]
    ds_read_b64_tr_b16 v[72:73], v11 offset:22624
    v_mfma_f32_16x16x32_bf16 v[156:159], v[40:43], v[92:95], v[156:159]
    ds_read_b64_tr_b16 v[74:75], v11 offset:29792
    v_mfma_f32_16x16x32_bf16 v[172:175], v[44:47], v[92:95], v[172:175]
    ds_read_b64_tr_b16 v[76:77], v10 offset:22656
    v_mfma_f32_16x16x32_bf16 v[188:191], v[48:51], v[92:95], v[188:191]
    ds_read_b64_tr_b16 v[78:79], v10 offset:29824
    v_mfma_f32_16x16x32_bf16 v[204:207], v[52:55], v[92:95], v[204:207]
    ds_read_b64_tr_b16 v[80:81], v11 offset:22688
    v_mfma_f32_16x16x32_bf16 v[220:223], v[56:59], v[92:95], v[220:223]
    ds_read_b64_tr_b16 v[82:83], v11 offset:29856
    v_mfma_f32_16x16x32_bf16 v[128:131], v[32:35], v[96:99], v[128:131]
    ds_read_b64_tr_b16 v[84:85], v10 offset:22720
    v_mfma_f32_16x16x32_bf16 v[144:147], v[36:39], v[96:99], v[144:147]
    ds_read_b64_tr_b16 v[86:87], v10 offset:29888
    v_mfma_f32_16x16x32_bf16 v[160:163], v[40:43], v[96:99], v[160:163]
    ds_read_b64_tr_b16 v[108:109], v17 offset:22528
    v_mfma_f32_16x16x32_bf16 v[176:179], v[44:47], v[96:99], v[176:179]
    ds_read_b64_tr_b16 v[110:111], v17 offset:26624
    v_mfma_f32_16x16x32_bf16 v[192:195], v[48:51], v[96:99], v[192:195]
    ds_read_b64_tr_b16 v[112:113], v18 offset:22528
    v_mfma_f32_16x16x32_bf16 v[208:211], v[52:55], v[96:99], v[208:211]
    ds_read_b64_tr_b16 v[114:115], v18 offset:26624
    v_mfma_f32_16x16x32_bf16 v[224:227], v[56:59], v[96:99], v[224:227]
    ds_read_b64_tr_b16 v[116:117], v19 offset:22528
    v_mfma_f32_16x16x32_bf16 v[132:135], v[32:35], v[100:103], v[132:135]
    ds_read_b64_tr_b16 v[118:119], v19 offset:26624
    v_mfma_f32_16x16x32_bf16 v[148:151], v[36:39], v[100:103], v[148:151]
    v_mfma_f32_16x16x32_bf16 v[164:167], v[40:43], v[100:103], v[164:167]
    v_mfma_f32_16x16x32_bf16 v[180:183], v[44:47], v[100:103], v[180:183]
    v_mfma_f32_16x16x32_bf16 v[196:199], v[48:51], v[100:103], v[196:199]
    v_mfma_f32_16x16x32_bf16 v[212:215], v[52:55], v[100:103], v[212:215]
    v_mfma_f32_16x16x32_bf16 v[228:231], v[56:59], v[100:103], v[228:231]
    s_waitcnt lgkmcnt(0)
    s_barrier
    v_mfma_f32_16x16x32_bf16 v[120:123], v[60:63], v[104:107], v[120:123]
    ds_read_b64_tr_b16 v[88:89], v20 offset:0
    v_mfma_f32_16x16x32_bf16 v[136:139], v[64:67], v[104:107], v[136:139]
    ds_read_b64_tr_b16 v[90:91], v20 offset:4096
    v_mfma_f32_16x16x32_bf16 v[152:155], v[68:71], v[104:107], v[152:155]
    ds_read_b64_tr_b16 v[32:33], v12 offset:0
    v_mfma_f32_16x16x32_bf16 v[168:171], v[72:75], v[104:107], v[168:171]
    ds_read_b64_tr_b16 v[34:35], v12 offset:7168
    v_mfma_f32_16x16x32_bf16 v[184:187], v[76:79], v[104:107], v[184:187]
    ds_read_b64_tr_b16 v[36:37], v13 offset:32
    v_mfma_f32_16x16x32_bf16 v[200:203], v[80:83], v[104:107], v[200:203]
    ds_read_b64_tr_b16 v[38:39], v13 offset:7200
    v_mfma_f32_16x16x32_bf16 v[216:219], v[84:87], v[104:107], v[216:219]
    ds_read_b64_tr_b16 v[40:41], v12 offset:64
    v_mfma_f32_16x16x32_bf16 v[124:127], v[60:63], v[108:111], v[124:127]
    ds_read_b64_tr_b16 v[42:43], v12 offset:7232
    v_mfma_f32_16x16x32_bf16 v[140:143], v[64:67], v[108:111], v[140:143]
    ds_read_b64_tr_b16 v[44:45], v13 offset:96
    v_mfma_f32_16x16x32_bf16 v[156:159], v[68:71], v[108:111], v[156:159]
    ds_read_b64_tr_b16 v[46:47], v13 offset:7264
    v_mfma_f32_16x16x32_bf16 v[172:175], v[72:75], v[108:111], v[172:175]
    ds_read_b64_tr_b16 v[48:49], v12 offset:128
    v_mfma_f32_16x16x32_bf16 v[188:191], v[76:79], v[108:111], v[188:191]
    ds_read_b64_tr_b16 v[50:51], v12 offset:7296
    v_mfma_f32_16x16x32_bf16 v[204:207], v[80:83], v[108:111], v[204:207]
    ds_read_b64_tr_b16 v[52:53], v13 offset:160
    v_mfma_f32_16x16x32_bf16 v[220:223], v[84:87], v[108:111], v[220:223]
    ds_read_b64_tr_b16 v[54:55], v13 offset:7328
    v_mfma_f32_16x16x32_bf16 v[128:131], v[60:63], v[112:115], v[128:131]
    ds_read_b64_tr_b16 v[56:57], v12 offset:192
    v_mfma_f32_16x16x32_bf16 v[144:147], v[64:67], v[112:115], v[144:147]
    ds_read_b64_tr_b16 v[58:59], v12 offset:7360
    v_mfma_f32_16x16x32_bf16 v[160:163], v[68:71], v[112:115], v[160:163]
    ds_read_b64_tr_b16 v[92:93], v21 offset:0
    v_mfma_f32_16x16x32_bf16 v[176:179], v[72:75], v[112:115], v[176:179]
    ds_read_b64_tr_b16 v[94:95], v21 offset:4096
    v_mfma_f32_16x16x32_bf16 v[192:195], v[76:79], v[112:115], v[192:195]
    ds_read_b64_tr_b16 v[96:97], v22 offset:0
    v_mfma_f32_16x16x32_bf16 v[208:211], v[80:83], v[112:115], v[208:211]
    ds_read_b64_tr_b16 v[98:99], v22 offset:4096
    v_mfma_f32_16x16x32_bf16 v[224:227], v[84:87], v[112:115], v[224:227]
    ds_read_b64_tr_b16 v[100:101], v23 offset:0
    v_mfma_f32_16x16x32_bf16 v[132:135], v[60:63], v[116:119], v[132:135]
    ds_read_b64_tr_b16 v[102:103], v23 offset:4096
    v_mfma_f32_16x16x32_bf16 v[148:151], v[64:67], v[116:119], v[148:151]
    v_mfma_f32_16x16x32_bf16 v[164:167], v[68:71], v[116:119], v[164:167]
    v_mfma_f32_16x16x32_bf16 v[180:183], v[72:75], v[116:119], v[180:183]
    v_mfma_f32_16x16x32_bf16 v[196:199], v[76:79], v[116:119], v[196:199]
    v_mfma_f32_16x16x32_bf16 v[212:215], v[80:83], v[116:119], v[212:215]
    v_mfma_f32_16x16x32_bf16 v[228:231], v[84:87], v[116:119], v[228:231]
    s_waitcnt lgkmcnt(0)
    v_mfma_f32_16x16x32_bf16 v[120:123], v[32:35], v[88:91], v[120:123]
    ds_read_b64_tr_b16 v[104:105], v20 offset:22528
    v_mfma_f32_16x16x32_bf16 v[136:139], v[36:39], v[88:91], v[136:139]
    ds_read_b64_tr_b16 v[106:107], v20 offset:26624
    v_mfma_f32_16x16x32_bf16 v[152:155], v[40:43], v[88:91], v[152:155]
    ds_read_b64_tr_b16 v[60:61], v12 offset:22528
    v_mfma_f32_16x16x32_bf16 v[168:171], v[44:47], v[88:91], v[168:171]
    ds_read_b64_tr_b16 v[62:63], v12 offset:29696
    v_mfma_f32_16x16x32_bf16 v[184:187], v[48:51], v[88:91], v[184:187]
    ds_read_b64_tr_b16 v[64:65], v13 offset:22560
    v_mfma_f32_16x16x32_bf16 v[200:203], v[52:55], v[88:91], v[200:203]
    ds_read_b64_tr_b16 v[66:67], v13 offset:29728
    v_mfma_f32_16x16x32_bf16 v[216:219], v[56:59], v[88:91], v[216:219]
    ds_read_b64_tr_b16 v[68:69], v12 offset:22592
    v_mfma_f32_16x16x32_bf16 v[124:127], v[32:35], v[92:95], v[124:127]
    ds_read_b64_tr_b16 v[70:71], v12 offset:29760
    v_mfma_f32_16x16x32_bf16 v[140:143], v[36:39], v[92:95], v[140:143]
    ds_read_b64_tr_b16 v[72:73], v13 offset:22624
    v_mfma_f32_16x16x32_bf16 v[156:159], v[40:43], v[92:95], v[156:159]
    ds_read_b64_tr_b16 v[74:75], v13 offset:29792
    v_mfma_f32_16x16x32_bf16 v[172:175], v[44:47], v[92:95], v[172:175]
    ds_read_b64_tr_b16 v[76:77], v12 offset:22656
    v_mfma_f32_16x16x32_bf16 v[188:191], v[48:51], v[92:95], v[188:191]
    ds_read_b64_tr_b16 v[78:79], v12 offset:29824
    v_mfma_f32_16x16x32_bf16 v[204:207], v[52:55], v[92:95], v[204:207]
    ds_read_b64_tr_b16 v[80:81], v13 offset:22688
    v_mfma_f32_16x16x32_bf16 v[220:223], v[56:59], v[92:95], v[220:223]
    ds_read_b64_tr_b16 v[82:83], v13 offset:29856
    v_mfma_f32_16x16x32_bf16 v[128:131], v[32:35], v[96:99], v[128:131]
    ds_read_b64_tr_b16 v[84:85], v12 offset:22720
    v_mfma_f32_16x16x32_bf16 v[144:147], v[36:39], v[96:99], v[144:147]
    ds_read_b64_tr_b16 v[86:87], v12 offset:29888
    v_mfma_f32_16x16x32_bf16 v[160:163], v[40:43], v[96:99], v[160:163]
    ds_read_b64_tr_b16 v[108:109], v21 offset:22528
    v_mfma_f32_16x16x32_bf16 v[176:179], v[44:47], v[96:99], v[176:179]
    ds_read_b64_tr_b16 v[110:111], v21 offset:26624
    v_mfma_f32_16x16x32_bf16 v[192:195], v[48:51], v[96:99], v[192:195]
    ds_read_b64_tr_b16 v[112:113], v22 offset:22528
    v_mfma_f32_16x16x32_bf16 v[208:211], v[52:55], v[96:99], v[208:211]
    ds_read_b64_tr_b16 v[114:115], v22 offset:26624
    v_mfma_f32_16x16x32_bf16 v[224:227], v[56:59], v[96:99], v[224:227]
    ds_read_b64_tr_b16 v[116:117], v23 offset:22528
    v_mfma_f32_16x16x32_bf16 v[132:135], v[32:35], v[100:103], v[132:135]
    ds_read_b64_tr_b16 v[118:119], v23 offset:26624
    v_mfma_f32_16x16x32_bf16 v[148:151], v[36:39], v[100:103], v[148:151]
    v_mfma_f32_16x16x32_bf16 v[164:167], v[40:43], v[100:103], v[164:167]
    v_mfma_f32_16x16x32_bf16 v[180:183], v[44:47], v[100:103], v[180:183]
    v_mfma_f32_16x16x32_bf16 v[196:199], v[48:51], v[100:103], v[196:199]
    v_mfma_f32_16x16x32_bf16 v[212:215], v[52:55], v[100:103], v[212:215]
    v_mfma_f32_16x16x32_bf16 v[228:231], v[56:59], v[100:103], v[228:231]
    s_waitcnt lgkmcnt(0)
    s_barrier
    v_mfma_f32_16x16x32_bf16 v[120:123], v[60:63], v[104:107], v[120:123]
    ds_read_b64_tr_b16 v[88:89], v24 offset:0
    v_mfma_f32_16x16x32_bf16 v[136:139], v[64:67], v[104:107], v[136:139]
    ds_read_b64_tr_b16 v[90:91], v24 offset:4096
    v_mfma_f32_16x16x32_bf16 v[152:155], v[68:71], v[104:107], v[152:155]
    ds_read_b64_tr_b16 v[32:33], v14 offset:0
    v_mfma_f32_16x16x32_bf16 v[168:171], v[72:75], v[104:107], v[168:171]
    ds_read_b64_tr_b16 v[34:35], v14 offset:7168
    v_mfma_f32_16x16x32_bf16 v[184:187], v[76:79], v[104:107], v[184:187]
    ds_read_b64_tr_b16 v[36:37], v15 offset:32
    v_mfma_f32_16x16x32_bf16 v[200:203], v[80:83], v[104:107], v[200:203]
    ds_read_b64_tr_b16 v[38:39], v15 offset:7200
    v_mfma_f32_16x16x32_bf16 v[216:219], v[84:87], v[104:107], v[216:219]
    ds_read_b64_tr_b16 v[40:41], v14 offset:64
    v_mfma_f32_16x16x32_bf16 v[124:127], v[60:63], v[108:111], v[124:127]
    ds_read_b64_tr_b16 v[42:43], v14 offset:7232
    v_mfma_f32_16x16x32_bf16 v[140:143], v[64:67], v[108:111], v[140:143]
    ds_read_b64_tr_b16 v[44:45], v15 offset:96
    v_mfma_f32_16x16x32_bf16 v[156:159], v[68:71], v[108:111], v[156:159]
    ds_read_b64_tr_b16 v[46:47], v15 offset:7264
    v_mfma_f32_16x16x32_bf16 v[172:175], v[72:75], v[108:111], v[172:175]
    ds_read_b64_tr_b16 v[48:49], v14 offset:128
    v_mfma_f32_16x16x32_bf16 v[188:191], v[76:79], v[108:111], v[188:191]
    ds_read_b64_tr_b16 v[50:51], v14 offset:7296
    v_mfma_f32_16x16x32_bf16 v[204:207], v[80:83], v[108:111], v[204:207]
    ds_read_b64_tr_b16 v[52:53], v15 offset:160
    v_mfma_f32_16x16x32_bf16 v[220:223], v[84:87], v[108:111], v[220:223]
    ds_read_b64_tr_b16 v[54:55], v15 offset:7328
    v_mfma_f32_16x16x32_bf16 v[128:131], v[60:63], v[112:115], v[128:131]
    ds_read_b64_tr_b16 v[56:57], v14 offset:192
    v_mfma_f32_16x16x32_bf16 v[144:147], v[64:67], v[112:115], v[144:147]
    ds_read_b64_tr_b16 v[58:59], v14 offset:7360
    v_mfma_f32_16x16x32_bf16 v[160:163], v[68:71], v[112:115], v[160:163]
    ds_read_b64_tr_b16 v[92:93], v25 offset:0
    v_mfma_f32_16x16x32_bf16 v[176:179], v[72:75], v[112:115], v[176:179]
    ds_read_b64_tr_b16 v[94:95], v25 offset:4096
    v_mfma_f32_16x16x32_bf16 v[192:195], v[76:79], v[112:115], v[192:195]
    ds_read_b64_tr_b16 v[96:97], v26 offset:0
    v_mfma_f32_16x16x32_bf16 v[208:211], v[80:83], v[112:115], v[208:211]
    ds_read_b64_tr_b16 v[98:99], v26 offset:4096
    v_mfma_f32_16x16x32_bf16 v[224:227], v[84:87], v[112:115], v[224:227]
    ds_read_b64_tr_b16 v[100:101], v27 offset:0
    v_mfma_f32_16x16x32_bf16 v[132:135], v[60:63], v[116:119], v[132:135]
    ds_read_b64_tr_b16 v[102:103], v27 offset:4096
    v_mfma_f32_16x16x32_bf16 v[148:151], v[64:67], v[116:119], v[148:151]
    v_mfma_f32_16x16x32_bf16 v[164:167], v[68:71], v[116:119], v[164:167]
    v_mfma_f32_16x16x32_bf16 v[180:183], v[72:75], v[116:119], v[180:183]
    v_mfma_f32_16x16x32_bf16 v[196:199], v[76:79], v[116:119], v[196:199]
    v_mfma_f32_16x16x32_bf16 v[212:215], v[80:83], v[116:119], v[212:215]
    v_mfma_f32_16x16x32_bf16 v[228:231], v[84:87], v[116:119], v[228:231]
    s_waitcnt lgkmcnt(0)
    v_mfma_f32_16x16x32_bf16 v[120:123], v[32:35], v[88:91], v[120:123]
    ds_read_b64_tr_b16 v[104:105], v24 offset:22528
    v_mfma_f32_16x16x32_bf16 v[136:139], v[36:39], v[88:91], v[136:139]
    ds_read_b64_tr_b16 v[106:107], v24 offset:26624
    v_mfma_f32_16x16x32_bf16 v[152:155], v[40:43], v[88:91], v[152:155]
    ds_read_b64_tr_b16 v[60:61], v14 offset:22528
    v_mfma_f32_16x16x32_bf16 v[168:171], v[44:47], v[88:91], v[168:171]
    ds_read_b64_tr_b16 v[62:63], v14 offset:29696
    v_mfma_f32_16x16x32_bf16 v[184:187], v[48:51], v[88:91], v[184:187]
    ds_read_b64_tr_b16 v[64:65], v15 offset:22560
    v_mfma_f32_16x16x32_bf16 v[200:203], v[52:55], v[88:91], v[200:203]
    ds_read_b64_tr_b16 v[66:67], v15 offset:29728
    v_mfma_f32_16x16x32_bf16 v[216:219], v[56:59], v[88:91], v[216:219]
    ds_read_b64_tr_b16 v[68:69], v14 offset:22592
    v_mfma_f32_16x16x32_bf16 v[124:127], v[32:35], v[92:95], v[124:127]
    ds_read_b64_tr_b16 v[70:71], v14 offset:29760
    v_mfma_f32_16x16x32_bf16 v[140:143], v[36:39], v[92:95], v[140:143]
    ds_read_b64_tr_b16 v[72:73], v15 offset:22624
    v_mfma_f32_16x16x32_bf16 v[156:159], v[40:43], v[92:95], v[156:159]
    ds_read_b64_tr_b16 v[74:75], v15 offset:29792
    v_mfma_f32_16x16x32_bf16 v[172:175], v[44:47], v[92:95], v[172:175]
    ds_read_b64_tr_b16 v[76:77], v14 offset:22656
    v_mfma_f32_16x16x32_bf16 v[188:191], v[48:51], v[92:95], v[188:191]
    ds_read_b64_tr_b16 v[78:79], v14 offset:29824
    v_mfma_f32_16x16x32_bf16 v[204:207], v[52:55], v[92:95], v[204:207]
    ds_read_b64_tr_b16 v[80:81], v15 offset:22688
    v_mfma_f32_16x16x32_bf16 v[220:223], v[56:59], v[92:95], v[220:223]
    ds_read_b64_tr_b16 v[82:83], v15 offset:29856
    v_mfma_f32_16x16x32_bf16 v[128:131], v[32:35], v[96:99], v[128:131]
    ds_read_b64_tr_b16 v[84:85], v14 offset:22720
    v_mfma_f32_16x16x32_bf16 v[144:147], v[36:39], v[96:99], v[144:147]
    ds_read_b64_tr_b16 v[86:87], v14 offset:29888
    v_mfma_f32_16x16x32_bf16 v[160:163], v[40:43], v[96:99], v[160:163]
    ds_read_b64_tr_b16 v[108:109], v25 offset:22528
    v_mfma_f32_16x16x32_bf16 v[176:179], v[44:47], v[96:99], v[176:179]
    ds_read_b64_tr_b16 v[110:111], v25 offset:26624
    v_mfma_f32_16x16x32_bf16 v[192:195], v[48:51], v[96:99], v[192:195]
    ds_read_b64_tr_b16 v[112:113], v26 offset:22528
    v_mfma_f32_16x16x32_bf16 v[208:211], v[52:55], v[96:99], v[208:211]
    ds_read_b64_tr_b16 v[114:115], v26 offset:26624
    v_mfma_f32_16x16x32_bf16 v[224:227], v[56:59], v[96:99], v[224:227]
    ds_read_b64_tr_b16 v[116:117], v27 offset:22528
    v_mfma_f32_16x16x32_bf16 v[132:135], v[32:35], v[100:103], v[132:135]
    ds_read_b64_tr_b16 v[118:119], v27 offset:26624
    v_mfma_f32_16x16x32_bf16 v[148:151], v[36:39], v[100:103], v[148:151]
    v_mfma_f32_16x16x32_bf16 v[164:167], v[40:43], v[100:103], v[164:167]
    v_mfma_f32_16x16x32_bf16 v[180:183], v[44:47], v[100:103], v[180:183]
    v_mfma_f32_16x16x32_bf16 v[196:199], v[48:51], v[100:103], v[196:199]
    v_mfma_f32_16x16x32_bf16 v[212:215], v[52:55], v[100:103], v[212:215]
    v_mfma_f32_16x16x32_bf16 v[228:231], v[56:59], v[100:103], v[228:231]
    s_waitcnt lgkmcnt(0)
    s_barrier
    v_mfma_f32_16x16x32_bf16 v[120:123], v[60:63], v[104:107], v[120:123]
    ds_read_b64_tr_b16 v[88:89], v16 offset:0
    v_mfma_f32_16x16x32_bf16 v[136:139], v[64:67], v[104:107], v[136:139]
    ds_read_b64_tr_b16 v[90:91], v16 offset:4096
    v_mfma_f32_16x16x32_bf16 v[152:155], v[68:71], v[104:107], v[152:155]
    ds_read_b64_tr_b16 v[32:33], v10 offset:0
    v_mfma_f32_16x16x32_bf16 v[168:171], v[72:75], v[104:107], v[168:171]
    ds_read_b64_tr_b16 v[34:35], v10 offset:7168
    v_mfma_f32_16x16x32_bf16 v[184:187], v[76:79], v[104:107], v[184:187]
    ds_read_b64_tr_b16 v[36:37], v11 offset:32
    v_mfma_f32_16x16x32_bf16 v[200:203], v[80:83], v[104:107], v[200:203]
    ds_read_b64_tr_b16 v[38:39], v11 offset:7200
    v_mfma_f32_16x16x32_bf16 v[216:219], v[84:87], v[104:107], v[216:219]
    ds_read_b64_tr_b16 v[40:41], v10 offset:64
    v_mfma_f32_16x16x32_bf16 v[124:127], v[60:63], v[108:111], v[124:127]
    ds_read_b64_tr_b16 v[42:43], v10 offset:7232
    v_mfma_f32_16x16x32_bf16 v[140:143], v[64:67], v[108:111], v[140:143]
    ds_read_b64_tr_b16 v[44:45], v11 offset:96
    v_mfma_f32_16x16x32_bf16 v[156:159], v[68:71], v[108:111], v[156:159]
    ds_read_b64_tr_b16 v[46:47], v11 offset:7264
    v_mfma_f32_16x16x32_bf16 v[172:175], v[72:75], v[108:111], v[172:175]
    ds_read_b64_tr_b16 v[48:49], v10 offset:128
    v_mfma_f32_16x16x32_bf16 v[188:191], v[76:79], v[108:111], v[188:191]
    ds_read_b64_tr_b16 v[50:51], v10 offset:7296
    v_mfma_f32_16x16x32_bf16 v[204:207], v[80:83], v[108:111], v[204:207]
    ds_read_b64_tr_b16 v[52:53], v11 offset:160
    v_mfma_f32_16x16x32_bf16 v[220:223], v[84:87], v[108:111], v[220:223]
    ds_read_b64_tr_b16 v[54:55], v11 offset:7328
    v_mfma_f32_16x16x32_bf16 v[128:131], v[60:63], v[112:115], v[128:131]
    ds_read_b64_tr_b16 v[56:57], v10 offset:192
    v_mfma_f32_16x16x32_bf16 v[144:147], v[64:67], v[112:115], v[144:147]
    ds_read_b64_tr_b16 v[58:59], v10 offset:7360
    v_mfma_f32_16x16x32_bf16 v[160:163], v[68:71], v[112:115], v[160:163]
    ds_read_b64_tr_b16 v[92:93], v17 offset:0
    v_mfma_f32_16x16x32_bf16 v[176:179], v[72:75], v[112:115], v[176:179]
    ds_read_b64_tr_b16 v[94:95], v17 offset:4096
    v_mfma_f32_16x16x32_bf16 v[192:195], v[76:79], v[112:115], v[192:195]
    ds_read_b64_tr_b16 v[96:97], v18 offset:0
    v_mfma_f32_16x16x32_bf16 v[208:211], v[80:83], v[112:115], v[208:211]
    ds_read_b64_tr_b16 v[98:99], v18 offset:4096
    v_mfma_f32_16x16x32_bf16 v[224:227], v[84:87], v[112:115], v[224:227]
    ds_read_b64_tr_b16 v[100:101], v19 offset:0
    v_mfma_f32_16x16x32_bf16 v[132:135], v[60:63], v[116:119], v[132:135]
    ds_read_b64_tr_b16 v[102:103], v19 offset:4096
    v_mfma_f32_16x16x32_bf16 v[148:151], v[64:67], v[116:119], v[148:151]
    v_mfma_f32_16x16x32_bf16 v[164:167], v[68:71], v[116:119], v[164:167]
    v_mfma_f32_16x16x32_bf16 v[180:183], v[72:75], v[116:119], v[180:183]
    v_mfma_f32_16x16x32_bf16 v[196:199], v[76:79], v[116:119], v[196:199]
    v_mfma_f32_16x16x32_bf16 v[212:215], v[80:83], v[116:119], v[212:215]
    v_mfma_f32_16x16x32_bf16 v[228:231], v[84:87], v[116:119], v[228:231]
    s_waitcnt lgkmcnt(0)
    v_mfma_f32_16x16x32_bf16 v[120:123], v[32:35], v[88:91], v[120:123]
    ds_read_b64_tr_b16 v[104:105], v16 offset:22528
    v_mfma_f32_16x16x32_bf16 v[136:139], v[36:39], v[88:91], v[136:139]
    ds_read_b64_tr_b16 v[106:107], v16 offset:26624
    v_mfma_f32_16x16x32_bf16 v[152:155], v[40:43], v[88:91], v[152:155]
    ds_read_b64_tr_b16 v[60:61], v10 offset:22528
    v_mfma_f32_16x16x32_bf16 v[168:171], v[44:47], v[88:91], v[168:171]
    ds_read_b64_tr_b16 v[62:63], v10 offset:29696
    v_mfma_f32_16x16x32_bf16 v[184:187], v[48:51], v[88:91], v[184:187]
    ds_read_b64_tr_b16 v[64:65], v11 offset:22560
    v_mfma_f32_16x16x32_bf16 v[200:203], v[52:55], v[88:91], v[200:203]
    ds_read_b64_tr_b16 v[66:67], v11 offset:29728
    v_mfma_f32_16x16x32_bf16 v[216:219], v[56:59], v[88:91], v[216:219]
    ds_read_b64_tr_b16 v[68:69], v10 offset:22592
    v_mfma_f32_16x16x32_bf16 v[124:127], v[32:35], v[92:95], v[124:127]
    ds_read_b64_tr_b16 v[70:71], v10 offset:29760
    v_mfma_f32_16x16x32_bf16 v[140:143], v[36:39], v[92:95], v[140:143]
    ds_read_b64_tr_b16 v[72:73], v11 offset:22624
    v_mfma_f32_16x16x32_bf16 v[156:159], v[40:43], v[92:95], v[156:159]
    ds_read_b64_tr_b16 v[74:75], v11 offset:29792
    v_mfma_f32_16x16x32_bf16 v[172:175], v[44:47], v[92:95], v[172:175]
    ds_read_b64_tr_b16 v[76:77], v10 offset:22656
    v_mfma_f32_16x16x32_bf16 v[188:191], v[48:51], v[92:95], v[188:191]
    ds_read_b64_tr_b16 v[78:79], v10 offset:29824
    v_mfma_f32_16x16x32_bf16 v[204:207], v[52:55], v[92:95], v[204:207]
    ds_read_b64_tr_b16 v[80:81], v11 offset:22688
    v_mfma_f32_16x16x32_bf16 v[220:223], v[56:59], v[92:95], v[220:223]
    ds_read_b64_tr_b16 v[82:83], v11 offset:29856
    v_mfma_f32_16x16x32_bf16 v[128:131], v[32:35], v[96:99], v[128:131]
    ds_read_b64_tr_b16 v[84:85], v10 offset:22720
    v_mfma_f32_16x16x32_bf16 v[144:147], v[36:39], v[96:99], v[144:147]
    ds_read_b64_tr_b16 v[86:87], v10 offset:29888
    v_mfma_f32_16x16x32_bf16 v[160:163], v[40:43], v[96:99], v[160:163]
    ds_read_b64_tr_b16 v[108:109], v17 offset:22528
    v_mfma_f32_16x16x32_bf16 v[176:179], v[44:47], v[96:99], v[176:179]
    ds_read_b64_tr_b16 v[110:111], v17 offset:26624
    v_mfma_f32_16x16x32_bf16 v[192:195], v[48:51], v[96:99], v[192:195]
    ds_read_b64_tr_b16 v[112:113], v18 offset:22528
    v_mfma_f32_16x16x32_bf16 v[208:211], v[52:55], v[96:99], v[208:211]
    ds_read_b64_tr_b16 v[114:115], v18 offset:26624
    v_mfma_f32_16x16x32_bf16 v[224:227], v[56:59], v[96:99], v[224:227]
    ds_read_b64_tr_b16 v[116:117], v19 offset:22528
    v_mfma_f32_16x16x32_bf16 v[132:135], v[32:35], v[100:103], v[132:135]
    ds_read_b64_tr_b16 v[118:119], v19 offset:26624
    v_mfma_f32_16x16x32_bf16 v[148:151], v[36:39], v[100:103], v[148:151]
    v_mfma_f32_16x16x32_bf16 v[164:167], v[40:43], v[100:103], v[164:167]
    v_mfma_f32_16x16x32_bf16 v[180:183], v[44:47], v[100:103], v[180:183]
    v_mfma_f32_16x16x32_bf16 v[196:199], v[48:51], v[100:103], v[196:199]
    v_mfma_f32_16x16x32_bf16 v[212:215], v[52:55], v[100:103], v[212:215]
    v_mfma_f32_16x16x32_bf16 v[228:231], v[56:59], v[100:103], v[228:231]
    s_waitcnt lgkmcnt(0)
    s_barrier
    v_mfma_f32_16x16x32_bf16 v[120:123], v[60:63], v[104:107], v[120:123]
    v_mfma_f32_16x16x32_bf16 v[136:139], v[64:67], v[104:107], v[136:139]
    v_mfma_f32_16x16x32_bf16 v[152:155], v[68:71], v[104:107], v[152:155]
    v_mfma_f32_16x16x32_bf16 v[168:171], v[72:75], v[104:107], v[168:171]
    v_mfma_f32_16x16x32_bf16 v[184:187], v[76:79], v[104:107], v[184:187]
    v_mfma_f32_16x16x32_bf16 v[200:203], v[80:83], v[104:107], v[200:203]
    v_mfma_f32_16x16x32_bf16 v[216:219], v[84:87], v[104:107], v[216:219]
    v_mfma_f32_16x16x32_bf16 v[124:127], v[60:63], v[108:111], v[124:127]
    v_mfma_f32_16x16x32_bf16 v[140:143], v[64:67], v[108:111], v[140:143]
    v_mfma_f32_16x16x32_bf16 v[156:159], v[68:71], v[108:111], v[156:159]
    v_mfma_f32_16x16x32_bf16 v[172:175], v[72:75], v[108:111], v[172:175]
    v_mfma_f32_16x16x32_bf16 v[188:191], v[76:79], v[108:111], v[188:191]
    v_mfma_f32_16x16x32_bf16 v[204:207], v[80:83], v[108:111], v[204:207]
    v_mfma_f32_16x16x32_bf16 v[220:223], v[84:87], v[108:111], v[220:223]
    v_mfma_f32_16x16x32_bf16 v[128:131], v[60:63], v[112:115], v[128:131]
    v_mfma_f32_16x16x32_bf16 v[144:147], v[64:67], v[112:115], v[144:147]
    v_mfma_f32_16x16x32_bf16 v[160:163], v[68:71], v[112:115], v[160:163]
    v_mfma_f32_16x16x32_bf16 v[176:179], v[72:75], v[112:115], v[176:179]
    v_mfma_f32_16x16x32_bf16 v[192:195], v[76:79], v[112:115], v[192:195]
    v_mfma_f32_16x16x32_bf16 v[208:211], v[80:83], v[112:115], v[208:211]
    v_mfma_f32_16x16x32_bf16 v[224:227], v[84:87], v[112:115], v[224:227]
    v_mfma_f32_16x16x32_bf16 v[132:135], v[60:63], v[116:119], v[132:135]
    v_mfma_f32_16x16x32_bf16 v[148:151], v[64:67], v[116:119], v[148:151]
    v_mfma_f32_16x16x32_bf16 v[164:167], v[68:71], v[116:119], v[164:167]
    v_mfma_f32_16x16x32_bf16 v[180:183], v[72:75], v[116:119], v[180:183]
    v_mfma_f32_16x16x32_bf16 v[196:199], v[76:79], v[116:119], v[196:199]
    v_mfma_f32_16x16x32_bf16 v[212:215], v[80:83], v[116:119], v[212:215]
    v_mfma_f32_16x16x32_bf16 v[228:231], v[84:87], v[116:119], v[228:231]
    s_waitcnt lgkmcnt(0)
    v_and_b32 v6, 15, v2
    s_lshl_b32 s45, s37, 6
    v_add_u32 v6, s45, v6
    v_lshlrev_b32 v7, 4, v6
    v_add_u32 v7, 135168, v7
    ds_read_b128 v[32:35], v7 offset:0
    ds_read_b128 v[36:39], v7 offset:256
    ds_read_b128 v[40:43], v7 offset:512
    ds_read_b128 v[44:47], v7 offset:768
    s_mul_i32 s45, s36, 448
    s_add_u32 s45, s45, 137216
    v_lshlrev_b32 v8, 4, v3
    v_add_u32 v8, s45, v8
    ds_read_b128 v[60:63], v8 offset:0
    ds_read_b128 v[64:67], v8 offset:64
    ds_read_b128 v[68:71], v8 offset:128
    ds_read_b128 v[72:75], v8 offset:192
    ds_read_b128 v[76:79], v8 offset:256
    ds_read_b128 v[80:83], v8 offset:320
    ds_read_b128 v[84:87], v8 offset:384
    s_mul_i32 s45, s36, 7
    s_add_u32 s45, s45, s33
    s_lshl_b32 s45, s45, 11
    s_lshl_b32 s46, s28, 7
    s_add_u32 s45, s45, s46
    s_lshl_b32 s46, s37, 6
    s_add_u32 s45, s45, s46
    v_add_u32 v9, s45, v2
    v_lshlrev_b32 v28, 4, v9
    s_add_u32 s20, s8, 7864320
    s_addc_u32 s21, s9, 0
    s_mov_b32 s22, 7077888
    s_mov_b32 s23, 0x20000
    s_waitcnt lgkmcnt(0)
    v_pk_fma_f32 v[120:121], v[60:61], v[32:33], v[120:121] op_sel:[0,0,0] op_sel_hi:[1,0,1] neg_lo:[0,1,0] neg_hi:[0,1,0]
    v_pk_fma_f32 v[122:123], v[62:63], v[32:33], v[122:123] op_sel:[0,0,0] op_sel_hi:[1,0,1] neg_lo:[0,1,0] neg_hi:[0,1,0]
    v_pk_fma_f32 v[124:125], v[60:61], v[36:37], v[124:125] op_sel:[0,0,0] op_sel_hi:[1,0,1] neg_lo:[0,1,0] neg_hi:[0,1,0]
    v_pk_fma_f32 v[126:127], v[62:63], v[36:37], v[126:127] op_sel:[0,0,0] op_sel_hi:[1,0,1] neg_lo:[0,1,0] neg_hi:[0,1,0]
    v_pk_fma_f32 v[128:129], v[60:61], v[40:41], v[128:129] op_sel:[0,0,0] op_sel_hi:[1,0,1] neg_lo:[0,1,0] neg_hi:[0,1,0]
    v_pk_fma_f32 v[130:131], v[62:63], v[40:41], v[130:131] op_sel:[0,0,0] op_sel_hi:[1,0,1] neg_lo:[0,1,0] neg_hi:[0,1,0]
    v_pk_fma_f32 v[132:133], v[60:61], v[44:45], v[132:133] op_sel:[0,0,0] op_sel_hi:[1,0,1] neg_lo:[0,1,0] neg_hi:[0,1,0]
    v_pk_fma_f32 v[134:135], v[62:63], v[44:45], v[134:135] op_sel:[0,0,0] op_sel_hi:[1,0,1] neg_lo:[0,1,0] neg_hi:[0,1,0]
    v_pk_mul_f32 v[88:89], v[120:121], v[32:33] op_sel:[0,1] op_sel_hi:[1,1]
    v_pk_mul_f32 v[90:91], v[124:125], v[36:37] op_sel:[0,1] op_sel_hi:[1,1]
    v_pk_mul_f32 v[92:93], v[128:129], v[40:41] op_sel:[0,1] op_sel_hi:[1,1]
    v_pk_mul_f32 v[94:95], v[132:133], v[44:45] op_sel:[0,1] op_sel_hi:[1,1]
    v_exp_f32 v88, v88
    v_exp_f32 v89, v89
    v_pk_mul_f32 v[96:97], v[120:121], v[122:123]
    v_exp_f32 v90, v90
    v_exp_f32 v91, v91
    v_pk_mul_f32 v[98:99], v[124:125], v[126:127]
    v_exp_f32 v92, v92
    v_exp_f32 v93, v93
    v_pk_mul_f32 v[100:101], v[128:129], v[130:131]
    v_exp_f32 v94, v94
    v_exp_f32 v95, v95
    v_pk_mul_f32 v[102:103], v[132:133], v[134:135]
    v_pk_fma_f32 v[88:89], v[88:89], v[34:35], v[34:35] op_sel:[0,0,0] op_sel_hi:[1,0,0]
    v_pk_fma_f32 v[90:91], v[90:91], v[38:39], v[38:39] op_sel:[0,0,0] op_sel_hi:[1,0,0]
    v_pk_fma_f32 v[92:93], v[92:93], v[42:43], v[42:43] op_sel:[0,0,0] op_sel_hi:[1,0,0]
    v_pk_fma_f32 v[94:95], v[94:95], v[46:47], v[46:47] op_sel:[0,0,0] op_sel_hi:[1,0,0]
    v_rcp_f32 v88, v88
    v_rcp_f32 v89, v89
    v_rcp_f32 v90, v90
    v_rcp_f32 v91, v91
    v_rcp_f32 v92, v92
    v_rcp_f32 v93, v93
    v_rcp_f32 v94, v94
    v_rcp_f32 v95, v95
    v_pk_mul_f32 v[96:97], v[96:97], v[88:89]
    v_pk_mul_f32 v[98:99], v[98:99], v[90:91]
    v_pk_mul_f32 v[100:101], v[100:101], v[92:93]
    v_pk_mul_f32 v[102:103], v[102:103], v[94:95]
    v_cvt_pk_bf16_f32 v104, v96, v97
    v_cvt_pk_bf16_f32 v105, v98, v99
    v_cvt_pk_bf16_f32 v106, v100, v101
    v_cvt_pk_bf16_f32 v107, v102, v103
    s_mov_b32 s31, 0
    v_permlane32_swap_b32 v104, v106
    v_permlane32_swap_b32 v105, v107
    s_nop 1
    v_permlane16_swap_b32 v104, v105
    v_permlane16_swap_b32 v106, v107
    buffer_store_dwordx4 v[104:107], v28, s[20:23], s31 offen sc1
    v_pk_fma_f32 v[136:137], v[64:65], v[32:33], v[136:137] op_sel:[0,0,0] op_sel_hi:[1,0,1] neg_lo:[0,1,0] neg_hi:[0,1,0]
    v_pk_fma_f32 v[138:139], v[66:67], v[32:33], v[138:139] op_sel:[0,0,0] op_sel_hi:[1,0,1] neg_lo:[0,1,0] neg_hi:[0,1,0]
    v_pk_fma_f32 v[140:141], v[64:65], v[36:37], v[140:141] op_sel:[0,0,0] op_sel_hi:[1,0,1] neg_lo:[0,1,0] neg_hi:[0,1,0]
    v_pk_fma_f32 v[142:143], v[66:67], v[36:37], v[142:143] op_sel:[0,0,0] op_sel_hi:[1,0,1] neg_lo:[0,1,0] neg_hi:[0,1,0]
    v_pk_fma_f32 v[144:145], v[64:65], v[40:41], v[144:145] op_sel:[0,0,0] op_sel_hi:[1,0,1] neg_lo:[0,1,0] neg_hi:[0,1,0]
    v_pk_fma_f32 v[146:147], v[66:67], v[40:41], v[146:147] op_sel:[0,0,0] op_sel_hi:[1,0,1] neg_lo:[0,1,0] neg_hi:[0,1,0]
    v_pk_fma_f32 v[148:149], v[64:65], v[44:45], v[148:149] op_sel:[0,0,0] op_sel_hi:[1,0,1] neg_lo:[0,1,0] neg_hi:[0,1,0]
    v_pk_fma_f32 v[150:151], v[66:67], v[44:45], v[150:151] op_sel:[0,0,0] op_sel_hi:[1,0,1] neg_lo:[0,1,0] neg_hi:[0,1,0]
    v_pk_mul_f32 v[88:89], v[136:137], v[32:33] op_sel:[0,1] op_sel_hi:[1,1]
    v_pk_mul_f32 v[90:91], v[140:141], v[36:37] op_sel:[0,1] op_sel_hi:[1,1]
    v_pk_mul_f32 v[92:93], v[144:145], v[40:41] op_sel:[0,1] op_sel_hi:[1,1]
    v_pk_mul_f32 v[94:95], v[148:149], v[44:45] op_sel:[0,1] op_sel_hi:[1,1]
    v_exp_f32 v88, v88
    v_exp_f32 v89, v89
    v_pk_mul_f32 v[96:97], v[136:137], v[138:139]
    v_exp_f32 v90, v90
    v_exp_f32 v91, v91
    v_pk_mul_f32 v[98:99], v[140:141], v[142:143]
    v_exp_f32 v92, v92
    v_exp_f32 v93, v93
    v_pk_mul_f32 v[100:101], v[144:145], v[146:147]
    v_exp_f32 v94, v94
    v_exp_f32 v95, v95
    v_pk_mul_f32 v[102:103], v[148:149], v[150:151]
    v_pk_fma_f32 v[88:89], v[88:89], v[34:35], v[34:35] op_sel:[0,0,0] op_sel_hi:[1,0,0]
    v_pk_fma_f32 v[90:91], v[90:91], v[38:39], v[38:39] op_sel:[0,0,0] op_sel_hi:[1,0,0]
    v_pk_fma_f32 v[92:93], v[92:93], v[42:43], v[42:43] op_sel:[0,0,0] op_sel_hi:[1,0,0]
    v_pk_fma_f32 v[94:95], v[94:95], v[46:47], v[46:47] op_sel:[0,0,0] op_sel_hi:[1,0,0]
    v_rcp_f32 v88, v88
    v_rcp_f32 v89, v89
    v_rcp_f32 v90, v90
    v_rcp_f32 v91, v91
    v_rcp_f32 v92, v92
    v_rcp_f32 v93, v93
    v_rcp_f32 v94, v94
    v_rcp_f32 v95, v95
    v_pk_mul_f32 v[96:97], v[96:97], v[88:89]
    v_pk_mul_f32 v[98:99], v[98:99], v[90:91]
    v_pk_mul_f32 v[100:101], v[100:101], v[92:93]
    v_pk_mul_f32 v[102:103], v[102:103], v[94:95]
    v_cvt_pk_bf16_f32 v108, v96, v97
    v_cvt_pk_bf16_f32 v109, v98, v99
    v_cvt_pk_bf16_f32 v110, v100, v101
    v_cvt_pk_bf16_f32 v111, v102, v103
    s_mov_b32 s31, 32768
    v_permlane32_swap_b32 v108, v110
    v_permlane32_swap_b32 v109, v111
    s_nop 1
    v_permlane16_swap_b32 v108, v109
    v_permlane16_swap_b32 v110, v111
    buffer_store_dwordx4 v[108:111], v28, s[20:23], s31 offen sc1
    v_pk_fma_f32 v[152:153], v[68:69], v[32:33], v[152:153] op_sel:[0,0,0] op_sel_hi:[1,0,1] neg_lo:[0,1,0] neg_hi:[0,1,0]
    v_pk_fma_f32 v[154:155], v[70:71], v[32:33], v[154:155] op_sel:[0,0,0] op_sel_hi:[1,0,1] neg_lo:[0,1,0] neg_hi:[0,1,0]
    v_pk_fma_f32 v[156:157], v[68:69], v[36:37], v[156:157] op_sel:[0,0,0] op_sel_hi:[1,0,1] neg_lo:[0,1,0] neg_hi:[0,1,0]
    v_pk_fma_f32 v[158:159], v[70:71], v[36:37], v[158:159] op_sel:[0,0,0] op_sel_hi:[1,0,1] neg_lo:[0,1,0] neg_hi:[0,1,0]
    v_pk_fma_f32 v[160:161], v[68:69], v[40:41], v[160:161] op_sel:[0,0,0] op_sel_hi:[1,0,1] neg_lo:[0,1,0] neg_hi:[0,1,0]
    v_pk_fma_f32 v[162:163], v[70:71], v[40:41], v[162:163] op_sel:[0,0,0] op_sel_hi:[1,0,1] neg_lo:[0,1,0] neg_hi:[0,1,0]
    v_pk_fma_f32 v[164:165], v[68:69], v[44:45], v[164:165] op_sel:[0,0,0] op_sel_hi:[1,0,1] neg_lo:[0,1,0] neg_hi:[0,1,0]
    v_pk_fma_f32 v[166:167], v[70:71], v[44:45], v[166:167] op_sel:[0,0,0] op_sel_hi:[1,0,1] neg_lo:[0,1,0] neg_hi:[0,1,0]
    v_pk_mul_f32 v[88:89], v[152:153], v[32:33] op_sel:[0,1] op_sel_hi:[1,1]
    v_pk_mul_f32 v[90:91], v[156:157], v[36:37] op_sel:[0,1] op_sel_hi:[1,1]
    v_pk_mul_f32 v[92:93], v[160:161], v[40:41] op_sel:[0,1] op_sel_hi:[1,1]
    v_pk_mul_f32 v[94:95], v[164:165], v[44:45] op_sel:[0,1] op_sel_hi:[1,1]
    v_exp_f32 v88, v88
    v_exp_f32 v89, v89
    v_pk_mul_f32 v[96:97], v[152:153], v[154:155]
    v_exp_f32 v90, v90
    v_exp_f32 v91, v91
    v_pk_mul_f32 v[98:99], v[156:157], v[158:159]
    v_exp_f32 v92, v92
    v_exp_f32 v93, v93
    v_pk_mul_f32 v[100:101], v[160:161], v[162:163]
    v_exp_f32 v94, v94
    v_exp_f32 v95, v95
    v_pk_mul_f32 v[102:103], v[164:165], v[166:167]
    v_pk_fma_f32 v[88:89], v[88:89], v[34:35], v[34:35] op_sel:[0,0,0] op_sel_hi:[1,0,0]
    v_pk_fma_f32 v[90:91], v[90:91], v[38:39], v[38:39] op_sel:[0,0,0] op_sel_hi:[1,0,0]
    v_pk_fma_f32 v[92:93], v[92:93], v[42:43], v[42:43] op_sel:[0,0,0] op_sel_hi:[1,0,0]
    v_pk_fma_f32 v[94:95], v[94:95], v[46:47], v[46:47] op_sel:[0,0,0] op_sel_hi:[1,0,0]
    v_rcp_f32 v88, v88
    v_rcp_f32 v89, v89
    v_rcp_f32 v90, v90
    v_rcp_f32 v91, v91
    v_rcp_f32 v92, v92
    v_rcp_f32 v93, v93
    v_rcp_f32 v94, v94
    v_rcp_f32 v95, v95
    v_pk_mul_f32 v[96:97], v[96:97], v[88:89]
    v_pk_mul_f32 v[98:99], v[98:99], v[90:91]
    v_pk_mul_f32 v[100:101], v[100:101], v[92:93]
    v_pk_mul_f32 v[102:103], v[102:103], v[94:95]
    v_cvt_pk_bf16_f32 v112, v96, v97
    v_cvt_pk_bf16_f32 v113, v98, v99
    v_cvt_pk_bf16_f32 v114, v100, v101
    v_cvt_pk_bf16_f32 v115, v102, v103
    s_mov_b32 s31, 65536
    v_permlane32_swap_b32 v112, v114
    v_permlane32_swap_b32 v113, v115
    s_nop 1
    v_permlane16_swap_b32 v112, v113
    v_permlane16_swap_b32 v114, v115
    buffer_store_dwordx4 v[112:115], v28, s[20:23], s31 offen sc1
    v_pk_fma_f32 v[168:169], v[72:73], v[32:33], v[168:169] op_sel:[0,0,0] op_sel_hi:[1,0,1] neg_lo:[0,1,0] neg_hi:[0,1,0]
    v_pk_fma_f32 v[170:171], v[74:75], v[32:33], v[170:171] op_sel:[0,0,0] op_sel_hi:[1,0,1] neg_lo:[0,1,0] neg_hi:[0,1,0]
    v_pk_fma_f32 v[172:173], v[72:73], v[36:37], v[172:173] op_sel:[0,0,0] op_sel_hi:[1,0,1] neg_lo:[0,1,0] neg_hi:[0,1,0]
    v_pk_fma_f32 v[174:175], v[74:75], v[36:37], v[174:175] op_sel:[0,0,0] op_sel_hi:[1,0,1] neg_lo:[0,1,0] neg_hi:[0,1,0]
    v_pk_fma_f32 v[176:177], v[72:73], v[40:41], v[176:177] op_sel:[0,0,0] op_sel_hi:[1,0,1] neg_lo:[0,1,0] neg_hi:[0,1,0]
    v_pk_fma_f32 v[178:179], v[74:75], v[40:41], v[178:179] op_sel:[0,0,0] op_sel_hi:[1,0,1] neg_lo:[0,1,0] neg_hi:[0,1,0]
    v_pk_fma_f32 v[180:181], v[72:73], v[44:45], v[180:181] op_sel:[0,0,0] op_sel_hi:[1,0,1] neg_lo:[0,1,0] neg_hi:[0,1,0]
    v_pk_fma_f32 v[182:183], v[74:75], v[44:45], v[182:183] op_sel:[0,0,0] op_sel_hi:[1,0,1] neg_lo:[0,1,0] neg_hi:[0,1,0]
    v_pk_mul_f32 v[88:89], v[168:169], v[32:33] op_sel:[0,1] op_sel_hi:[1,1]
    v_pk_mul_f32 v[90:91], v[172:173], v[36:37] op_sel:[0,1] op_sel_hi:[1,1]
    v_pk_mul_f32 v[92:93], v[176:177], v[40:41] op_sel:[0,1] op_sel_hi:[1,1]
    v_pk_mul_f32 v[94:95], v[180:181], v[44:45] op_sel:[0,1] op_sel_hi:[1,1]
    v_exp_f32 v88, v88
    v_exp_f32 v89, v89
    v_pk_mul_f32 v[96:97], v[168:169], v[170:171]
    v_exp_f32 v90, v90
    v_exp_f32 v91, v91
    v_pk_mul_f32 v[98:99], v[172:173], v[174:175]
    v_exp_f32 v92, v92
    v_exp_f32 v93, v93
    v_pk_mul_f32 v[100:101], v[176:177], v[178:179]
    v_exp_f32 v94, v94
    v_exp_f32 v95, v95
    v_pk_mul_f32 v[102:103], v[180:181], v[182:183]
    v_pk_fma_f32 v[88:89], v[88:89], v[34:35], v[34:35] op_sel:[0,0,0] op_sel_hi:[1,0,0]
    v_pk_fma_f32 v[90:91], v[90:91], v[38:39], v[38:39] op_sel:[0,0,0] op_sel_hi:[1,0,0]
    v_pk_fma_f32 v[92:93], v[92:93], v[42:43], v[42:43] op_sel:[0,0,0] op_sel_hi:[1,0,0]
    v_pk_fma_f32 v[94:95], v[94:95], v[46:47], v[46:47] op_sel:[0,0,0] op_sel_hi:[1,0,0]
    v_rcp_f32 v88, v88
    v_rcp_f32 v89, v89
    v_rcp_f32 v90, v90
    v_rcp_f32 v91, v91
    v_rcp_f32 v92, v92
    v_rcp_f32 v93, v93
    v_rcp_f32 v94, v94
    v_rcp_f32 v95, v95
    v_pk_mul_f32 v[96:97], v[96:97], v[88:89]
    v_pk_mul_f32 v[98:99], v[98:99], v[90:91]
    v_pk_mul_f32 v[100:101], v[100:101], v[92:93]
    v_pk_mul_f32 v[102:103], v[102:103], v[94:95]
    v_cvt_pk_bf16_f32 v116, v96, v97
    v_cvt_pk_bf16_f32 v117, v98, v99
    v_cvt_pk_bf16_f32 v118, v100, v101
    v_cvt_pk_bf16_f32 v119, v102, v103
    s_mov_b32 s31, 98304
    v_permlane32_swap_b32 v116, v118
    v_permlane32_swap_b32 v117, v119
    s_nop 1
    v_permlane16_swap_b32 v116, v117
    v_permlane16_swap_b32 v118, v119
    buffer_store_dwordx4 v[116:119], v28, s[20:23], s31 offen sc1
    v_pk_fma_f32 v[184:185], v[76:77], v[32:33], v[184:185] op_sel:[0,0,0] op_sel_hi:[1,0,1] neg_lo:[0,1,0] neg_hi:[0,1,0]
    v_pk_fma_f32 v[186:187], v[78:79], v[32:33], v[186:187] op_sel:[0,0,0] op_sel_hi:[1,0,1] neg_lo:[0,1,0] neg_hi:[0,1,0]
    v_pk_fma_f32 v[188:189], v[76:77], v[36:37], v[188:189] op_sel:[0,0,0] op_sel_hi:[1,0,1] neg_lo:[0,1,0] neg_hi:[0,1,0]
    v_pk_fma_f32 v[190:191], v[78:79], v[36:37], v[190:191] op_sel:[0,0,0] op_sel_hi:[1,0,1] neg_lo:[0,1,0] neg_hi:[0,1,0]
    v_pk_fma_f32 v[192:193], v[76:77], v[40:41], v[192:193] op_sel:[0,0,0] op_sel_hi:[1,0,1] neg_lo:[0,1,0] neg_hi:[0,1,0]
    v_pk_fma_f32 v[194:195], v[78:79], v[40:41], v[194:195] op_sel:[0,0,0] op_sel_hi:[1,0,1] neg_lo:[0,1,0] neg_hi:[0,1,0]
    v_pk_fma_f32 v[196:197], v[76:77], v[44:45], v[196:197] op_sel:[0,0,0] op_sel_hi:[1,0,1] neg_lo:[0,1,0] neg_hi:[0,1,0]
    v_pk_fma_f32 v[198:199], v[78:79], v[44:45], v[198:199] op_sel:[0,0,0] op_sel_hi:[1,0,1] neg_lo:[0,1,0] neg_hi:[0,1,0]
    v_pk_mul_f32 v[88:89], v[184:185], v[32:33] op_sel:[0,1] op_sel_hi:[1,1]
    v_pk_mul_f32 v[90:91], v[188:189], v[36:37] op_sel:[0,1] op_sel_hi:[1,1]
    v_pk_mul_f32 v[92:93], v[192:193], v[40:41] op_sel:[0,1] op_sel_hi:[1,1]
    v_pk_mul_f32 v[94:95], v[196:197], v[44:45] op_sel:[0,1] op_sel_hi:[1,1]
    v_exp_f32 v88, v88
    v_exp_f32 v89, v89
    v_pk_mul_f32 v[96:97], v[184:185], v[186:187]
    v_exp_f32 v90, v90
    v_exp_f32 v91, v91
    v_pk_mul_f32 v[98:99], v[188:189], v[190:191]
    v_exp_f32 v92, v92
    v_exp_f32 v93, v93
    v_pk_mul_f32 v[100:101], v[192:193], v[194:195]
    v_exp_f32 v94, v94
    v_exp_f32 v95, v95
    v_pk_mul_f32 v[102:103], v[196:197], v[198:199]
    v_pk_fma_f32 v[88:89], v[88:89], v[34:35], v[34:35] op_sel:[0,0,0] op_sel_hi:[1,0,0]
    v_pk_fma_f32 v[90:91], v[90:91], v[38:39], v[38:39] op_sel:[0,0,0] op_sel_hi:[1,0,0]
    v_pk_fma_f32 v[92:93], v[92:93], v[42:43], v[42:43] op_sel:[0,0,0] op_sel_hi:[1,0,0]
    v_pk_fma_f32 v[94:95], v[94:95], v[46:47], v[46:47] op_sel:[0,0,0] op_sel_hi:[1,0,0]
    v_rcp_f32 v88, v88
    v_rcp_f32 v89, v89
    v_rcp_f32 v90, v90
    v_rcp_f32 v91, v91
    v_rcp_f32 v92, v92
    v_rcp_f32 v93, v93
    v_rcp_f32 v94, v94
    v_rcp_f32 v95, v95
    v_pk_mul_f32 v[96:97], v[96:97], v[88:89]
    v_pk_mul_f32 v[98:99], v[98:99], v[90:91]
    v_pk_mul_f32 v[100:101], v[100:101], v[92:93]
    v_pk_mul_f32 v[102:103], v[102:103], v[94:95]
    v_cvt_pk_bf16_f32 v104, v96, v97
    v_cvt_pk_bf16_f32 v105, v98, v99
    v_cvt_pk_bf16_f32 v106, v100, v101
    v_cvt_pk_bf16_f32 v107, v102, v103
    s_mov_b32 s31, 131072
    v_permlane32_swap_b32 v104, v106
    v_permlane32_swap_b32 v105, v107
    s_nop 1
    v_permlane16_swap_b32 v104, v105
    v_permlane16_swap_b32 v106, v107
    buffer_store_dwordx4 v[104:107], v28, s[20:23], s31 offen sc1
    v_pk_fma_f32 v[200:201], v[80:81], v[32:33], v[200:201] op_sel:[0,0,0] op_sel_hi:[1,0,1] neg_lo:[0,1,0] neg_hi:[0,1,0]
    v_pk_fma_f32 v[202:203], v[82:83], v[32:33], v[202:203] op_sel:[0,0,0] op_sel_hi:[1,0,1] neg_lo:[0,1,0] neg_hi:[0,1,0]
    v_pk_fma_f32 v[204:205], v[80:81], v[36:37], v[204:205] op_sel:[0,0,0] op_sel_hi:[1,0,1] neg_lo:[0,1,0] neg_hi:[0,1,0]
    v_pk_fma_f32 v[206:207], v[82:83], v[36:37], v[206:207] op_sel:[0,0,0] op_sel_hi:[1,0,1] neg_lo:[0,1,0] neg_hi:[0,1,0]
    v_pk_fma_f32 v[208:209], v[80:81], v[40:41], v[208:209] op_sel:[0,0,0] op_sel_hi:[1,0,1] neg_lo:[0,1,0] neg_hi:[0,1,0]
    v_pk_fma_f32 v[210:211], v[82:83], v[40:41], v[210:211] op_sel:[0,0,0] op_sel_hi:[1,0,1] neg_lo:[0,1,0] neg_hi:[0,1,0]
    v_pk_fma_f32 v[212:213], v[80:81], v[44:45], v[212:213] op_sel:[0,0,0] op_sel_hi:[1,0,1] neg_lo:[0,1,0] neg_hi:[0,1,0]
    v_pk_fma_f32 v[214:215], v[82:83], v[44:45], v[214:215] op_sel:[0,0,0] op_sel_hi:[1,0,1] neg_lo:[0,1,0] neg_hi:[0,1,0]
    v_pk_mul_f32 v[88:89], v[200:201], v[32:33] op_sel:[0,1] op_sel_hi:[1,1]
    v_pk_mul_f32 v[90:91], v[204:205], v[36:37] op_sel:[0,1] op_sel_hi:[1,1]
    v_pk_mul_f32 v[92:93], v[208:209], v[40:41] op_sel:[0,1] op_sel_hi:[1,1]
    v_pk_mul_f32 v[94:95], v[212:213], v[44:45] op_sel:[0,1] op_sel_hi:[1,1]
    v_exp_f32 v88, v88
    v_exp_f32 v89, v89
    v_pk_mul_f32 v[96:97], v[200:201], v[202:203]
    v_exp_f32 v90, v90
    v_exp_f32 v91, v91
    v_pk_mul_f32 v[98:99], v[204:205], v[206:207]
    v_exp_f32 v92, v92
    v_exp_f32 v93, v93
    v_pk_mul_f32 v[100:101], v[208:209], v[210:211]
    v_exp_f32 v94, v94
    v_exp_f32 v95, v95
    v_pk_mul_f32 v[102:103], v[212:213], v[214:215]
    v_pk_fma_f32 v[88:89], v[88:89], v[34:35], v[34:35] op_sel:[0,0,0] op_sel_hi:[1,0,0]
    v_pk_fma_f32 v[90:91], v[90:91], v[38:39], v[38:39] op_sel:[0,0,0] op_sel_hi:[1,0,0]
    v_pk_fma_f32 v[92:93], v[92:93], v[42:43], v[42:43] op_sel:[0,0,0] op_sel_hi:[1,0,0]
    v_pk_fma_f32 v[94:95], v[94:95], v[46:47], v[46:47] op_sel:[0,0,0] op_sel_hi:[1,0,0]
    v_rcp_f32 v88, v88
    v_rcp_f32 v89, v89
    v_rcp_f32 v90, v90
    v_rcp_f32 v91, v91
    v_rcp_f32 v92, v92
    v_rcp_f32 v93, v93
    v_rcp_f32 v94, v94
    v_rcp_f32 v95, v95
    v_pk_mul_f32 v[96:97], v[96:97], v[88:89]
    v_pk_mul_f32 v[98:99], v[98:99], v[90:91]
    v_pk_mul_f32 v[100:101], v[100:101], v[92:93]
    v_pk_mul_f32 v[102:103], v[102:103], v[94:95]
    v_cvt_pk_bf16_f32 v108, v96, v97
    v_cvt_pk_bf16_f32 v109, v98, v99
    v_cvt_pk_bf16_f32 v110, v100, v101
    v_cvt_pk_bf16_f32 v111, v102, v103
    s_mov_b32 s31, 163840
    v_permlane32_swap_b32 v108, v110
    v_permlane32_swap_b32 v109, v111
    s_nop 1
    v_permlane16_swap_b32 v108, v109
    v_permlane16_swap_b32 v110, v111
    buffer_store_dwordx4 v[108:111], v28, s[20:23], s31 offen sc1
    v_pk_fma_f32 v[216:217], v[84:85], v[32:33], v[216:217] op_sel:[0,0,0] op_sel_hi:[1,0,1] neg_lo:[0,1,0] neg_hi:[0,1,0]
    v_pk_fma_f32 v[218:219], v[86:87], v[32:33], v[218:219] op_sel:[0,0,0] op_sel_hi:[1,0,1] neg_lo:[0,1,0] neg_hi:[0,1,0]
    v_pk_fma_f32 v[220:221], v[84:85], v[36:37], v[220:221] op_sel:[0,0,0] op_sel_hi:[1,0,1] neg_lo:[0,1,0] neg_hi:[0,1,0]
    v_pk_fma_f32 v[222:223], v[86:87], v[36:37], v[222:223] op_sel:[0,0,0] op_sel_hi:[1,0,1] neg_lo:[0,1,0] neg_hi:[0,1,0]
    v_pk_fma_f32 v[224:225], v[84:85], v[40:41], v[224:225] op_sel:[0,0,0] op_sel_hi:[1,0,1] neg_lo:[0,1,0] neg_hi:[0,1,0]
    v_pk_fma_f32 v[226:227], v[86:87], v[40:41], v[226:227] op_sel:[0,0,0] op_sel_hi:[1,0,1] neg_lo:[0,1,0] neg_hi:[0,1,0]
    v_pk_fma_f32 v[228:229], v[84:85], v[44:45], v[228:229] op_sel:[0,0,0] op_sel_hi:[1,0,1] neg_lo:[0,1,0] neg_hi:[0,1,0]
    v_pk_fma_f32 v[230:231], v[86:87], v[44:45], v[230:231] op_sel:[0,0,0] op_sel_hi:[1,0,1] neg_lo:[0,1,0] neg_hi:[0,1,0]
    v_pk_mul_f32 v[88:89], v[216:217], v[32:33] op_sel:[0,1] op_sel_hi:[1,1]
    v_pk_mul_f32 v[90:91], v[220:221], v[36:37] op_sel:[0,1] op_sel_hi:[1,1]
    v_pk_mul_f32 v[92:93], v[224:225], v[40:41] op_sel:[0,1] op_sel_hi:[1,1]
    v_pk_mul_f32 v[94:95], v[228:229], v[44:45] op_sel:[0,1] op_sel_hi:[1,1]
    v_exp_f32 v88, v88
    v_exp_f32 v89, v89
    v_pk_mul_f32 v[96:97], v[216:217], v[218:219]
    v_exp_f32 v90, v90
    v_exp_f32 v91, v91
    v_pk_mul_f32 v[98:99], v[220:221], v[222:223]
    v_exp_f32 v92, v92
    v_exp_f32 v93, v93
    v_pk_mul_f32 v[100:101], v[224:225], v[226:227]
    v_exp_f32 v94, v94
    v_exp_f32 v95, v95
    v_pk_mul_f32 v[102:103], v[228:229], v[230:231]
    v_pk_fma_f32 v[88:89], v[88:89], v[34:35], v[34:35] op_sel:[0,0,0] op_sel_hi:[1,0,0]
    v_pk_fma_f32 v[90:91], v[90:91], v[38:39], v[38:39] op_sel:[0,0,0] op_sel_hi:[1,0,0]
    v_pk_fma_f32 v[92:93], v[92:93], v[42:43], v[42:43] op_sel:[0,0,0] op_sel_hi:[1,0,0]
    v_pk_fma_f32 v[94:95], v[94:95], v[46:47], v[46:47] op_sel:[0,0,0] op_sel_hi:[1,0,0]
    v_rcp_f32 v88, v88
    v_rcp_f32 v89, v89
    v_rcp_f32 v90, v90
    v_rcp_f32 v91, v91
    v_rcp_f32 v92, v92
    v_rcp_f32 v93, v93
    v_rcp_f32 v94, v94
    v_rcp_f32 v95, v95
    v_pk_mul_f32 v[96:97], v[96:97], v[88:89]
    v_pk_mul_f32 v[98:99], v[98:99], v[90:91]
    v_pk_mul_f32 v[100:101], v[100:101], v[92:93]
    v_pk_mul_f32 v[102:103], v[102:103], v[94:95]
    v_cvt_pk_bf16_f32 v112, v96, v97
    v_cvt_pk_bf16_f32 v113, v98, v99
    v_cvt_pk_bf16_f32 v114, v100, v101
    v_cvt_pk_bf16_f32 v115, v102, v103
    s_mov_b32 s31, 196608
    v_permlane32_swap_b32 v112, v114
    v_permlane32_swap_b32 v113, v115
    s_nop 1
    v_permlane16_swap_b32 v112, v113
    v_permlane16_swap_b32 v114, v115
    buffer_store_dwordx4 v[112:115], v28, s[20:23], s31 offen sc1
    s_and_b32 s34, s2, 7
    s_lshr_b32 s35, s2, 3
    s_and_b32 s92, s34, 1
    s_lshl_b32 s92, s92, 2
    s_and_b32 s45, s35, 3
    s_add_u32 s92, s92, s45
    s_lshr_b32 s93, s34, 1
    s_lshl_b32 s93, s93, 3
    s_lshr_b32 s45, s35, 2
    s_add_u32 s93, s93, s45
    s_and_b32 s45, s93, 7
    s_mul_i32 s45, s45, 14
    s_lshr_b32 s94, s45, 3
    s_lshl_b32 s36, s93, 6
    s_lshl_b32 s37, s30, 4
    s_add_u32 s36, s36, s37
    v_and_or_b32 v9, v2, 15, s36
    v_lshl_add_u32 v7, v3, 11, v9
    v_lshlrev_b32 v120, 4, v7
    s_mul_i32 s37, s36, 1280
    s_mul_i32 s45, s92, 160
    s_add_u32 s37, s37, s45
    s_mul_i32 s36, s30, 2816
    s_add_u32 s36, s36, 0
    v_and_b32 v7, 15, v2
    v_mul_u32_u24 v7, 176, v7
    v_lshl_add_u32 v7, v3, 3, v7
    v_add_u32 v122, s36, v7
    v_add_u32 v6, 0, v2
    v_mul_u32_u24 v7, 6554, v6
    v_lshrrev_b32 v7, 16, v7
    v_mul_u32_u24 v8, 10, v7
    v_sub_u32 v6, v6, v8
    v_lshlrev_b32 v6, 4, v6
    v_mul_u32_u24 v8, 176, v7
    v_add3_u32 v126, v8, v6, s36
    v_mul_u32_u24 v8, 1280, v7
    v_add3_u32 v129, v8, v6, s37
    v_add_u32 v6, 64, v2
    v_mul_u32_u24 v7, 6554, v6
    v_lshrrev_b32 v7, 16, v7
    v_mul_u32_u24 v8, 10, v7
    v_sub_u32 v6, v6, v8
    v_lshlrev_b32 v6, 4, v6
    v_mul_u32_u24 v8, 176, v7
    v_add3_u32 v127, v8, v6, s36
    v_mul_u32_u24 v8, 1280, v7
    v_add3_u32 v130, v8, v6, s37
    v_add_u32 v6, 128, v2
    v_mul_u32_u24 v7, 6554, v6
    v_lshrrev_b32 v7, 16, v7
    v_mul_u32_u24 v8, 10, v7
    v_sub_u32 v6, v6, v8
    v_lshlrev_b32 v6, 4, v6
    v_mul_u32_u24 v8, 176, v7
    v_add3_u32 v128, v8, v6, s36
    v_mul_u32_u24 v8, 1280, v7
    v_add3_u32 v131, v8, v6, s37
    v_bfe_u32 v6, v2, 2, 2
    v_lshl_add_u32 v6, v3, 2, v6
    v_and_b32 v7, 3, v2
    v_lshlrev_b32 v7, 3, v7
    v_lshlrev_b32 v123, 4, v2
    v_add_u32 v124, 61440, v123
    v_add_u32 v125, 122880, v123
    v_lshl_add_u32 v6, v6, 7, v7
    s_lshl_b32 s36, s30, 5
    s_add_u32 s36, s36, 143360
    v_add_u32 v121, s36, v6
    v_mov_b32 v132, 0
    v_mov_b32 v133, 0
    v_mov_b32 v134, 0
    v_mov_b32 v135, 0
    v_mov_b32 v136, 0
    v_mov_b32 v137, 0
    v_mov_b32 v138, 0
    v_mov_b32 v139, 0
    v_mov_b32 v140, 0
    v_mov_b32 v141, 0
    v_mov_b32 v142, 0
    v_mov_b32 v143, 0
    v_mov_b32 v144, 0
    v_mov_b32 v145, 0
    v_mov_b32 v146, 0
    v_mov_b32 v147, 0
    v_mov_b32 v148, 0
    v_mov_b32 v149, 0
    v_mov_b32 v150, 0
    v_mov_b32 v151, 0
    s_mov_b32 s24, s96
    s_mov_b32 s25, s97
    s_mov_b32 s26, 2621440
    s_mov_b32 s27, 0x20000
    s_waitcnt vmcnt(0)
    s_barrier
    s_cmp_lg_u32 s30, 0
    s_cbranch_scc1 g_skip_sequential_preLN__ssm_conv_s4__glu_gated_swiglu__prompt_kernel_40
    s_lshl_b32 s45, s28, 7
    s_add_u32 s45, s45, 4096
    v_mov_b32 v6, s45
    v_mov_b32 v7, 1
    s_mov_b64 exec, 1
    buffer_atomic_add v7, v6, s[4:7], 0 offen sc0
    s_waitcnt vmcnt(0)
    v_readfirstlane_b32 s46, v7
    s_nop 1
    s_cmp_lg_u32 s46, 15
    s_cbranch_scc1 g_notlast_sequential_preLN__ssm_conv_s4__glu_gated_swiglu__prompt_kernel_41
    s_add_u32 s45, s45, 2048
    v_mov_b32 v6, s45
    v_mov_b32 v7, 1
    buffer_store_dword v7, v6, s[4:7], 0 offen sc1
g_notlast_sequential_preLN__ssm_conv_s4__glu_gated_swiglu__prompt_kernel_41:
    s_lshr_b32 s45, s93, 1
    s_lshl_b32 s45, s45, 7
    s_add_u32 s45, s45, 6144
    v_mov_b32 v6, s45
    s_mov_b32 s47, 0x40000
g_poll_sequential_preLN__ssm_conv_s4__glu_gated_swiglu__prompt_kernel_42:
    buffer_load_dword v7, v6, s[4:7], 0 offen sc1
    s_waitcnt vmcnt(0)
    v_readfirstlane_b32 s46, v7
    s_nop 1
    s_cmp_lg_u32 s46, 0
    s_cbranch_scc1 g_done_sequential_preLN__ssm_conv_s4__glu_gated_swiglu__prompt_kernel_43
    s_sleep 1
    s_sub_u32 s47, s47, 1
    s_cmp_lg_u32 s47, 0
    s_cbranch_scc1 g_poll_sequential_preLN__ssm_conv_s4__glu_gated_swiglu__prompt_kernel_42
g_done_sequential_preLN__ssm_conv_s4__glu_gated_swiglu__prompt_kernel_43:
    s_mov_b64 exec, -1
g_skip_sequential_preLN__ssm_conv_s4__glu_gated_swiglu__prompt_kernel_40:
    s_barrier
    s_mov_b32 s32, s94
    s_lshl_b32 s40, s32, 19
    s_add_u32 s32, s32, 1
    s_cmp_eq_u32 s32, 14
    s_cselect_b32 s32, 0, s32
    s_add_u32 s31, s40, 0
    buffer_load_dwordx4 v[32:35], v120, s[20:23], s31 offen sc1
    s_add_u32 s31, s40, 131072
    buffer_load_dwordx4 v[36:39], v120, s[20:23], s31 offen sc1
    s_add_u32 s31, s40, 262144
    buffer_load_dwordx4 v[40:43], v120, s[20:23], s31 offen sc1
    s_add_u32 s31, s40, 393216
    buffer_load_dwordx4 v[44:47], v120, s[20:23], s31 offen sc1
    ds_read_b128 v[152:155], v123 offset:0
    ds_read_b128 v[156:159], v123 offset:1024
    ds_read_b128 v[160:163], v123 offset:2048
    ds_read_b128 v[164:167], v123 offset:3072
    ds_read_b128 v[168:171], v123 offset:4096
    ds_read_b128 v[172:175], v123 offset:5120
    ds_read_b128 v[176:179], v123 offset:6144
    ds_read_b128 v[180:183], v123 offset:7168
    ds_read_b128 v[184:187], v123 offset:8192
    ds_read_b128 v[188:191], v123 offset:9216
    s_lshl_b32 s40, s32, 19
    s_add_u32 s32, s32, 1
    s_cmp_eq_u32 s32, 14
    s_cselect_b32 s32, 0, s32
    s_add_u32 s31, s40, 0
    buffer_load_dwordx4 v[48:51], v120, s[20:23], s31 offen sc1
    s_add_u32 s31, s40, 131072
    buffer_load_dwordx4 v[52:55], v120, s[20:23], s31 offen sc1
    s_add_u32 s31, s40, 262144
    buffer_load_dwordx4 v[56:59], v120, s[20:23], s31 offen sc1
    s_add_u32 s31, s40, 393216
    buffer_load_dwordx4 v[60:63], v120, s[20:23], s31 offen sc1
    s_lshl_b32 s40, s32, 19
    s_add_u32 s32, s32, 1
    s_cmp_eq_u32 s32, 14
    s_cselect_b32 s32, 0, s32
    s_add_u32 s31, s40, 0
    buffer_load_dwordx4 v[64:67], v120, s[20:23], s31 offen sc1
    s_add_u32 s31, s40, 131072
    buffer_load_dwordx4 v[68:71], v120, s[20:23], s31 offen sc1
    s_add_u32 s31, s40, 262144
    buffer_load_dwordx4 v[72:75], v120, s[20:23], s31 offen sc1
    s_add_u32 s31, s40, 393216
    buffer_load_dwordx4 v[76:79], v120, s[20:23], s31 offen sc1
    s_waitcnt vmcnt(8)
    s_waitcnt lgkmcnt(5)
    v_mfma_f32_16x16x32_bf16 v[132:135], v[152:155], v[32:35], v[132:135]
    ds_read_b128 v[192:195], v123 offset:10240
    v_mfma_f32_16x16x32_bf16 v[136:139], v[156:159], v[32:35], v[136:139]
    ds_read_b128 v[196:199], v123 offset:11264
    v_mfma_f32_16x16x32_bf16 v[140:143], v[160:163], v[32:35], v[140:143]
    ds_read_b128 v[200:203], v123 offset:12288
    v_mfma_f32_16x16x32_bf16 v[144:147], v[164:167], v[32:35], v[144:147]
    ds_read_b128 v[204:207], v123 offset:13312
    v_mfma_f32_16x16x32_bf16 v[148:151], v[168:171], v[32:35], v[148:151]
    ds_read_b128 v[208:211], v123 offset:14336
    s_waitcnt lgkmcnt(5)
    v_mfma_f32_16x16x32_bf16 v[132:135], v[172:175], v[36:39], v[132:135]
    ds_read_b128 v[152:155], v123 offset:15360
    v_mfma_f32_16x16x32_bf16 v[136:139], v[176:179], v[36:39], v[136:139]
    ds_read_b128 v[156:159], v123 offset:16384
    v_mfma_f32_16x16x32_bf16 v[140:143], v[180:183], v[36:39], v[140:143]
    ds_read_b128 v[160:163], v123 offset:17408
    v_mfma_f32_16x16x32_bf16 v[144:147], v[184:187], v[36:39], v[144:147]
    ds_read_b128 v[164:167], v123 offset:18432
    v_mfma_f32_16x16x32_bf16 v[148:151], v[188:191], v[36:39], v[148:151]
    ds_read_b128 v[168:171], v123 offset:19456
    s_barrier
    s_waitcnt lgkmcnt(5)
    v_mfma_f32_16x16x32_bf16 v[132:135], v[192:195], v[40:43], v[132:135]
    ds_read_b128 v[172:175], v123 offset:20480
    s_lshl_b32 s40, s32, 19
    s_add_u32 s32, s32, 1
    s_cmp_eq_u32 s32, 14
    s_cselect_b32 s32, 0, s32
    s_add_u32 s31, s40, 0
    buffer_load_dwordx4 v[80:83], v120, s[20:23], s31 offen sc1
    v_mfma_f32_16x16x32_bf16 v[136:139], v[196:199], v[40:43], v[136:139]
    ds_read_b128 v[176:179], v123 offset:21504
    v_mfma_f32_16x16x32_bf16 v[140:143], v[200:203], v[40:43], v[140:143]
    ds_read_b128 v[180:183], v123 offset:22528
    v_mfma_f32_16x16x32_bf16 v[144:147], v[204:207], v[40:43], v[144:147]
    ds_read_b128 v[184:187], v123 offset:23552
    v_mfma_f32_16x16x32_bf16 v[148:151], v[208:211], v[40:43], v[148:151]
    ds_read_b128 v[188:191], v123 offset:24576
    s_waitcnt lgkmcnt(5)
    v_mfma_f32_16x16x32_bf16 v[132:135], v[152:155], v[44:47], v[132:135]
    ds_read_b128 v[192:195], v123 offset:25600
    s_add_u32 s31, s40, 131072
    buffer_load_dwordx4 v[84:87], v120, s[20:23], s31 offen sc1
    v_mfma_f32_16x16x32_bf16 v[136:139], v[156:159], v[44:47], v[136:139]
    ds_read_b128 v[196:199], v123 offset:26624
    v_mfma_f32_16x16x32_bf16 v[140:143], v[160:163], v[44:47], v[140:143]
    ds_read_b128 v[200:203], v123 offset:27648
    v_mfma_f32_16x16x32_bf16 v[144:147], v[164:167], v[44:47], v[144:147]
    ds_read_b128 v[204:207], v123 offset:28672
    v_mfma_f32_16x16x32_bf16 v[148:151], v[168:171], v[44:47], v[148:151]
    ds_read_b128 v[208:211], v123 offset:29696
    s_waitcnt vmcnt(6)
    s_waitcnt lgkmcnt(5)
    v_mfma_f32_16x16x32_bf16 v[132:135], v[172:175], v[48:51], v[132:135]
    ds_read_b128 v[152:155], v123 offset:30720
    s_add_u32 s31, s40, 262144
    buffer_load_dwordx4 v[88:91], v120, s[20:23], s31 offen sc1
    v_mfma_f32_16x16x32_bf16 v[136:139], v[176:179], v[48:51], v[136:139]
    ds_read_b128 v[156:159], v123 offset:31744
    v_mfma_f32_16x16x32_bf16 v[140:143], v[180:183], v[48:51], v[140:143]
    ds_read_b128 v[160:163], v123 offset:32768
    v_mfma_f32_16x16x32_bf16 v[144:147], v[184:187], v[48:51], v[144:147]
    ds_read_b128 v[164:167], v123 offset:33792
    v_mfma_f32_16x16x32_bf16 v[148:151], v[188:191], v[48:51], v[148:151]
    ds_read_b128 v[168:171], v123 offset:34816
    s_waitcnt lgkmcnt(5)
    v_mfma_f32_16x16x32_bf16 v[132:135], v[192:195], v[52:55], v[132:135]
    ds_read_b128 v[172:175], v123 offset:35840
    s_add_u32 s31, s40, 393216
    buffer_load_dwordx4 v[92:95], v120, s[20:23], s31 offen sc1
    v_mfma_f32_16x16x32_bf16 v[136:139], v[196:199], v[52:55], v[136:139]
    ds_read_b128 v[176:179], v123 offset:36864
    v_mfma_f32_16x16x32_bf16 v[140:143], v[200:203], v[52:55], v[140:143]
    ds_read_b128 v[180:183], v123 offset:37888
    v_mfma_f32_16x16x32_bf16 v[144:147], v[204:207], v[52:55], v[144:147]
    ds_read_b128 v[184:187], v123 offset:38912
    v_mfma_f32_16x16x32_bf16 v[148:151], v[208:211], v[52:55], v[148:151]
    ds_read_b128 v[188:191], v123 offset:39936
    s_barrier
    s_waitcnt lgkmcnt(5)
    v_mfma_f32_16x16x32_bf16 v[132:135], v[152:155], v[56:59], v[132:135]
    ds_read_b128 v[192:195], v123 offset:40960
    s_lshl_b32 s40, s32, 19
    s_add_u32 s32, s32, 1
    s_cmp_eq_u32 s32, 14
    s_cselect_b32 s32, 0, s32
    s_add_u32 s31, s40, 0
    buffer_load_dwordx4 v[32:35], v120, s[20:23], s31 offen sc1
    v_mfma_f32_16x16x32_bf16 v[136:139], v[156:159], v[56:59], v[136:139]
    ds_read_b128 v[196:199], v123 offset:41984
    v_mfma_f32_16x16x32_bf16 v[140:143], v[160:163], v[56:59], v[140:143]
    ds_read_b128 v[200:203], v123 offset:43008
    v_mfma_f32_16x16x32_bf16 v[144:147], v[164:167], v[56:59], v[144:147]
    ds_read_b128 v[204:207], v123 offset:44032
    v_mfma_f32_16x16x32_bf16 v[148:151], v[168:171], v[56:59], v[148:151]
    ds_read_b128 v[208:211], v123 offset:45056
    s_waitcnt lgkmcnt(5)
    v_mfma_f32_16x16x32_bf16 v[132:135], v[172:175], v[60:63], v[132:135]
    ds_read_b128 v[152:155], v123 offset:46080
    s_add_u32 s31, s40, 131072
    buffer_load_dwordx4 v[36:39], v120, s[20:23], s31 offen sc1
    v_mfma_f32_16x16x32_bf16 v[136:139], v[176:179], v[60:63], v[136:139]
    ds_read_b128 v[156:159], v123 offset:47104
    v_mfma_f32_16x16x32_bf16 v[140:143], v[180:183], v[60:63], v[140:143]
    ds_read_b128 v[160:163], v123 offset:48128
    v_mfma_f32_16x16x32_bf16 v[144:147], v[184:187], v[60:63], v[144:147]
    ds_read_b128 v[164:167], v123 offset:49152
    v_mfma_f32_16x16x32_bf16 v[148:151], v[188:191], v[60:63], v[148:151]
    ds_read_b128 v[168:171], v123 offset:50176
    s_waitcnt vmcnt(6)
    s_waitcnt lgkmcnt(5)
    v_mfma_f32_16x16x32_bf16 v[132:135], v[192:195], v[64:67], v[132:135]
    ds_read_b128 v[172:175], v123 offset:51200
    s_add_u32 s31, s40, 262144
    buffer_load_dwordx4 v[40:43], v120, s[20:23], s31 offen sc1
    v_mfma_f32_16x16x32_bf16 v[136:139], v[196:199], v[64:67], v[136:139]
    ds_read_b128 v[176:179], v123 offset:52224
    v_mfma_f32_16x16x32_bf16 v[140:143], v[200:203], v[64:67], v[140:143]
    ds_read_b128 v[180:183], v123 offset:53248
    v_mfma_f32_16x16x32_bf16 v[144:147], v[204:207], v[64:67], v[144:147]
    ds_read_b128 v[184:187], v123 offset:54272
    v_mfma_f32_16x16x32_bf16 v[148:151], v[208:211], v[64:67], v[148:151]
    ds_read_b128 v[188:191], v123 offset:55296
    s_waitcnt lgkmcnt(5)
    v_mfma_f32_16x16x32_bf16 v[132:135], v[152:155], v[68:71], v[132:135]
    ds_read_b128 v[192:195], v123 offset:56320
    s_add_u32 s31, s40, 393216
    buffer_load_dwordx4 v[44:47], v120, s[20:23], s31 offen sc1
    v_mfma_f32_16x16x32_bf16 v[136:139], v[156:159], v[68:71], v[136:139]
    ds_read_b128 v[196:199], v123 offset:57344
    v_mfma_f32_16x16x32_bf16 v[140:143], v[160:163], v[68:71], v[140:143]
    ds_read_b128 v[200:203], v123 offset:58368
    v_mfma_f32_16x16x32_bf16 v[144:147], v[164:167], v[68:71], v[144:147]
    ds_read_b128 v[204:207], v123 offset:59392
    v_mfma_f32_16x16x32_bf16 v[148:151], v[168:171], v[68:71], v[148:151]
    ds_read_b128 v[208:211], v123 offset:60416
    s_barrier
    s_waitcnt lgkmcnt(5)
    v_mfma_f32_16x16x32_bf16 v[132:135], v[172:175], v[72:75], v[132:135]
    ds_read_b128 v[152:155], v124 offset:0
    s_lshl_b32 s40, s32, 19
    s_add_u32 s32, s32, 1
    s_cmp_eq_u32 s32, 14
    s_cselect_b32 s32, 0, s32
    s_add_u32 s31, s40, 0
    buffer_load_dwordx4 v[48:51], v120, s[20:23], s31 offen sc1
    v_mfma_f32_16x16x32_bf16 v[136:139], v[176:179], v[72:75], v[136:139]
    ds_read_b128 v[156:159], v124 offset:1024
    v_mfma_f32_16x16x32_bf16 v[140:143], v[180:183], v[72:75], v[140:143]
    ds_read_b128 v[160:163], v124 offset:2048
    v_mfma_f32_16x16x32_bf16 v[144:147], v[184:187], v[72:75], v[144:147]
    ds_read_b128 v[164:167], v124 offset:3072
    v_mfma_f32_16x16x32_bf16 v[148:151], v[188:191], v[72:75], v[148:151]
    ds_read_b128 v[168:171], v124 offset:4096
    s_waitcnt lgkmcnt(5)
    v_mfma_f32_16x16x32_bf16 v[132:135], v[192:195], v[76:79], v[132:135]
    ds_read_b128 v[172:175], v124 offset:5120
    s_add_u32 s31, s40, 131072
    buffer_load_dwordx4 v[52:55], v120, s[20:23], s31 offen sc1
    v_mfma_f32_16x16x32_bf16 v[136:139], v[196:199], v[76:79], v[136:139]
    ds_read_b128 v[176:179], v124 offset:6144
    v_mfma_f32_16x16x32_bf16 v[140:143], v[200:203], v[76:79], v[140:143]
    ds_read_b128 v[180:183], v124 offset:7168
    v_mfma_f32_16x16x32_bf16 v[144:147], v[204:207], v[76:79], v[144:147]
    ds_read_b128 v[184:187], v124 offset:8192
    v_mfma_f32_16x16x32_bf16 v[148:151], v[208:211], v[76:79], v[148:151]
    ds_read_b128 v[188:191], v124 offset:9216
    s_waitcnt vmcnt(6)
    s_waitcnt lgkmcnt(5)
    v_mfma_f32_16x16x32_bf16 v[132:135], v[152:155], v[80:83], v[132:135]
    ds_read_b128 v[192:195], v124 offset:10240
    s_add_u32 s31, s40, 262144
    buffer_load_dwordx4 v[56:59], v120, s[20:23], s31 offen sc1
    v_mfma_f32_16x16x32_bf16 v[136:139], v[156:159], v[80:83], v[136:139]
    ds_read_b128 v[196:199], v124 offset:11264
    v_mfma_f32_16x16x32_bf16 v[140:143], v[160:163], v[80:83], v[140:143]
    ds_read_b128 v[200:203], v124 offset:12288
    v_mfma_f32_16x16x32_bf16 v[144:147], v[164:167], v[80:83], v[144:147]
    ds_read_b128 v[204:207], v124 offset:13312
    v_mfma_f32_16x16x32_bf16 v[148:151], v[168:171], v[80:83], v[148:151]
    ds_read_b128 v[208:211], v124 offset:14336
    s_waitcnt lgkmcnt(5)
    v_mfma_f32_16x16x32_bf16 v[132:135], v[172:175], v[84:87], v[132:135]
    ds_read_b128 v[152:155], v124 offset:15360
    s_add_u32 s31, s40, 393216
    buffer_load_dwordx4 v[60:63], v120, s[20:23], s31 offen sc1
    v_mfma_f32_16x16x32_bf16 v[136:139], v[176:179], v[84:87], v[136:139]
    ds_read_b128 v[156:159], v124 offset:16384
    v_mfma_f32_16x16x32_bf16 v[140:143], v[180:183], v[84:87], v[140:143]
    ds_read_b128 v[160:163], v124 offset:17408
    v_mfma_f32_16x16x32_bf16 v[144:147], v[184:187], v[84:87], v[144:147]
    ds_read_b128 v[164:167], v124 offset:18432
    v_mfma_f32_16x16x32_bf16 v[148:151], v[188:191], v[84:87], v[148:151]
    ds_read_b128 v[168:171], v124 offset:19456
    s_barrier
    s_waitcnt lgkmcnt(5)
    v_mfma_f32_16x16x32_bf16 v[132:135], v[192:195], v[88:91], v[132:135]
    ds_read_b128 v[172:175], v124 offset:20480
    s_lshl_b32 s40, s32, 19
    s_add_u32 s32, s32, 1
    s_cmp_eq_u32 s32, 14
    s_cselect_b32 s32, 0, s32
    s_add_u32 s31, s40, 0
    buffer_load_dwordx4 v[64:67], v120, s[20:23], s31 offen sc1
    v_mfma_f32_16x16x32_bf16 v[136:139], v[196:199], v[88:91], v[136:139]
    ds_read_b128 v[176:179], v124 offset:21504
    v_mfma_f32_16x16x32_bf16 v[140:143], v[200:203], v[88:91], v[140:143]
    ds_read_b128 v[180:183], v124 offset:22528
    v_mfma_f32_16x16x32_bf16 v[144:147], v[204:207], v[88:91], v[144:147]
    ds_read_b128 v[184:187], v124 offset:23552
    v_mfma_f32_16x16x32_bf16 v[148:151], v[208:211], v[88:91], v[148:151]
    ds_read_b128 v[188:191], v124 offset:24576
    s_waitcnt lgkmcnt(5)
    v_mfma_f32_16x16x32_bf16 v[132:135], v[152:155], v[92:95], v[132:135]
    ds_read_b128 v[192:195], v124 offset:25600
    s_add_u32 s31, s40, 131072
    buffer_load_dwordx4 v[68:71], v120, s[20:23], s31 offen sc1
    v_mfma_f32_16x16x32_bf16 v[136:139], v[156:159], v[92:95], v[136:139]
    ds_read_b128 v[196:199], v124 offset:26624
    v_mfma_f32_16x16x32_bf16 v[140:143], v[160:163], v[92:95], v[140:143]
    ds_read_b128 v[200:203], v124 offset:27648
    v_mfma_f32_16x16x32_bf16 v[144:147], v[164:167], v[92:95], v[144:147]
    ds_read_b128 v[204:207], v124 offset:28672
    v_mfma_f32_16x16x32_bf16 v[148:151], v[168:171], v[92:95], v[148:151]
    ds_read_b128 v[208:211], v124 offset:29696
    s_waitcnt vmcnt(6)
    s_waitcnt lgkmcnt(5)
    v_mfma_f32_16x16x32_bf16 v[132:135], v[172:175], v[32:35], v[132:135]
    ds_read_b128 v[152:155], v124 offset:30720
    s_add_u32 s31, s40, 262144
    buffer_load_dwordx4 v[72:75], v120, s[20:23], s31 offen sc1
    v_mfma_f32_16x16x32_bf16 v[136:139], v[176:179], v[32:35], v[136:139]
    ds_read_b128 v[156:159], v124 offset:31744
    v_mfma_f32_16x16x32_bf16 v[140:143], v[180:183], v[32:35], v[140:143]
    ds_read_b128 v[160:163], v124 offset:32768
    v_mfma_f32_16x16x32_bf16 v[144:147], v[184:187], v[32:35], v[144:147]
    ds_read_b128 v[164:167], v124 offset:33792
    v_mfma_f32_16x16x32_bf16 v[148:151], v[188:191], v[32:35], v[148:151]
    ds_read_b128 v[168:171], v124 offset:34816
    s_waitcnt lgkmcnt(5)
    v_mfma_f32_16x16x32_bf16 v[132:135], v[192:195], v[36:39], v[132:135]
    ds_read_b128 v[172:175], v124 offset:35840
    s_add_u32 s31, s40, 393216
    buffer_load_dwordx4 v[76:79], v120, s[20:23], s31 offen sc1
    v_mfma_f32_16x16x32_bf16 v[136:139], v[196:199], v[36:39], v[136:139]
    ds_read_b128 v[176:179], v124 offset:36864
    v_mfma_f32_16x16x32_bf16 v[140:143], v[200:203], v[36:39], v[140:143]
    ds_read_b128 v[180:183], v124 offset:37888
    v_mfma_f32_16x16x32_bf16 v[144:147], v[204:207], v[36:39], v[144:147]
    ds_read_b128 v[184:187], v124 offset:38912
    v_mfma_f32_16x16x32_bf16 v[148:151], v[208:211], v[36:39], v[148:151]
    ds_read_b128 v[188:191], v124 offset:39936
    s_barrier
    s_waitcnt lgkmcnt(5)
    v_mfma_f32_16x16x32_bf16 v[132:135], v[152:155], v[40:43], v[132:135]
    ds_read_b128 v[192:195], v124 offset:40960
    s_lshl_b32 s40, s32, 19
    s_add_u32 s32, s32, 1
    s_cmp_eq_u32 s32, 14
    s_cselect_b32 s32, 0, s32
    s_add_u32 s31, s40, 0
    buffer_load_dwordx4 v[80:83], v120, s[20:23], s31 offen sc1
    v_mfma_f32_16x16x32_bf16 v[136:139], v[156:159], v[40:43], v[136:139]
    ds_read_b128 v[196:199], v124 offset:41984
    v_mfma_f32_16x16x32_bf16 v[140:143], v[160:163], v[40:43], v[140:143]
    ds_read_b128 v[200:203], v124 offset:43008
    v_mfma_f32_16x16x32_bf16 v[144:147], v[164:167], v[40:43], v[144:147]
    ds_read_b128 v[204:207], v124 offset:44032
    v_mfma_f32_16x16x32_bf16 v[148:151], v[168:171], v[40:43], v[148:151]
    ds_read_b128 v[208:211], v124 offset:45056
    s_waitcnt lgkmcnt(5)
    v_mfma_f32_16x16x32_bf16 v[132:135], v[172:175], v[44:47], v[132:135]
    ds_read_b128 v[152:155], v124 offset:46080
    s_add_u32 s31, s40, 131072
    buffer_load_dwordx4 v[84:87], v120, s[20:23], s31 offen sc1
    v_mfma_f32_16x16x32_bf16 v[136:139], v[176:179], v[44:47], v[136:139]
    ds_read_b128 v[156:159], v124 offset:47104
    v_mfma_f32_16x16x32_bf16 v[140:143], v[180:183], v[44:47], v[140:143]
    ds_read_b128 v[160:163], v124 offset:48128
    v_mfma_f32_16x16x32_bf16 v[144:147], v[184:187], v[44:47], v[144:147]
    ds_read_b128 v[164:167], v124 offset:49152
    v_mfma_f32_16x16x32_bf16 v[148:151], v[188:191], v[44:47], v[148:151]
    ds_read_b128 v[168:171], v124 offset:50176
    s_waitcnt vmcnt(6)
    s_waitcnt lgkmcnt(5)
    v_mfma_f32_16x16x32_bf16 v[132:135], v[192:195], v[48:51], v[132:135]
    ds_read_b128 v[172:175], v124 offset:51200
    s_add_u32 s31, s40, 262144
    buffer_load_dwordx4 v[88:91], v120, s[20:23], s31 offen sc1
    v_mfma_f32_16x16x32_bf16 v[136:139], v[196:199], v[48:51], v[136:139]
    ds_read_b128 v[176:179], v124 offset:52224
    v_mfma_f32_16x16x32_bf16 v[140:143], v[200:203], v[48:51], v[140:143]
    ds_read_b128 v[180:183], v124 offset:53248
    v_mfma_f32_16x16x32_bf16 v[144:147], v[204:207], v[48:51], v[144:147]
    ds_read_b128 v[184:187], v124 offset:54272
    v_mfma_f32_16x16x32_bf16 v[148:151], v[208:211], v[48:51], v[148:151]
    ds_read_b128 v[188:191], v124 offset:55296
    s_waitcnt lgkmcnt(5)
    v_mfma_f32_16x16x32_bf16 v[132:135], v[152:155], v[52:55], v[132:135]
    ds_read_b128 v[192:195], v124 offset:56320
    s_add_u32 s31, s40, 393216
    buffer_load_dwordx4 v[92:95], v120, s[20:23], s31 offen sc1
    v_mfma_f32_16x16x32_bf16 v[136:139], v[156:159], v[52:55], v[136:139]
    ds_read_b128 v[196:199], v124 offset:57344
    v_mfma_f32_16x16x32_bf16 v[140:143], v[160:163], v[52:55], v[140:143]
    ds_read_b128 v[200:203], v124 offset:58368
    v_mfma_f32_16x16x32_bf16 v[144:147], v[164:167], v[52:55], v[144:147]
    ds_read_b128 v[204:207], v124 offset:59392
    v_mfma_f32_16x16x32_bf16 v[148:151], v[168:171], v[52:55], v[148:151]
    ds_read_b128 v[208:211], v124 offset:60416
    s_barrier
    s_waitcnt lgkmcnt(5)
    v_mfma_f32_16x16x32_bf16 v[132:135], v[172:175], v[56:59], v[132:135]
    ds_read_b128 v[152:155], v125 offset:0
    s_lshl_b32 s40, s32, 19
    s_add_u32 s32, s32, 1
    s_cmp_eq_u32 s32, 14
    s_cselect_b32 s32, 0, s32
    s_add_u32 s31, s40, 0
    buffer_load_dwordx4 v[32:35], v120, s[20:23], s31 offen sc1
    v_mfma_f32_16x16x32_bf16 v[136:139], v[176:179], v[56:59], v[136:139]
    ds_read_b128 v[156:159], v125 offset:1024
    v_mfma_f32_16x16x32_bf16 v[140:143], v[180:183], v[56:59], v[140:143]
    ds_read_b128 v[160:163], v125 offset:2048
    v_mfma_f32_16x16x32_bf16 v[144:147], v[184:187], v[56:59], v[144:147]
    ds_read_b128 v[164:167], v125 offset:3072
    v_mfma_f32_16x16x32_bf16 v[148:151], v[188:191], v[56:59], v[148:151]
    ds_read_b128 v[168:171], v125 offset:4096
    s_waitcnt lgkmcnt(5)
    v_mfma_f32_16x16x32_bf16 v[132:135], v[192:195], v[60:63], v[132:135]
    ds_read_b128 v[172:175], v125 offset:5120
    s_add_u32 s31, s40, 131072
    buffer_load_dwordx4 v[36:39], v120, s[20:23], s31 offen sc1
    v_mfma_f32_16x16x32_bf16 v[136:139], v[196:199], v[60:63], v[136:139]
    ds_read_b128 v[176:179], v125 offset:6144
    v_mfma_f32_16x16x32_bf16 v[140:143], v[200:203], v[60:63], v[140:143]
    ds_read_b128 v[180:183], v125 offset:7168
    v_mfma_f32_16x16x32_bf16 v[144:147], v[204:207], v[60:63], v[144:147]
    ds_read_b128 v[184:187], v125 offset:8192
    v_mfma_f32_16x16x32_bf16 v[148:151], v[208:211], v[60:63], v[148:151]
    ds_read_b128 v[188:191], v125 offset:9216
    s_waitcnt vmcnt(6)
    s_waitcnt lgkmcnt(5)
    v_mfma_f32_16x16x32_bf16 v[132:135], v[152:155], v[64:67], v[132:135]
    ds_read_b128 v[192:195], v125 offset:10240
    s_add_u32 s31, s40, 262144
    buffer_load_dwordx4 v[40:43], v120, s[20:23], s31 offen sc1
    v_mfma_f32_16x16x32_bf16 v[136:139], v[156:159], v[64:67], v[136:139]
    ds_read_b128 v[196:199], v125 offset:11264
    v_mfma_f32_16x16x32_bf16 v[140:143], v[160:163], v[64:67], v[140:143]
    ds_read_b128 v[200:203], v125 offset:12288
    v_mfma_f32_16x16x32_bf16 v[144:147], v[164:167], v[64:67], v[144:147]
    ds_read_b128 v[204:207], v125 offset:13312
    v_mfma_f32_16x16x32_bf16 v[148:151], v[168:171], v[64:67], v[148:151]
    ds_read_b128 v[208:211], v125 offset:14336
    s_waitcnt lgkmcnt(5)
    v_mfma_f32_16x16x32_bf16 v[132:135], v[172:175], v[68:71], v[132:135]
    ds_read_b128 v[152:155], v125 offset:15360
    s_add_u32 s31, s40, 393216
    buffer_load_dwordx4 v[44:47], v120, s[20:23], s31 offen sc1
    v_mfma_f32_16x16x32_bf16 v[136:139], v[176:179], v[68:71], v[136:139]
    ds_read_b128 v[156:159], v125 offset:16384
    v_mfma_f32_16x16x32_bf16 v[140:143], v[180:183], v[68:71], v[140:143]
    ds_read_b128 v[160:163], v125 offset:17408
    v_mfma_f32_16x16x32_bf16 v[144:147], v[184:187], v[68:71], v[144:147]
    ds_read_b128 v[164:167], v125 offset:18432
    v_mfma_f32_16x16x32_bf16 v[148:151], v[188:191], v[68:71], v[148:151]
    ds_read_b128 v[168:171], v125 offset:19456
    s_barrier
    s_waitcnt lgkmcnt(5)
    v_mfma_f32_16x16x32_bf16 v[132:135], v[192:195], v[72:75], v[132:135]
    ds_read_b128 v[172:175], v123 offset:0
    s_lshl_b32 s40, s32, 19
    s_add_u32 s32, s32, 1
    s_cmp_eq_u32 s32, 14
    s_cselect_b32 s32, 0, s32
    s_add_u32 s31, s40, 0
    buffer_load_dwordx4 v[48:51], v120, s[20:23], s31 offen sc1
    v_mfma_f32_16x16x32_bf16 v[136:139], v[196:199], v[72:75], v[136:139]
    ds_read_b128 v[176:179], v123 offset:1024
    v_mfma_f32_16x16x32_bf16 v[140:143], v[200:203], v[72:75], v[140:143]
    ds_read_b128 v[180:183], v123 offset:2048
    v_mfma_f32_16x16x32_bf16 v[144:147], v[204:207], v[72:75], v[144:147]
    ds_read_b128 v[184:187], v123 offset:3072
    v_mfma_f32_16x16x32_bf16 v[148:151], v[208:211], v[72:75], v[148:151]
    ds_read_b128 v[188:191], v123 offset:4096
    s_waitcnt lgkmcnt(5)
    v_mfma_f32_16x16x32_bf16 v[132:135], v[152:155], v[76:79], v[132:135]
    ds_read_b128 v[192:195], v123 offset:5120
    s_add_u32 s31, s40, 131072
    buffer_load_dwordx4 v[52:55], v120, s[20:23], s31 offen sc1
    v_mfma_f32_16x16x32_bf16 v[136:139], v[156:159], v[76:79], v[136:139]
    ds_read_b128 v[196:199], v123 offset:6144
    v_mfma_f32_16x16x32_bf16 v[140:143], v[160:163], v[76:79], v[140:143]
    ds_read_b128 v[200:203], v123 offset:7168
    v_mfma_f32_16x16x32_bf16 v[144:147], v[164:167], v[76:79], v[144:147]
    ds_read_b128 v[204:207], v123 offset:8192
    v_mfma_f32_16x16x32_bf16 v[148:151], v[168:171], v[76:79], v[148:151]
    ds_read_b128 v[208:211], v123 offset:9216
    s_waitcnt vmcnt(6)
    s_waitcnt lgkmcnt(5)
    v_mfma_f32_16x16x32_bf16 v[132:135], v[172:175], v[80:83], v[132:135]
    ds_read_b128 v[152:155], v123 offset:10240
    s_add_u32 s31, s40, 262144
    buffer_load_dwordx4 v[56:59], v120, s[20:23], s31 offen sc1
    v_mfma_f32_16x16x32_bf16 v[136:139], v[176:179], v[80:83], v[136:139]
    ds_read_b128 v[156:159], v123 offset:11264
    v_mfma_f32_16x16x32_bf16 v[140:143], v[180:183], v[80:83], v[140:143]
    ds_read_b128 v[160:163], v123 offset:12288
    v_mfma_f32_16x16x32_bf16 v[144:147], v[184:187], v[80:83], v[144:147]
    ds_read_b128 v[164:167], v123 offset:13312
    v_mfma_f32_16x16x32_bf16 v[148:151], v[188:191], v[80:83], v[148:151]
    ds_read_b128 v[168:171], v123 offset:14336
    s_waitcnt lgkmcnt(5)
    v_mfma_f32_16x16x32_bf16 v[132:135], v[192:195], v[84:87], v[132:135]
    ds_read_b128 v[172:175], v123 offset:15360
    s_add_u32 s31, s40, 393216
    buffer_load_dwordx4 v[60:63], v120, s[20:23], s31 offen sc1
    v_mfma_f32_16x16x32_bf16 v[136:139], v[196:199], v[84:87], v[136:139]
    ds_read_b128 v[176:179], v123 offset:16384
    v_mfma_f32_16x16x32_bf16 v[140:143], v[200:203], v[84:87], v[140:143]
    ds_read_b128 v[180:183], v123 offset:17408
    v_mfma_f32_16x16x32_bf16 v[144:147], v[204:207], v[84:87], v[144:147]
    ds_read_b128 v[184:187], v123 offset:18432
    v_mfma_f32_16x16x32_bf16 v[148:151], v[208:211], v[84:87], v[148:151]
    ds_read_b128 v[188:191], v123 offset:19456
    s_barrier
    s_waitcnt lgkmcnt(5)
    v_mfma_f32_16x16x32_bf16 v[132:135], v[152:155], v[88:91], v[132:135]
    ds_read_b128 v[192:195], v123 offset:20480
    s_lshl_b32 s40, s32, 19
    s_add_u32 s32, s32, 1
    s_cmp_eq_u32 s32, 14
    s_cselect_b32 s32, 0, s32
    s_add_u32 s31, s40, 0
    buffer_load_dwordx4 v[64:67], v120, s[20:23], s31 offen sc1
    v_mfma_f32_16x16x32_bf16 v[136:139], v[156:159], v[88:91], v[136:139]
    ds_read_b128 v[196:199], v123 offset:21504
    v_mfma_f32_16x16x32_bf16 v[140:143], v[160:163], v[88:91], v[140:143]
    ds_read_b128 v[200:203], v123 offset:22528
    v_mfma_f32_16x16x32_bf16 v[144:147], v[164:167], v[88:91], v[144:147]
    ds_read_b128 v[204:207], v123 offset:23552
    v_mfma_f32_16x16x32_bf16 v[148:151], v[168:171], v[88:91], v[148:151]
    ds_read_b128 v[208:211], v123 offset:24576
    s_waitcnt lgkmcnt(5)
    v_mfma_f32_16x16x32_bf16 v[132:135], v[172:175], v[92:95], v[132:135]
    ds_read_b128 v[152:155], v123 offset:25600
    s_add_u32 s31, s40, 131072
    buffer_load_dwordx4 v[68:71], v120, s[20:23], s31 offen sc1
    v_mfma_f32_16x16x32_bf16 v[136:139], v[176:179], v[92:95], v[136:139]
    ds_read_b128 v[156:159], v123 offset:26624
    v_mfma_f32_16x16x32_bf16 v[140:143], v[180:183], v[92:95], v[140:143]
    ds_read_b128 v[160:163], v123 offset:27648
    v_mfma_f32_16x16x32_bf16 v[144:147], v[184:187], v[92:95], v[144:147]
    ds_read_b128 v[164:167], v123 offset:28672
    v_mfma_f32_16x16x32_bf16 v[148:151], v[188:191], v[92:95], v[148:151]
    ds_read_b128 v[168:171], v123 offset:29696
    s_waitcnt vmcnt(6)
    s_waitcnt lgkmcnt(5)
    v_mfma_f32_16x16x32_bf16 v[132:135], v[192:195], v[32:35], v[132:135]
    ds_read_b128 v[172:175], v123 offset:30720
    s_add_u32 s31, s40, 262144
    buffer_load_dwordx4 v[72:75], v120, s[20:23], s31 offen sc1
    v_mfma_f32_16x16x32_bf16 v[136:139], v[196:199], v[32:35], v[136:139]
    ds_read_b128 v[176:179], v123 offset:31744
    v_mfma_f32_16x16x32_bf16 v[140:143], v[200:203], v[32:35], v[140:143]
    ds_read_b128 v[180:183], v123 offset:32768
    v_mfma_f32_16x16x32_bf16 v[144:147], v[204:207], v[32:35], v[144:147]
    ds_read_b128 v[184:187], v123 offset:33792
    v_mfma_f32_16x16x32_bf16 v[148:151], v[208:211], v[32:35], v[148:151]
    ds_read_b128 v[188:191], v123 offset:34816
    s_waitcnt lgkmcnt(5)
    v_mfma_f32_16x16x32_bf16 v[132:135], v[152:155], v[36:39], v[132:135]
    ds_read_b128 v[192:195], v123 offset:35840
    s_add_u32 s31, s40, 393216
    buffer_load_dwordx4 v[76:79], v120, s[20:23], s31 offen sc1
    v_mfma_f32_16x16x32_bf16 v[136:139], v[156:159], v[36:39], v[136:139]
    ds_read_b128 v[196:199], v123 offset:36864
    v_mfma_f32_16x16x32_bf16 v[140:143], v[160:163], v[36:39], v[140:143]
    ds_read_b128 v[200:203], v123 offset:37888
    v_mfma_f32_16x16x32_bf16 v[144:147], v[164:167], v[36:39], v[144:147]
    ds_read_b128 v[204:207], v123 offset:38912
    v_mfma_f32_16x16x32_bf16 v[148:151], v[168:171], v[36:39], v[148:151]
    ds_read_b128 v[208:211], v123 offset:39936
    s_barrier
    s_waitcnt lgkmcnt(5)
    v_mfma_f32_16x16x32_bf16 v[132:135], v[172:175], v[40:43], v[132:135]
    ds_read_b128 v[152:155], v123 offset:40960
    s_lshl_b32 s40, s32, 19
    s_add_u32 s32, s32, 1
    s_cmp_eq_u32 s32, 14
    s_cselect_b32 s32, 0, s32
    s_add_u32 s31, s40, 0
    buffer_load_dwordx4 v[80:83], v120, s[20:23], s31 offen sc1
    v_mfma_f32_16x16x32_bf16 v[136:139], v[176:179], v[40:43], v[136:139]
    ds_read_b128 v[156:159], v123 offset:41984
    v_mfma_f32_16x16x32_bf16 v[140:143], v[180:183], v[40:43], v[140:143]
    ds_read_b128 v[160:163], v123 offset:43008
    v_mfma_f32_16x16x32_bf16 v[144:147], v[184:187], v[40:43], v[144:147]
    ds_read_b128 v[164:167], v123 offset:44032
    v_mfma_f32_16x16x32_bf16 v[148:151], v[188:191], v[40:43], v[148:151]
    ds_read_b128 v[168:171], v123 offset:45056
    s_waitcnt lgkmcnt(5)
    v_mfma_f32_16x16x32_bf16 v[132:135], v[192:195], v[44:47], v[132:135]
    ds_read_b128 v[172:175], v123 offset:46080
    s_add_u32 s31, s40, 131072
    buffer_load_dwordx4 v[84:87], v120, s[20:23], s31 offen sc1
    v_mfma_f32_16x16x32_bf16 v[136:139], v[196:199], v[44:47], v[136:139]
    ds_read_b128 v[176:179], v123 offset:47104
    v_mfma_f32_16x16x32_bf16 v[140:143], v[200:203], v[44:47], v[140:143]
    ds_read_b128 v[180:183], v123 offset:48128
    v_mfma_f32_16x16x32_bf16 v[144:147], v[204:207], v[44:47], v[144:147]
    ds_read_b128 v[184:187], v123 offset:49152
    v_mfma_f32_16x16x32_bf16 v[148:151], v[208:211], v[44:47], v[148:151]
    ds_read_b128 v[188:191], v123 offset:50176
    s_waitcnt vmcnt(6)
    s_waitcnt lgkmcnt(5)
    v_mfma_f32_16x16x32_bf16 v[132:135], v[152:155], v[48:51], v[132:135]
    ds_read_b128 v[192:195], v123 offset:51200
    s_add_u32 s31, s40, 262144
    buffer_load_dwordx4 v[88:91], v120, s[20:23], s31 offen sc1
    v_mfma_f32_16x16x32_bf16 v[136:139], v[156:159], v[48:51], v[136:139]
    ds_read_b128 v[196:199], v123 offset:52224
    v_mfma_f32_16x16x32_bf16 v[140:143], v[160:163], v[48:51], v[140:143]
    ds_read_b128 v[200:203], v123 offset:53248
    v_mfma_f32_16x16x32_bf16 v[144:147], v[164:167], v[48:51], v[144:147]
    ds_read_b128 v[204:207], v123 offset:54272
    v_mfma_f32_16x16x32_bf16 v[148:151], v[168:171], v[48:51], v[148:151]
    ds_read_b128 v[208:211], v123 offset:55296
    s_waitcnt lgkmcnt(5)
    v_mfma_f32_16x16x32_bf16 v[132:135], v[172:175], v[52:55], v[132:135]
    ds_read_b128 v[152:155], v123 offset:56320
    s_add_u32 s31, s40, 393216
    buffer_load_dwordx4 v[92:95], v120, s[20:23], s31 offen sc1
    v_mfma_f32_16x16x32_bf16 v[136:139], v[176:179], v[52:55], v[136:139]
    ds_read_b128 v[156:159], v123 offset:57344
    v_mfma_f32_16x16x32_bf16 v[140:143], v[180:183], v[52:55], v[140:143]
    ds_read_b128 v[160:163], v123 offset:58368
    v_mfma_f32_16x16x32_bf16 v[144:147], v[184:187], v[52:55], v[144:147]
    ds_read_b128 v[164:167], v123 offset:59392
    v_mfma_f32_16x16x32_bf16 v[148:151], v[188:191], v[52:55], v[148:151]
    ds_read_b128 v[168:171], v123 offset:60416
    s_barrier
    s_waitcnt lgkmcnt(5)
    v_mfma_f32_16x16x32_bf16 v[132:135], v[192:195], v[56:59], v[132:135]
    ds_read_b128 v[172:175], v124 offset:0
    s_lshl_b32 s40, s32, 19
    s_add_u32 s32, s32, 1
    s_cmp_eq_u32 s32, 14
    s_cselect_b32 s32, 0, s32
    s_add_u32 s31, s40, 0
    buffer_load_dwordx4 v[32:35], v120, s[20:23], s31 offen sc1
    v_mfma_f32_16x16x32_bf16 v[136:139], v[196:199], v[56:59], v[136:139]
    ds_read_b128 v[176:179], v124 offset:1024
    v_mfma_f32_16x16x32_bf16 v[140:143], v[200:203], v[56:59], v[140:143]
    ds_read_b128 v[180:183], v124 offset:2048
    v_mfma_f32_16x16x32_bf16 v[144:147], v[204:207], v[56:59], v[144:147]
    ds_read_b128 v[184:187], v124 offset:3072
    v_mfma_f32_16x16x32_bf16 v[148:151], v[208:211], v[56:59], v[148:151]
    ds_read_b128 v[188:191], v124 offset:4096
    s_waitcnt lgkmcnt(5)
    v_mfma_f32_16x16x32_bf16 v[132:135], v[152:155], v[60:63], v[132:135]
    ds_read_b128 v[192:195], v124 offset:5120
    s_add_u32 s31, s40, 131072
    buffer_load_dwordx4 v[36:39], v120, s[20:23], s31 offen sc1
    v_mfma_f32_16x16x32_bf16 v[136:139], v[156:159], v[60:63], v[136:139]
    ds_read_b128 v[196:199], v124 offset:6144
    v_mfma_f32_16x16x32_bf16 v[140:143], v[160:163], v[60:63], v[140:143]
    ds_read_b128 v[200:203], v124 offset:7168
    v_mfma_f32_16x16x32_bf16 v[144:147], v[164:167], v[60:63], v[144:147]
    ds_read_b128 v[204:207], v124 offset:8192
    v_mfma_f32_16x16x32_bf16 v[148:151], v[168:171], v[60:63], v[148:151]
    ds_read_b128 v[208:211], v124 offset:9216
    s_waitcnt vmcnt(6)
    s_waitcnt lgkmcnt(5)
    v_mfma_f32_16x16x32_bf16 v[132:135], v[172:175], v[64:67], v[132:135]
    ds_read_b128 v[152:155], v124 offset:10240
    s_add_u32 s31, s40, 262144
    buffer_load_dwordx4 v[40:43], v120, s[20:23], s31 offen sc1
    v_mfma_f32_16x16x32_bf16 v[136:139], v[176:179], v[64:67], v[136:139]
    ds_read_b128 v[156:159], v124 offset:11264
    v_mfma_f32_16x16x32_bf16 v[140:143], v[180:183], v[64:67], v[140:143]
    ds_read_b128 v[160:163], v124 offset:12288
    v_mfma_f32_16x16x32_bf16 v[144:147], v[184:187], v[64:67], v[144:147]
    ds_read_b128 v[164:167], v124 offset:13312
    v_mfma_f32_16x16x32_bf16 v[148:151], v[188:191], v[64:67], v[148:151]
    ds_read_b128 v[168:171], v124 offset:14336
    s_waitcnt lgkmcnt(5)
    v_mfma_f32_16x16x32_bf16 v[132:135], v[192:195], v[68:71], v[132:135]
    ds_read_b128 v[172:175], v124 offset:15360
    s_add_u32 s31, s40, 393216
    buffer_load_dwordx4 v[44:47], v120, s[20:23], s31 offen sc1
    v_mfma_f32_16x16x32_bf16 v[136:139], v[196:199], v[68:71], v[136:139]
    ds_read_b128 v[176:179], v124 offset:16384
    v_mfma_f32_16x16x32_bf16 v[140:143], v[200:203], v[68:71], v[140:143]
    ds_read_b128 v[180:183], v124 offset:17408
    v_mfma_f32_16x16x32_bf16 v[144:147], v[204:207], v[68:71], v[144:147]
    ds_read_b128 v[184:187], v124 offset:18432
    v_mfma_f32_16x16x32_bf16 v[148:151], v[208:211], v[68:71], v[148:151]
    ds_read_b128 v[188:191], v124 offset:19456
    s_barrier
    s_waitcnt lgkmcnt(5)
    v_mfma_f32_16x16x32_bf16 v[132:135], v[152:155], v[72:75], v[132:135]
    ds_read_b128 v[192:195], v124 offset:20480
    s_lshl_b32 s40, s32, 19
    s_add_u32 s32, s32, 1
    s_cmp_eq_u32 s32, 14
    s_cselect_b32 s32, 0, s32
    s_add_u32 s31, s40, 0
    buffer_load_dwordx4 v[48:51], v120, s[20:23], s31 offen sc1
    v_mfma_f32_16x16x32_bf16 v[136:139], v[156:159], v[72:75], v[136:139]
    ds_read_b128 v[196:199], v124 offset:21504
    v_mfma_f32_16x16x32_bf16 v[140:143], v[160:163], v[72:75], v[140:143]
    ds_read_b128 v[200:203], v124 offset:22528
    v_mfma_f32_16x16x32_bf16 v[144:147], v[164:167], v[72:75], v[144:147]
    ds_read_b128 v[204:207], v124 offset:23552
    v_mfma_f32_16x16x32_bf16 v[148:151], v[168:171], v[72:75], v[148:151]
    ds_read_b128 v[208:211], v124 offset:24576
    s_waitcnt lgkmcnt(5)
    v_mfma_f32_16x16x32_bf16 v[132:135], v[172:175], v[76:79], v[132:135]
    ds_read_b128 v[152:155], v124 offset:25600
    s_add_u32 s31, s40, 131072
    buffer_load_dwordx4 v[52:55], v120, s[20:23], s31 offen sc1
    v_mfma_f32_16x16x32_bf16 v[136:139], v[176:179], v[76:79], v[136:139]
    ds_read_b128 v[156:159], v124 offset:26624
    v_mfma_f32_16x16x32_bf16 v[140:143], v[180:183], v[76:79], v[140:143]
    ds_read_b128 v[160:163], v124 offset:27648
    v_mfma_f32_16x16x32_bf16 v[144:147], v[184:187], v[76:79], v[144:147]
    ds_read_b128 v[164:167], v124 offset:28672
    v_mfma_f32_16x16x32_bf16 v[148:151], v[188:191], v[76:79], v[148:151]
    ds_read_b128 v[168:171], v124 offset:29696
    s_waitcnt vmcnt(6)
    s_waitcnt lgkmcnt(5)
    v_mfma_f32_16x16x32_bf16 v[132:135], v[192:195], v[80:83], v[132:135]
    ds_read_b128 v[172:175], v124 offset:30720
    s_add_u32 s31, s40, 262144
    buffer_load_dwordx4 v[56:59], v120, s[20:23], s31 offen sc1
    v_mfma_f32_16x16x32_bf16 v[136:139], v[196:199], v[80:83], v[136:139]
    ds_read_b128 v[176:179], v124 offset:31744
    v_mfma_f32_16x16x32_bf16 v[140:143], v[200:203], v[80:83], v[140:143]
    ds_read_b128 v[180:183], v124 offset:32768
    v_mfma_f32_16x16x32_bf16 v[144:147], v[204:207], v[80:83], v[144:147]
    ds_read_b128 v[184:187], v124 offset:33792
    v_mfma_f32_16x16x32_bf16 v[148:151], v[208:211], v[80:83], v[148:151]
    ds_read_b128 v[188:191], v124 offset:34816
    s_waitcnt lgkmcnt(5)
    v_mfma_f32_16x16x32_bf16 v[132:135], v[152:155], v[84:87], v[132:135]
    ds_read_b128 v[192:195], v124 offset:35840
    s_add_u32 s31, s40, 393216
    buffer_load_dwordx4 v[60:63], v120, s[20:23], s31 offen sc1
    v_mfma_f32_16x16x32_bf16 v[136:139], v[156:159], v[84:87], v[136:139]
    ds_read_b128 v[196:199], v124 offset:36864
    v_mfma_f32_16x16x32_bf16 v[140:143], v[160:163], v[84:87], v[140:143]
    ds_read_b128 v[200:203], v124 offset:37888
    v_mfma_f32_16x16x32_bf16 v[144:147], v[164:167], v[84:87], v[144:147]
    ds_read_b128 v[204:207], v124 offset:38912
    v_mfma_f32_16x16x32_bf16 v[148:151], v[168:171], v[84:87], v[148:151]
    ds_read_b128 v[208:211], v124 offset:39936
    s_barrier
    s_waitcnt lgkmcnt(5)
    v_mfma_f32_16x16x32_bf16 v[132:135], v[172:175], v[88:91], v[132:135]
    ds_read_b128 v[152:155], v124 offset:40960
    v_mfma_f32_16x16x32_bf16 v[136:139], v[176:179], v[88:91], v[136:139]
    ds_read_b128 v[156:159], v124 offset:41984
    v_mfma_f32_16x16x32_bf16 v[140:143], v[180:183], v[88:91], v[140:143]
    ds_read_b128 v[160:163], v124 offset:43008
    v_mfma_f32_16x16x32_bf16 v[144:147], v[184:187], v[88:91], v[144:147]
    ds_read_b128 v[164:167], v124 offset:44032
    v_mfma_f32_16x16x32_bf16 v[148:151], v[188:191], v[88:91], v[148:151]
    ds_read_b128 v[168:171], v124 offset:45056
    s_waitcnt lgkmcnt(5)
    v_mfma_f32_16x16x32_bf16 v[132:135], v[192:195], v[92:95], v[132:135]
    ds_read_b128 v[172:175], v124 offset:46080
    v_mfma_f32_16x16x32_bf16 v[136:139], v[196:199], v[92:95], v[136:139]
    ds_read_b128 v[176:179], v124 offset:47104
    v_mfma_f32_16x16x32_bf16 v[140:143], v[200:203], v[92:95], v[140:143]
    ds_read_b128 v[180:183], v124 offset:48128
    v_mfma_f32_16x16x32_bf16 v[144:147], v[204:207], v[92:95], v[144:147]
    ds_read_b128 v[184:187], v124 offset:49152
    v_mfma_f32_16x16x32_bf16 v[148:151], v[208:211], v[92:95], v[148:151]
    ds_read_b128 v[188:191], v124 offset:50176
    s_waitcnt vmcnt(4)
    s_waitcnt lgkmcnt(5)
    v_mfma_f32_16x16x32_bf16 v[132:135], v[152:155], v[32:35], v[132:135]
    ds_read_b128 v[192:195], v124 offset:51200
    v_mfma_f32_16x16x32_bf16 v[136:139], v[156:159], v[32:35], v[136:139]
    ds_read_b128 v[196:199], v124 offset:52224
    v_mfma_f32_16x16x32_bf16 v[140:143], v[160:163], v[32:35], v[140:143]
    ds_read_b128 v[200:203], v124 offset:53248
    v_mfma_f32_16x16x32_bf16 v[144:147], v[164:167], v[32:35], v[144:147]
    ds_read_b128 v[204:207], v124 offset:54272
    v_mfma_f32_16x16x32_bf16 v[148:151], v[168:171], v[32:35], v[148:151]
    ds_read_b128 v[208:211], v124 offset:55296
    s_waitcnt lgkmcnt(5)
    v_mfma_f32_16x16x32_bf16 v[132:135], v[172:175], v[36:39], v[132:135]
    ds_read_b128 v[152:155], v124 offset:56320
    v_mfma_f32_16x16x32_bf16 v[136:139], v[176:179], v[36:39], v[136:139]
    ds_read_b128 v[156:159], v124 offset:57344
    v_mfma_f32_16x16x32_bf16 v[140:143], v[180:183], v[36:39], v[140:143]
    ds_read_b128 v[160:163], v124 offset:58368
    v_mfma_f32_16x16x32_bf16 v[144:147], v[184:187], v[36:39], v[144:147]
    ds_read_b128 v[164:167], v124 offset:59392
    v_mfma_f32_16x16x32_bf16 v[148:151], v[188:191], v[36:39], v[148:151]
    ds_read_b128 v[168:171], v124 offset:60416
    s_barrier
    s_waitcnt lgkmcnt(5)
    v_mfma_f32_16x16x32_bf16 v[132:135], v[192:195], v[40:43], v[132:135]
    ds_read_b128 v[172:175], v125 offset:0
    v_mfma_f32_16x16x32_bf16 v[136:139], v[196:199], v[40:43], v[136:139]
    ds_read_b128 v[176:179], v125 offset:1024
    v_mfma_f32_16x16x32_bf16 v[140:143], v[200:203], v[40:43], v[140:143]
    ds_read_b128 v[180:183], v125 offset:2048
    v_mfma_f32_16x16x32_bf16 v[144:147], v[204:207], v[40:43], v[144:147]
    ds_read_b128 v[184:187], v125 offset:3072
    v_mfma_f32_16x16x32_bf16 v[148:151], v[208:211], v[40:43], v[148:151]
    ds_read_b128 v[188:191], v125 offset:4096
    s_waitcnt lgkmcnt(5)
    v_mfma_f32_16x16x32_bf16 v[132:135], v[152:155], v[44:47], v[132:135]
    ds_read_b128 v[192:195], v125 offset:5120
    v_mfma_f32_16x16x32_bf16 v[136:139], v[156:159], v[44:47], v[136:139]
    ds_read_b128 v[196:199], v125 offset:6144
    v_mfma_f32_16x16x32_bf16 v[140:143], v[160:163], v[44:47], v[140:143]
    ds_read_b128 v[200:203], v125 offset:7168
    v_mfma_f32_16x16x32_bf16 v[144:147], v[164:167], v[44:47], v[144:147]
    ds_read_b128 v[204:207], v125 offset:8192
    v_mfma_f32_16x16x32_bf16 v[148:151], v[168:171], v[44:47], v[148:151]
    ds_read_b128 v[208:211], v125 offset:9216
    s_waitcnt vmcnt(0)
    s_waitcnt lgkmcnt(5)
    v_mfma_f32_16x16x32_bf16 v[132:135], v[172:175], v[48:51], v[132:135]
    ds_read_b128 v[152:155], v125 offset:10240
    v_mfma_f32_16x16x32_bf16 v[136:139], v[176:179], v[48:51], v[136:139]
    ds_read_b128 v[156:159], v125 offset:11264
    v_mfma_f32_16x16x32_bf16 v[140:143], v[180:183], v[48:51], v[140:143]
    ds_read_b128 v[160:163], v125 offset:12288
    v_mfma_f32_16x16x32_bf16 v[144:147], v[184:187], v[48:51], v[144:147]
    ds_read_b128 v[164:167], v125 offset:13312
    v_mfma_f32_16x16x32_bf16 v[148:151], v[188:191], v[48:51], v[148:151]
    ds_read_b128 v[168:171], v125 offset:14336
    s_waitcnt lgkmcnt(5)
    v_mfma_f32_16x16x32_bf16 v[132:135], v[192:195], v[52:55], v[132:135]
    ds_read_b128 v[172:175], v125 offset:15360
    v_mfma_f32_16x16x32_bf16 v[136:139], v[196:199], v[52:55], v[136:139]
    ds_read_b128 v[176:179], v125 offset:16384
    v_mfma_f32_16x16x32_bf16 v[140:143], v[200:203], v[52:55], v[140:143]
    ds_read_b128 v[180:183], v125 offset:17408
    v_mfma_f32_16x16x32_bf16 v[144:147], v[204:207], v[52:55], v[144:147]
    ds_read_b128 v[184:187], v125 offset:18432
    v_mfma_f32_16x16x32_bf16 v[148:151], v[208:211], v[52:55], v[148:151]
    ds_read_b128 v[188:191], v125 offset:19456
    s_waitcnt lgkmcnt(5)
    v_mfma_f32_16x16x32_bf16 v[132:135], v[152:155], v[56:59], v[132:135]
    v_mfma_f32_16x16x32_bf16 v[136:139], v[156:159], v[56:59], v[136:139]
    v_mfma_f32_16x16x32_bf16 v[140:143], v[160:163], v[56:59], v[140:143]
    v_mfma_f32_16x16x32_bf16 v[144:147], v[164:167], v[56:59], v[144:147]
    v_mfma_f32_16x16x32_bf16 v[148:151], v[168:171], v[56:59], v[148:151]
    s_waitcnt lgkmcnt(0)
    v_mfma_f32_16x16x32_bf16 v[132:135], v[172:175], v[60:63], v[132:135]
    ds_read_b64_tr_b16 v[192:193], v121 offset:0
    v_mfma_f32_16x16x32_bf16 v[136:139], v[176:179], v[60:63], v[136:139]
    ds_read_b64_tr_b16 v[196:197], v121 offset:2048
    v_mfma_f32_16x16x32_bf16 v[140:143], v[180:183], v[60:63], v[140:143]
    ds_read_b64_tr_b16 v[200:201], v121 offset:4096
    v_mfma_f32_16x16x32_bf16 v[144:147], v[184:187], v[60:63], v[144:147]
    ds_read_b64_tr_b16 v[204:205], v121 offset:6144
    v_mfma_f32_16x16x32_bf16 v[148:151], v[188:191], v[60:63], v[148:151]
    ds_read_b64_tr_b16 v[208:209], v121 offset:8192
    s_waitcnt lgkmcnt(0)
    v_lshlrev_b32 v194, 16, v192
    v_and_b32 v192, 0xffff0000, v192
    v_lshlrev_b32 v195, 16, v193
    v_and_b32 v193, 0xffff0000, v193
    v_add_f32 v132, v132, v194
    v_add_f32 v133, v133, v192
    v_add_f32 v134, v134, v195
    v_add_f32 v135, v135, v193
    v_cvt_pk_bf16_f32 v132, v132, v133
    v_cvt_pk_bf16_f32 v133, v134, v135
    ds_write_b64 v122, v[132:133] offset:0
    v_lshlrev_b32 v198, 16, v196
    v_and_b32 v196, 0xffff0000, v196
    v_lshlrev_b32 v199, 16, v197
    v_and_b32 v197, 0xffff0000, v197
    v_add_f32 v136, v136, v198
    v_add_f32 v137, v137, v196
    v_add_f32 v138, v138, v199
    v_add_f32 v139, v139, v197
    v_cvt_pk_bf16_f32 v136, v136, v137
    v_cvt_pk_bf16_f32 v137, v138, v139
    ds_write_b64 v122, v[136:137] offset:32
    v_lshlrev_b32 v202, 16, v200
    v_and_b32 v200, 0xffff0000, v200
    v_lshlrev_b32 v203, 16, v201
    v_and_b32 v201, 0xffff0000, v201
    v_add_f32 v140, v140, v202
    v_add_f32 v141, v141, v200
    v_add_f32 v142, v142, v203
    v_add_f32 v143, v143, v201
    v_cvt_pk_bf16_f32 v140, v140, v141
    v_cvt_pk_bf16_f32 v141, v142, v143
    ds_write_b64 v122, v[140:141] offset:64
    v_lshlrev_b32 v206, 16, v204
    v_and_b32 v204, 0xffff0000, v204
    v_lshlrev_b32 v207, 16, v205
    v_and_b32 v205, 0xffff0000, v205
    v_add_f32 v144, v144, v206
    v_add_f32 v145, v145, v204
    v_add_f32 v146, v146, v207
    v_add_f32 v147, v147, v205
    v_cvt_pk_bf16_f32 v144, v144, v145
    v_cvt_pk_bf16_f32 v145, v146, v147
    ds_write_b64 v122, v[144:145] offset:96
    v_lshlrev_b32 v210, 16, v208
    v_and_b32 v208, 0xffff0000, v208
    v_lshlrev_b32 v211, 16, v209
    v_and_b32 v209, 0xffff0000, v209
    v_add_f32 v148, v148, v210
    v_add_f32 v149, v149, v208
    v_add_f32 v150, v150, v211
    v_add_f32 v151, v151, v209
    v_cvt_pk_bf16_f32 v148, v148, v149
    v_cvt_pk_bf16_f32 v149, v150, v151
    ds_write_b64 v122, v[148:149] offset:128
    s_waitcnt lgkmcnt(0)
    ds_read_b128 v[172:175], v126
    ds_read_b128 v[176:179], v127
    ds_read_b128 v[180:183], v128
    s_waitcnt lgkmcnt(2)
    buffer_store_dwordx4 v[172:175], v129, s[24:27], 0 offen
    s_waitcnt lgkmcnt(1)
    buffer_store_dwordx4 v[176:179], v130, s[24:27], 0 offen
    s_waitcnt lgkmcnt(0)
    s_mov_b32 exec_hi, 0
    buffer_store_dwordx4 v[180:183], v131, s[24:27], 0 offen
    s_mov_b64 exec, -1
    s_endpgm
loader_sequential_preLN__ssm_conv_s4__glu_gated_swiglu__prompt_kernel_33:
    s_sub_u32 s44, s30, 4
    s_mul_i32 s36, s29, 286720
    s_add_u32 s12, s8, s36
    s_addc_u32 s13, s9, 0
    s_add_u32 s12, s12, 15335424
    s_addc_u32 s13, s13, 0
    s_mov_b32 s14, 286720
    s_mov_b32 s15, 0x20000
    v_lshlrev_b32 v10, 4, v2
    s_lshl_b32 s36, s44, 3
    s_lshl_b32 s37, s28, 8
    s_add_u32 s45, s36, 0
    v_add_u32 v6, s45, v3
    v_and_b32 v7, 7, v6
    v_lshlrev_b32 v7, 1, v7
    v_and_b32 v8, 15, v2
    v_xor_b32 v7, v7, v8
    v_lshlrev_b32 v7, 4, v7
    v_lshl_add_u32 v7, v6, 12, v7
    v_add_u32 v11, s37, v7
    s_add_u32 s45, s36, 4
    v_add_u32 v6, s45, v3
    v_and_b32 v7, 7, v6
    v_lshlrev_b32 v7, 1, v7
    v_and_b32 v8, 15, v2
    v_xor_b32 v7, v7, v8
    v_lshlrev_b32 v7, 4, v7
    v_lshl_add_u32 v7, v6, 12, v7
    v_add_u32 v12, s37, v7
    s_mov_b32 s32, 0
    s_and_b32 s36, s44, 1
    s_lshr_b32 s37, s44, 1
    s_mul_i32 s47, s44, 7168
    s_mul_i32 s45, s36, 7168
    s_mul_i32 s46, s37, 22528
    s_add_u32 s42, s45, s46
    s_lshl_b32 s45, s44, 11
    s_add_u32 s43, s45, 14336
    s_mov_b32 s38, 0
    v_mov_b32 v6, 12672
    s_mov_b32 s45, 0x40000
w13_poll_sequential_preLN__ssm_conv_s4__glu_gated_swiglu__prompt_kernel_44:
    buffer_load_dword v7, v6, s[4:7], 0 offen sc1
    s_waitcnt vmcnt(0)
    v_readfirstlane_b32 s46, v7
    s_nop 1
    s_cmp_lg_u32 s46, 0
    s_cbranch_scc1 w13_done_sequential_preLN__ssm_conv_s4__glu_gated_swiglu__prompt_kernel_45
    s_sleep 4
    s_sub_u32 s45, s45, 1
    s_cmp_lg_u32 s45, 0
    s_cbranch_scc1 w13_poll_sequential_preLN__ssm_conv_s4__glu_gated_swiglu__prompt_kernel_44
w13_done_sequential_preLN__ssm_conv_s4__glu_gated_swiglu__prompt_kernel_45:
    s_add_u32 s40, s47, 0
    s_add_u32 m0, s42, 0
    s_nop 0
    buffer_load_dwordx4 v10, s[12:15], s40 offen offset:0 sc1 lds
    buffer_load_dwordx4 v10, s[12:15], s40 offen offset:1024 sc1 lds
    buffer_load_dwordx4 v10, s[12:15], s40 offen offset:2048 sc1 lds
    buffer_load_dwordx4 v10, s[12:15], s40 offen offset:3072 sc1 lds
    s_add_u32 m0, s42, 4096
    s_add_u32 s40, s40, 4096
    buffer_load_dwordx4 v10, s[12:15], s40 offen offset:0 sc1 lds
    buffer_load_dwordx4 v10, s[12:15], s40 offen offset:1024 sc1 lds
    buffer_load_dwordx4 v10, s[12:15], s40 offen offset:2048 sc1 lds
    s_add_u32 s40, s47, 28672
    s_add_u32 m0, s42, 45056
    s_nop 0
    buffer_load_dwordx4 v10, s[12:15], s40 offen offset:0 sc1 lds
    buffer_load_dwordx4 v10, s[12:15], s40 offen offset:1024 sc1 lds
    buffer_load_dwordx4 v10, s[12:15], s40 offen offset:2048 sc1 lds
    buffer_load_dwordx4 v10, s[12:15], s40 offen offset:3072 sc1 lds
    s_add_u32 m0, s42, 49152
    s_add_u32 s40, s40, 4096
    buffer_load_dwordx4 v10, s[12:15], s40 offen offset:0 sc1 lds
    buffer_load_dwordx4 v10, s[12:15], s40 offen offset:1024 sc1 lds
    buffer_load_dwordx4 v10, s[12:15], s40 offen offset:2048 sc1 lds
    s_add_u32 s40, s47, 57344
    s_add_u32 m0, s42, 90112
    s_nop 0
    buffer_load_dwordx4 v10, s[12:15], s40 offen offset:0 sc1 lds
    buffer_load_dwordx4 v10, s[12:15], s40 offen offset:1024 sc1 lds
    buffer_load_dwordx4 v10, s[12:15], s40 offen offset:2048 sc1 lds
    buffer_load_dwordx4 v10, s[12:15], s40 offen offset:3072 sc1 lds
    s_add_u32 m0, s42, 94208
    s_add_u32 s40, s40, 4096
    buffer_load_dwordx4 v10, s[12:15], s40 offen offset:0 sc1 lds
    buffer_load_dwordx4 v10, s[12:15], s40 offen offset:1024 sc1 lds
    buffer_load_dwordx4 v10, s[12:15], s40 offen offset:2048 sc1 lds
    s_barrier
    s_add_u32 m0, s43, 0
    s_mov_b32 s31, 0
    buffer_load_dwordx4 v11, s[16:19], s31 offen sc1 lds
    s_add_u32 m0, s43, 1024
    s_mov_b32 s31, 0
    buffer_load_dwordx4 v12, s[16:19], s31 offen sc1 lds
    s_add_u32 m0, s43, 22528
    s_mov_b32 s31, 131072
    buffer_load_dwordx4 v11, s[16:19], s31 offen sc1 lds
    s_add_u32 m0, s43, 23552
    s_mov_b32 s31, 131072
    buffer_load_dwordx4 v12, s[16:19], s31 offen sc1 lds
    s_add_u32 m0, s43, 45056
    s_mov_b32 s31, 262144
    buffer_load_dwordx4 v11, s[16:19], s31 offen sc1 lds
    s_add_u32 m0, s43, 46080
    s_mov_b32 s31, 262144
    buffer_load_dwordx4 v12, s[16:19], s31 offen sc1 lds
    s_add_u32 m0, s43, 67584
    s_mov_b32 s31, 393216
    buffer_load_dwordx4 v11, s[16:19], s31 offen sc1 lds
    s_add_u32 m0, s43, 68608
    s_mov_b32 s31, 393216
    buffer_load_dwordx4 v12, s[16:19], s31 offen sc1 lds
    s_waitcnt vmcnt(4)
    s_barrier
    s_add_u32 m0, s43, 90112
    s_mov_b32 s31, 524288
    buffer_load_dwordx4 v11, s[16:19], s31 offen sc1 lds
    s_add_u32 m0, s43, 91136
    s_mov_b32 s31, 524288
    buffer_load_dwordx4 v12, s[16:19], s31 offen sc1 lds
    s_add_u32 m0, s43, 112640
    s_mov_b32 s31, 655360
    buffer_load_dwordx4 v11, s[16:19], s31 offen sc1 lds
    s_add_u32 m0, s43, 113664
    s_mov_b32 s31, 655360
    buffer_load_dwordx4 v12, s[16:19], s31 offen sc1 lds
    s_waitcnt vmcnt(4)
    s_barrier
    s_mov_b32 s32, 3
    s_mov_b32 s38, 0
    s_mov_b32 s39, 5
lloop_sequential_preLN__ssm_conv_s4__glu_gated_swiglu__prompt_kernel_46:
    s_mul_i32 s40, s32, 28672
    s_add_u32 s40, s40, s47
    s_lshl_b32 s41, s32, 18
    s_add_u32 s48, s38, s42
    s_add_u32 s49, s38, s43
    s_add_u32 s32, s32, 1
    s_cmp_eq_u32 s32, 10
    s_cselect_b32 s32, 0, s32
    s_add_u32 s38, s38, 45056
    s_cmp_eq_u32 s38, 135168
    s_cselect_b32 s38, 0, s38
    s_mov_b32 m0, s48
    s_nop 0
    buffer_load_dwordx4 v10, s[12:15], s40 offen offset:0 sc1 lds
    buffer_load_dwordx4 v10, s[12:15], s40 offen offset:1024 sc1 lds
    buffer_load_dwordx4 v10, s[12:15], s40 offen offset:2048 sc1 lds
    buffer_load_dwordx4 v10, s[12:15], s40 offen offset:3072 sc1 lds
    s_add_u32 m0, s48, 4096
    s_add_u32 s40, s40, 4096
    buffer_load_dwordx4 v10, s[12:15], s40 offen offset:0 sc1 lds
    buffer_load_dwordx4 v10, s[12:15], s40 offen offset:1024 sc1 lds
    buffer_load_dwordx4 v10, s[12:15], s40 offen offset:2048 sc1 lds
    s_add_u32 m0, s49, 0
    s_add_u32 s31, s41, 0
    buffer_load_dwordx4 v11, s[16:19], s31 offen sc1 lds
    s_add_u32 m0, s49, 1024
    s_add_u32 s31, s41, 0
    buffer_load_dwordx4 v12, s[16:19], s31 offen sc1 lds
    s_add_u32 m0, s49, 22528
    s_add_u32 s31, s41, 131072
    buffer_load_dwordx4 v11, s[16:19], s31 offen sc1 lds
    s_add_u32 m0, s49, 23552
    s_add_u32 s31, s41, 131072
    buffer_load_dwordx4 v12, s[16:19], s31 offen sc1 lds
    s_waitcnt vmcnt(11)
    s_barrier
    s_sub_u32 s39, s39, 1
    s_cmp_lg_u32 s39, 0
    s_cbranch_scc1 lloop_sequential_preLN__ssm_conv_s4__glu_gated_swiglu__prompt_kernel_46
    s_add_u32 s45, s80, 2048
    v_mov_b32 v9, s45
    buffer_load_dword v7, v9, s[4:7], 0 offen sc1
    s_mul_i32 s40, s32, 28672
    s_add_u32 s40, s40, s47
    s_lshl_b32 s41, s32, 18
    s_add_u32 s48, s38, s42
    s_add_u32 s49, s38, s43
    s_add_u32 s32, s32, 1
    s_cmp_eq_u32 s32, 10
    s_cselect_b32 s32, 0, s32
    s_add_u32 s38, s38, 45056
    s_cmp_eq_u32 s38, 135168
    s_cselect_b32 s38, 0, s38
    s_mov_b32 m0, s48
    s_nop 0
    buffer_load_dwordx4 v10, s[12:15], s40 offen offset:0 sc1 lds
    buffer_load_dwordx4 v10, s[12:15], s40 offen offset:1024 sc1 lds
    buffer_load_dwordx4 v10, s[12:15], s40 offen offset:2048 sc1 lds
    buffer_load_dwordx4 v10, s[12:15], s40 offen offset:3072 sc1 lds
    s_add_u32 m0, s48, 4096
    s_add_u32 s40, s40, 4096
    buffer_load_dwordx4 v10, s[12:15], s40 offen offset:0 sc1 lds
    buffer_load_dwordx4 v10, s[12:15], s40 offen offset:1024 sc1 lds
    buffer_load_dwordx4 v10, s[12:15], s40 offen offset:2048 sc1 lds
    s_add_u32 m0, s49, 0
    s_add_u32 s31, s41, 0
    buffer_load_dwordx4 v11, s[16:19], s31 offen sc1 lds
    s_add_u32 m0, s49, 1024
    s_add_u32 s31, s41, 0
    buffer_load_dwordx4 v12, s[16:19], s31 offen sc1 lds
    s_add_u32 m0, s49, 22528
    s_add_u32 s31, s41, 131072
    buffer_load_dwordx4 v11, s[16:19], s31 offen sc1 lds
    s_add_u32 m0, s49, 23552
    s_add_u32 s31, s41, 131072
    buffer_load_dwordx4 v12, s[16:19], s31 offen sc1 lds
    s_waitcnt vmcnt(11)
    v_readfirstlane_b32 s45, v7
    s_nop 1
    s_cmp_lg_u32 s45, 0
    s_cbranch_scc1 polled_sequential_preLN__ssm_conv_s4__glu_gated_swiglu__prompt_kernel_48
    s_mov_b32 s39, 0x40000
poll_sequential_preLN__ssm_conv_s4__glu_gated_swiglu__prompt_kernel_47:
    buffer_load_dword v7, v9, s[4:7], 0 offen sc1
    s_waitcnt vmcnt(0)
    v_readfirstlane_b32 s45, v7
    s_nop 1
    s_cmp_lg_u32 s45, 0
    s_cbranch_scc1 polled_sequential_preLN__ssm_conv_s4__glu_gated_swiglu__prompt_kernel_48
    s_sleep 2
    s_sub_u32 s39, s39, 1
    s_cmp_lg_u32 s39, 0
    s_cbranch_scc1 poll_sequential_preLN__ssm_conv_s4__glu_gated_swiglu__prompt_kernel_47
polled_sequential_preLN__ssm_conv_s4__glu_gated_swiglu__prompt_kernel_48:
    s_barrier
    s_mul_i32 s40, s32, 28672
    s_add_u32 s40, s40, s47
    s_lshl_b32 s41, s32, 18
    s_add_u32 s48, s38, s42
    s_add_u32 s49, s38, s43
    s_add_u32 s32, s32, 1
    s_cmp_eq_u32 s32, 10
    s_cselect_b32 s32, 0, s32
    s_add_u32 s38, s38, 45056
    s_cmp_eq_u32 s38, 135168
    s_cselect_b32 s38, 0, s38
    s_mov_b32 m0, s48
    s_nop 0
    buffer_load_dwordx4 v10, s[12:15], s40 offen offset:0 sc1 lds
    buffer_load_dwordx4 v10, s[12:15], s40 offen offset:1024 sc1 lds
    buffer_load_dwordx4 v10, s[12:15], s40 offen offset:2048 sc1 lds
    buffer_load_dwordx4 v10, s[12:15], s40 offen offset:3072 sc1 lds
    s_add_u32 m0, s48, 4096
    s_add_u32 s40, s40, 4096
    buffer_load_dwordx4 v10, s[12:15], s40 offen offset:0 sc1 lds
    buffer_load_dwordx4 v10, s[12:15], s40 offen offset:1024 sc1 lds
    buffer_load_dwordx4 v10, s[12:15], s40 offen offset:2048 sc1 lds
    s_add_u32 m0, s49, 0
    s_add_u32 s31, s41, 0
    buffer_load_dwordx4 v11, s[16:19], s31 offen sc1 lds
    s_add_u32 m0, s49, 1024
    s_add_u32 s31, s41, 0
    buffer_load_dwordx4 v12, s[16:19], s31 offen sc1 lds
    s_add_u32 m0, s49, 22528
    s_add_u32 s31, s41, 131072
    buffer_load_dwordx4 v11, s[16:19], s31 offen sc1 lds
    s_add_u32 m0, s49, 23552
    s_add_u32 s31, s41, 131072
    buffer_load_dwordx4 v12, s[16:19], s31 offen sc1 lds
    v_and_b32 v6, 15, v2
    v_lshlrev_b32 v6, 4, v6
    v_lshl_add_u32 v6, v3, 10, v6
    s_lshl_b32 s45, s28, 14
    s_lshl_b32 s46, s44, 8
    s_add_u32 s45, s45, s46
    buffer_load_dwordx4 v[20:23], v6, s[76:79], s45 offen sc1
    s_add_u32 s45, s45, 4096
    buffer_load_dwordx4 v[24:27], v6, s[76:79], s45 offen sc1
    s_add_u32 s45, s45, 4096
    buffer_load_dwordx4 v[28:31], v6, s[76:79], s45 offen sc1
    s_add_u32 s45, s45, 4096
    buffer_load_dwordx4 v[32:35], v6, s[76:79], s45 offen sc1
    s_add_u32 s24, s8, 14942208
    s_addc_u32 s25, s9, 0
    s_mov_b32 s26, 114688
    s_mov_b32 s27, 0x20000
    s_mul_i32 s31, s29, 896
    s_mul_i32 s45, s44, 28672
    s_add_u32 s31, s31, s45
    buffer_load_dwordx4 v[36:39], v10, s[24:27], s31 offen sc1
    s_add_u32 s31, s31, 14336
    buffer_load_dwordx4 v[40:43], v10, s[24:27], s31 offen sc1
    s_waitcnt vmcnt(17)
    s_barrier
    s_waitcnt vmcnt(0)
    s_setprio 1
    v_pk_add_f32 v[36:37], v[36:37], v[40:41]
    v_pk_add_f32 v[38:39], v[38:39], v[42:43]
    s_lshl_b32 s45, s44, 10
    s_add_u32 s45, s45, 138240
    v_add_u32 v6, s45, v10
    ds_write_b128 v6, v[36:39]
    v_pk_add_f32 v[20:21], v[20:21], v[24:25]
    v_pk_add_f32 v[22:23], v[22:23], v[26:27]
    v_pk_add_f32 v[20:21], v[20:21], v[28:29]
    v_pk_add_f32 v[22:23], v[22:23], v[30:31]
    v_pk_add_f32 v[20:21], v[20:21], v[32:33]
    v_pk_add_f32 v[22:23], v[22:23], v[34:35]
    v_mov_b32 v24, v20
    v_mov_b32 v25, v21
    v_mov_b32 v26, v22
    v_mov_b32 v27, v23
    v_permlane32_swap_b32 v20, v24
    v_permlane32_swap_b32 v21, v25
    v_permlane32_swap_b32 v22, v26
    v_permlane32_swap_b32 v23, v27
    v_add_f32 v20, v20, v24
    v_add_f32 v21, v21, v25
    v_add_f32 v22, v22, v26
    v_add_f32 v23, v23, v27
    v_mov_b32 v24, v20
    v_mov_b32 v25, v21
    v_mov_b32 v26, v22
    v_mov_b32 v27, v23
    v_permlane16_swap_b32 v20, v24
    v_permlane16_swap_b32 v21, v25
    v_permlane16_swap_b32 v22, v26
    v_permlane16_swap_b32 v23, v27
    v_add_f32 v20, v20, v24
    v_add_f32 v21, v21, v25
    v_add_f32 v22, v22, v26
    v_add_f32 v23, v23, v27
    s_waitcnt vmcnt(0) lgkmcnt(0)
    s_barrier
    v_add_u32 v9, 138240, v10
    ds_read_b128 v[36:39], v9 offset:0
    ds_read_b128 v[40:43], v9 offset:1024
    ds_read_b128 v[44:47], v9 offset:2048
    ds_read_b128 v[48:51], v9 offset:3072
    v_and_b32 v8, 1, v3
    v_cmp_eq_u32 vcc, 1, v8
    s_nop 1
    v_cndmask_b32 v14, v20, v21, vcc
    v_cndmask_b32 v15, v22, v23, vcc
    v_mul_f32 v14, 0x3acccccd, v14
    v_mul_f32 v15, 0x3acccccd, v15
    v_fma_f32 v15, -v14, v14, v15
    v_max_f32 v15, 0, v15
    v_cvt_pk_bf16_f32 v15, v15, v15
    v_lshlrev_b32 v15, 16, v15
    v_add_f32 v15, 0x3727c5ac, v15
    v_cvt_pk_bf16_f32 v15, v15, v15
    v_lshlrev_b32 v15, 16, v15
    v_sqrt_f32 v15, v15
    s_nop 0
    v_cvt_pk_bf16_f32 v15, v15, v15
    v_lshlrev_b32 v15, 16, v15
    v_mov_b32 v16, v15
    v_rcp_f32 v6, v15
    s_nop 0
    v_fma_f32 v7, -v15, v6, 1.0
    v_fma_f32 v15, v7, v6, v6
    v_cvt_pk_bf16_f32 v14, v14, v14
    v_lshlrev_b32 v14, 16, v14
    v_and_b32 v6, 15, v2
    v_lshl_add_u32 v6, v6, 1, v8
    s_lshl_b32 s45, s44, 9
    s_add_u32 s45, s45, 135168
    v_lshl_add_u32 v6, v6, 4, s45
    v_mov_b32 v28, v14
    v_mul_f32 v29, 0xbfb8aa3b, v15
    v_mul_f32 v30, v16, v16
    v_mov_b32 v31, 0
    ds_write_b128 v6, v[28:31]
    s_waitcnt lgkmcnt(0)
    v_pk_add_f32 v[36:37], v[36:37], v[40:41]
    v_pk_add_f32 v[38:39], v[38:39], v[42:43]
    v_pk_add_f32 v[36:37], v[36:37], v[44:45]
    v_pk_add_f32 v[38:39], v[38:39], v[46:47]
    v_pk_add_f32 v[36:37], v[36:37], v[48:49]
    v_pk_add_f32 v[38:39], v[38:39], v[50:51]
    v_add_u32 v6, 137216, v10
    ds_write_b128 v6, v[36:39]
    s_waitcnt lgkmcnt(0)
    s_setprio 0
    s_barrier
    v_mov_b32 v6, 12416
    s_mov_b32 s47, 0x40000
w2_poll_sequential_preLN__ssm_conv_s4__glu_gated_swiglu__prompt_kernel_49:
    buffer_load_dword v7, v6, s[4:7], 0 offen sc1
    s_waitcnt vmcnt(0)
    v_readfirstlane_b32 s46, v7
    s_nop 1
    s_cmp_lg_u32 s46, 0
    s_cbranch_scc1 w2_done_sequential_preLN__ssm_conv_s4__glu_gated_swiglu__prompt_kernel_50
    s_sleep 2
    s_sub_u32 s47, s47, 1
    s_cmp_lg_u32 s47, 0
    s_cbranch_scc1 w2_poll_sequential_preLN__ssm_conv_s4__glu_gated_swiglu__prompt_kernel_49
w2_done_sequential_preLN__ssm_conv_s4__glu_gated_swiglu__prompt_kernel_50:
    s_and_b32 s34, s2, 7
    s_lshr_b32 s35, s2, 3
    s_and_b32 s92, s34, 1
    s_lshl_b32 s92, s92, 2
    s_and_b32 s45, s35, 3
    s_add_u32 s92, s92, s45
    s_lshr_b32 s93, s34, 1
    s_lshl_b32 s93, s93, 3
    s_lshr_b32 s45, s35, 2
    s_add_u32 s93, s93, s45
    s_and_b32 s45, s93, 7
    s_mul_i32 s45, s45, 14
    s_lshr_b32 s94, s45, 3
    s_mul_i32 s36, s92, 276480
    s_add_u32 s12, s8, s36
    s_addc_u32 s13, s9, 0
    s_add_u32 s12, s12, 19922944
    s_addc_u32 s13, s13, 0
    s_mov_b32 s14, 276480
    s_mov_b32 s15, 0x20000
    s_mul_i32 s41, s44, 5120
    s_mov_b32 s32, s94
    s_mul_i32 s40, s32, 20480
    s_add_u32 s40, s40, s41
    s_add_u32 s32, s32, 1
    s_cmp_eq_u32 s32, 14
    s_cselect_b32 s32, 0, s32
    s_add_u32 m0, s41, 0
    s_nop 0
    buffer_load_dwordx4 v10, s[12:15], s40 offen offset:0 sc1 lds
    buffer_load_dwordx4 v10, s[12:15], s40 offen offset:1024 sc1 lds
    buffer_load_dwordx4 v10, s[12:15], s40 offen offset:2048 sc1 lds
    buffer_load_dwordx4 v10, s[12:15], s40 offen offset:3072 sc1 lds
    s_add_u32 m0, s41, 4096
    s_add_u32 s40, s40, 4096
    buffer_load_dwordx4 v10, s[12:15], s40 offen offset:0 sc1 lds
    s_barrier
    s_mul_i32 s40, s32, 20480
    s_add_u32 s40, s40, s41
    s_add_u32 s32, s32, 1
    s_cmp_eq_u32 s32, 14
    s_cselect_b32 s32, 0, s32
    s_add_u32 m0, s41, 20480
    s_nop 0
    buffer_load_dwordx4 v10, s[12:15], s40 offen offset:0 sc1 lds
    buffer_load_dwordx4 v10, s[12:15], s40 offen offset:1024 sc1 lds
    buffer_load_dwordx4 v10, s[12:15], s40 offen offset:2048 sc1 lds
    buffer_load_dwordx4 v10, s[12:15], s40 offen offset:3072 sc1 lds
    s_add_u32 m0, s41, 24576
    s_add_u32 s40, s40, 4096
    buffer_load_dwordx4 v10, s[12:15], s40 offen offset:0 sc1 lds
    s_mul_i32 s40, s32, 20480
    s_add_u32 s40, s40, s41
    s_add_u32 s32, s32, 1
    s_cmp_eq_u32 s32, 14
    s_cselect_b32 s32, 0, s32
    s_add_u32 m0, s41, 40960
    s_nop 0
    buffer_load_dwordx4 v10, s[12:15], s40 offen offset:0 sc1 lds
    buffer_load_dwordx4 v10, s[12:15], s40 offen offset:1024 sc1 lds
    buffer_load_dwordx4 v10, s[12:15], s40 offen offset:2048 sc1 lds
    buffer_load_dwordx4 v10, s[12:15], s40 offen offset:3072 sc1 lds
    s_add_u32 m0, s41, 45056
    s_add_u32 s40, s40, 4096
    buffer_load_dwordx4 v10, s[12:15], s40 offen offset:0 sc1 lds
    s_mul_i32 s40, s32, 20480
    s_add_u32 s40, s40, s41
    s_add_u32 s32, s32, 1
    s_cmp_eq_u32 s32, 14
    s_cselect_b32 s32, 0, s32
    s_add_u32 m0, s41, 61440
    s_nop 0
    buffer_load_dwordx4 v10, s[12:15], s40 offen offset:0 sc1 lds
    buffer_load_dwordx4 v10, s[12:15], s40 offen offset:1024 sc1 lds
    buffer_load_dwordx4 v10, s[12:15], s40 offen offset:2048 sc1 lds
    buffer_load_dwordx4 v10, s[12:15], s40 offen offset:3072 sc1 lds
    s_add_u32 m0, s41, 65536
    s_add_u32 s40, s40, 4096
    buffer_load_dwordx4 v10, s[12:15], s40 offen offset:0 sc1 lds
    s_mul_i32 s40, s32, 20480
    s_add_u32 s40, s40, s41
    s_add_u32 s32, s32, 1
    s_cmp_eq_u32 s32, 14
    s_cselect_b32 s32, 0, s32
    s_add_u32 m0, s41, 81920
    s_nop 0
    buffer_load_dwordx4 v10, s[12:15], s40 offen offset:0 sc1 lds
    buffer_load_dwordx4 v10, s[12:15], s40 offen offset:1024 sc1 lds
    buffer_load_dwordx4 v10, s[12:15], s40 offen offset:2048 sc1 lds
    buffer_load_dwordx4 v10, s[12:15], s40 offen offset:3072 sc1 lds
    s_add_u32 m0, s41, 86016
    s_add_u32 s40, s40, 4096
    buffer_load_dwordx4 v10, s[12:15], s40 offen offset:0 sc1 lds
    s_mul_i32 s40, s32, 20480
    s_add_u32 s40, s40, s41
    s_add_u32 s32, s32, 1
    s_cmp_eq_u32 s32, 14
    s_cselect_b32 s32, 0, s32
    s_add_u32 m0, s41, 102400
    s_nop 0
    buffer_load_dwordx4 v10, s[12:15], s40 offen offset:0 sc1 lds
    buffer_load_dwordx4 v10, s[12:15], s40 offen offset:1024 sc1 lds
    buffer_load_dwordx4 v10, s[12:15], s40 offen offset:2048 sc1 lds
    buffer_load_dwordx4 v10, s[12:15], s40 offen offset:3072 sc1 lds
    s_add_u32 m0, s41, 106496
    s_add_u32 s40, s40, 4096
    buffer_load_dwordx4 v10, s[12:15], s40 offen offset:0 sc1 lds
    s_mul_i32 s40, s32, 20480
    s_add_u32 s40, s40, s41
    s_add_u32 s32, s32, 1
    s_cmp_eq_u32 s32, 14
    s_cselect_b32 s32, 0, s32
    s_add_u32 m0, s41, 122880
    s_nop 0
    buffer_load_dwordx4 v10, s[12:15], s40 offen offset:0 sc1 lds
    buffer_load_dwordx4 v10, s[12:15], s40 offen offset:1024 sc1 lds
    buffer_load_dwordx4 v10, s[12:15], s40 offen offset:2048 sc1 lds
    buffer_load_dwordx4 v10, s[12:15], s40 offen offset:3072 sc1 lds
    s_add_u32 m0, s41, 126976
    s_add_u32 s40, s40, 4096
    buffer_load_dwordx4 v10, s[12:15], s40 offen offset:0 sc1 lds
    s_mul_i32 s37, s92, 80
    v_lshrrev_b32 v6, 3, v2
    v_add_u32 v6, s37, v6
    v_lshlrev_b32 v6, 12, v6
    v_and_b32 v7, 7, v2
    v_lshl_add_u32 v6, v7, 4, v6
    s_lshl_b32 s36, s93, 7
    v_add_u32 v6, s36, v6
    s_lshl_b32 s36, s44, 10
    s_add_u32 m0, s36, 143360
    s_lshl_b32 s31, s44, 15
    s_add_u32 s31, s31, 0
    buffer_load_dwordx4 v6, s[16:19], s31 offen sc1 lds
    s_lshl_b32 s36, s44, 10
    s_add_u32 m0, s36, 147456
    s_lshl_b32 s31, s44, 15
    s_add_u32 s31, s31, 131072
    buffer_load_dwordx4 v6, s[16:19], s31 offen sc1 lds
    s_lshl_b32 s36, s44, 10
    s_add_u32 m0, s36, 151552
    s_lshl_b32 s31, s44, 15
    s_add_u32 s31, s31, 262144
    buffer_load_dwordx4 v6, s[16:19], s31 offen sc1 lds
    s_waitcnt vmcnt(33)
    s_barrier
    s_waitcnt vmcnt(28)
    s_barrier
    s_waitcnt vmcnt(23)
    s_barrier
    s_mul_i32 s40, s32, 20480
    s_add_u32 s40, s40, s41
    s_add_u32 s32, s32, 1
    s_cmp_eq_u32 s32, 14
    s_cselect_b32 s32, 0, s32
    s_add_u32 m0, s41, 0
    s_nop 0
    buffer_load_dwordx4 v10, s[12:15], s40 offen offset:0 sc1 lds
    buffer_load_dwordx4 v10, s[12:15], s40 offen offset:1024 sc1 lds
    buffer_load_dwordx4 v10, s[12:15], s40 offen offset:2048 sc1 lds
    buffer_load_dwordx4 v10, s[12:15], s40 offen offset:3072 sc1 lds
    s_add_u32 m0, s41, 4096
    s_add_u32 s40, s40, 4096
    buffer_load_dwordx4 v10, s[12:15], s40 offen offset:0 sc1 lds
    s_waitcnt vmcnt(23)
    s_barrier
    s_mul_i32 s40, s32, 20480
    s_add_u32 s40, s40, s41
    s_add_u32 s32, s32, 1
    s_cmp_eq_u32 s32, 14
    s_cselect_b32 s32, 0, s32
    s_add_u32 m0, s41, 20480
    s_nop 0
    buffer_load_dwordx4 v10, s[12:15], s40 offen offset:0 sc1 lds
    buffer_load_dwordx4 v10, s[12:15], s40 offen offset:1024 sc1 lds
    buffer_load_dwordx4 v10, s[12:15], s40 offen offset:2048 sc1 lds
    buffer_load_dwordx4 v10, s[12:15], s40 offen offset:3072 sc1 lds
    s_add_u32 m0, s41, 24576
    s_add_u32 s40, s40, 4096
    buffer_load_dwordx4 v10, s[12:15], s40 offen offset:0 sc1 lds
    s_waitcnt vmcnt(23)
    s_barrier
    s_mul_i32 s40, s32, 20480
    s_add_u32 s40, s40, s41
    s_add_u32 s32, s32, 1
    s_cmp_eq_u32 s32, 14
    s_cselect_b32 s32, 0, s32
    s_add_u32 m0, s41, 40960
    s_nop 0
    buffer_load_dwordx4 v10, s[12:15], s40 offen offset:0 sc1 lds
    buffer_load_dwordx4 v10, s[12:15], s40 offen offset:1024 sc1 lds
    buffer_load_dwordx4 v10, s[12:15], s40 offen offset:2048 sc1 lds
    buffer_load_dwordx4 v10, s[12:15], s40 offen offset:3072 sc1 lds
    s_add_u32 m0, s41, 45056
    s_add_u32 s40, s40, 4096
    buffer_load_dwordx4 v10, s[12:15], s40 offen offset:0 sc1 lds
    s_waitcnt vmcnt(23)
    s_barrier
    s_mul_i32 s40, s32, 20480
    s_add_u32 s40, s40, s41
    s_add_u32 s32, s32, 1
    s_cmp_eq_u32 s32, 14
    s_cselect_b32 s32, 0, s32
    s_add_u32 m0, s41, 61440
    s_nop 0
    buffer_load_dwordx4 v10, s[12:15], s40 offen offset:0 sc1 lds
    buffer_load_dwordx4 v10, s[12:15], s40 offen offset:1024 sc1 lds
    buffer_load_dwordx4 v10, s[12:15], s40 offen offset:2048 sc1 lds
    buffer_load_dwordx4 v10, s[12:15], s40 offen offset:3072 sc1 lds
    s_add_u32 m0, s41, 65536
    s_add_u32 s40, s40, 4096
    buffer_load_dwordx4 v10, s[12:15], s40 offen offset:0 sc1 lds
    s_waitcnt vmcnt(23)
    s_barrier
    s_mul_i32 s40, s32, 20480
    s_add_u32 s40, s40, s41
    s_add_u32 s32, s32, 1
    s_cmp_eq_u32 s32, 14
    s_cselect_b32 s32, 0, s32
    s_add_u32 m0, s41, 81920
    s_nop 0
    buffer_load_dwordx4 v10, s[12:15], s40 offen offset:0 sc1 lds
    buffer_load_dwordx4 v10, s[12:15], s40 offen offset:1024 sc1 lds
    buffer_load_dwordx4 v10, s[12:15], s40 offen offset:2048 sc1 lds
    buffer_load_dwordx4 v10, s[12:15], s40 offen offset:3072 sc1 lds
    s_add_u32 m0, s41, 86016
    s_add_u32 s40, s40, 4096
    buffer_load_dwordx4 v10, s[12:15], s40 offen offset:0 sc1 lds
    s_waitcnt vmcnt(20)
    s_barrier
    s_mul_i32 s40, s32, 20480
    s_add_u32 s40, s40, s41
    s_add_u32 s32, s32, 1
    s_cmp_eq_u32 s32, 14
    s_cselect_b32 s32, 0, s32
    s_add_u32 m0, s41, 102400
    s_nop 0
    buffer_load_dwordx4 v10, s[12:15], s40 offen offset:0 sc1 lds
    buffer_load_dwordx4 v10, s[12:15], s40 offen offset:1024 sc1 lds
    buffer_load_dwordx4 v10, s[12:15], s40 offen offset:2048 sc1 lds
    buffer_load_dwordx4 v10, s[12:15], s40 offen offset:3072 sc1 lds
    s_add_u32 m0, s41, 106496
    s_add_u32 s40, s40, 4096
    buffer_load_dwordx4 v10, s[12:15], s40 offen offset:0 sc1 lds
    s_waitcnt vmcnt(20)
    s_barrier
    s_mul_i32 s40, s32, 20480
    s_add_u32 s40, s40, s41
    s_add_u32 s32, s32, 1
    s_cmp_eq_u32 s32, 14
    s_cselect_b32 s32, 0, s32
    s_add_u32 m0, s41, 122880
    s_nop 0
    buffer_load_dwordx4 v10, s[12:15], s40 offen offset:0 sc1 lds
    buffer_load_dwordx4 v10, s[12:15], s40 offen offset:1024 sc1 lds
    buffer_load_dwordx4 v10, s[12:15], s40 offen offset:2048 sc1 lds
    buffer_load_dwordx4 v10, s[12:15], s40 offen offset:3072 sc1 lds
    s_add_u32 m0, s41, 126976
    s_add_u32 s40, s40, 4096
    buffer_load_dwordx4 v10, s[12:15], s40 offen offset:0 sc1 lds
    s_waitcnt vmcnt(20)
    s_barrier
    s_waitcnt vmcnt(15)
    s_barrier
    s_waitcnt vmcnt(10)
    s_barrier
    s_waitcnt vmcnt(5)
    s_barrier
    s_waitcnt vmcnt(0)
    s_barrier
    s_endpgm
done_sequential_preLN__ssm_conv_s4__glu_gated_swiglu__prompt_kernel_1:
    s_endpgm

.section .rodata,"a"
.p2align 6
.amdhsa_kernel sequential_preLN__ssm_conv_s4__glu_gated_swiglu__prompt_kernel
  .amdhsa_next_free_vgpr 254
  .amdhsa_next_free_sgpr 98
  .amdhsa_accum_offset 256
  .amdhsa_group_segment_fixed_size 0
  .amdhsa_kernarg_size 128
  .amdhsa_user_sgpr_count 2
  .amdhsa_user_sgpr_kernarg_segment_ptr 1
  .amdhsa_system_sgpr_workgroup_id_x 1
  .amdhsa_float_denorm_mode_32 3
.end_amdhsa_kernel
```
